```python
import torch

def _softmax(x, axis=-1):
    return torch.softmax(x, dim=axis)
def _gelu(x):
    return torch.nn.functional.gelu(x, approximate="tanh")
def _silu(x):
    return torch.nn.functional.silu(x)
def _sigmoid(x):
    return torch.sigmoid(x)
def _layernorm(x, axis=-1, eps=1e-5):
    m = x.mean(dim=axis, keepdim=True)
    v = x.var(dim=axis, keepdim=True, unbiased=False)
    return (x - m) / torch.sqrt(v + eps)
def _scatter_add(tgt, idx, src, axis=0):
    return tgt.clone().index_add_(axis, idx, src)
def _segment_sum(src, seg, n):
    out = torch.zeros((n,) + src.shape[1:], dtype=src.dtype)
    return out.index_add_(0, seg, src)
def _pad(x, pw):
    flat = tuple(v for pair in reversed(pw) for v in pair)
    return torch.nn.functional.pad(x, flat)

kernel_name = 'parallel_sum__softmax_full_mha__mixer_token_mlp__prompt'

def setup_inputs():

    _w = (lambda a: (lambda t: t.to(torch.bfloat16) if t.is_floating_point() else t)(torch.as_tensor(a)))
    def _A_setup():
        B, S, D = 1, 2048, 448
        return {
            "x": _w((lambda *s: torch.randn(*s, dtype=torch.bfloat16) * 0.05)(B, S, D)),
            "wqkv": _w((lambda *s: torch.randn(*s, dtype=torch.bfloat16) * 0.05)(D, 3 * D)),
            "wo": _w((lambda *s: torch.randn(*s, dtype=torch.bfloat16) * 0.05)(D, D)),
        }
    _A_in = _A_setup()

    def _B_setup():
        B, S, D, F = 1, 2048, 448, 1792
        return {
            "x": _w((lambda *s: torch.randn(*s, dtype=torch.bfloat16) * 0.05)(B, S, D)),
            "w1": _w((lambda *s: torch.randn(*s, dtype=torch.bfloat16) * 0.8)(S, F) * (S ** -0.5)),
            "b1": _w((lambda *s: torch.randn(*s, dtype=torch.bfloat16) * 12.8)(F) * 0.02),
            "w2": _w((lambda *s: torch.randn(*s, dtype=torch.bfloat16) * 0.2)(F, S) * (F ** -0.5)),
            "b2": _w((lambda *s: torch.randn(*s, dtype=torch.bfloat16) * 1.6)(S) * 0.02),
        }
    _B_in = _B_setup()

    return {
        "A_x": _A_in["x"],
        "A_wqkv": _A_in["wqkv"],
        "A_wo": _A_in["wo"],
        "B_x": _B_in["x"],
        "B_w1": _B_in["w1"],
        "B_b1": _B_in["b1"],
        "B_w2": _B_in["w2"],
        "B_b2": _B_in["b2"],
    }

def reference(A_x, A_wqkv, A_wo, B_x, B_w1, B_b1, B_w2, B_b2):
    def _A_ref(x, wqkv, wo):
        B, S, D = x.shape
        H = 16; Dh = D // H
        qkv = (lambda x, *d: x.permute(*d))((x @ wqkv).reshape(B, S, 3, H, Dh), 2, 0, 3, 1, 4)
        q, k, v = qkv[0], qkv[1], qkv[2]
        scale = Dh ** -0.5
        scores = torch.einsum("bhqd,bhkd->bhqk", q, k) * scale
        p = _softmax(scores, axis=-1)
        o = torch.einsum("bhqk,bhkd->bhqd", p, v)
        return (lambda x, *d: x.permute(*d))(o, 0, 2, 1, 3).reshape(B, S, D) @ wo

    def _B_ref(x, w1, b1, w2, b2):
        B, S, D = x.shape
        h = _layernorm(x, axis=-1)
        u = torch.einsum("bsd,sf->bdf", h, w1) + b1
        u = _gelu(u)
        y = torch.einsum("bdf,fs->bds", u, w2) + b2
        return (lambda x, *d: x.permute(*d))(y, 0, 2, 1)

    x = A_x
    xn = _layernorm(x, axis=-1)
    return x + _A_ref(xn, A_wqkv, A_wo) + _B_ref(xn, B_w1, B_b1, B_w2, B_b2)
```

```asm
; @launch grid=(256,1,1) block=(512,1,1) lds=163840
.amdgcn_target "amdgcn-amd-amdhsa--gfx950"
.text
.globl parallel_sum__softmax_full_mha__mixer_token_mlp__prompt_kernel
.p2align 8
.type parallel_sum__softmax_full_mha__mixer_token_mlp__prompt_kernel,@function
parallel_sum__softmax_full_mha__mixer_token_mlp__prompt_kernel:
    s_cmp_ge_u32 s2, 256
    s_cbranch_scc1 L_end
    s_load_dwordx2 s[4:5], s[0:1], 0
    s_load_dwordx2 s[8:9], s[0:1], 8
    s_load_dwordx2 s[40:41], s[0:1], 80
    s_load_dwordx2 s[12:13], s[0:1], 16
    s_load_dwordx2 s[16:17], s[0:1], 32
    s_load_dwordx2 s[24:25], s[0:1], 40
    s_load_dwordx2 s[20:21], s[0:1], 48
    s_load_dwordx2 s[28:29], s[0:1], 56
    s_load_dwordx2 s[32:33], s[0:1], 64
    s_load_dwordx2 s[36:37], s[0:1], 72
    s_getpc_b64 s[50:51]
L_pc:
    s_lshr_b32 s48, s2, 3
    s_sub_u32 s48, s48, 24
    s_cmp_ge_u32 s48, 8
    s_cbranch_scc1 L_nopf_1
    v_and_b32 v2, 0x1c0, v0
    v_cmp_eq_u32 vcc, 256, v2
    s_cbranch_vccz L_nopf_1
    v_and_b32 v2, 63, v0
    v_lshl_add_u32 v2, s48, 6, v2
    v_lshlrev_b32 v2, 7, v2
    v_min_u32 v2, L_last-L_pc, v2
    v_mov_b32 v3, s51
    v_add_co_u32 v2, vcc, s50, v2
    s_nop 1
    v_addc_co_u32 v3, vcc, 0, v3, vcc
    global_load_dword v240, v[2:3], off
L_nopf_1:
    v_lshrrev_b32 v2, 6, v0
    v_and_b32 v1, 63, v0
    v_readfirstlane_b32 s44, v2
    s_and_b32 s45, s2, 7
    s_lshr_b32 s46, s2, 3
    s_lshr_b32 s48, s45, 1
    s_lshl_b32 s48, s48, 3
    s_and_b32 s49, s46, 7
    s_add_u32 s68, s48, s49
    s_lshr_b32 s49, s46, 3
    s_add_u32 s47, s49, s44
    s_and_b32 s47, s47, 3
    s_lshl_b32 s57, s45, 3
    s_add_u32 s57, s57, s46
    s_sub_u32 s57, s57, 24
    s_lshl_b32 s48, s68, 2
    s_add_u32 s48, s48, s47
    s_lshl_b32 s48, s48, 1
    s_lshl_b32 s69, s57, 2
    s_add_u32 s69, s69, s44
    s_cmp_lt_u32 s46, 24
    s_cselect_b32 s48, s48, s69
    s_lshl_b32 s48, s48, 3
    v_lshrrev_b32 v132, 3, v1
    v_add_u32 v132, s48, v132
    v_mul_u32_u24 v132, 896, v132
    v_and_b32 v2, 7, v1
    v_lshl_add_u32 v132, v2, 4, v132
    v_add_u32 v133, 7168, v132
    s_mov_b32 s6, 1835008
    s_mov_b32 s7, 0x20000
    s_cmp_ge_u32 s46, 24
    s_waitcnt lgkmcnt(0)
    s_cbranch_scc1 L_nox2_3
    s_cmp_ge_u32 s44, 4
    s_cbranch_scc1 L_nox_2
    buffer_load_dwordx4 v[4:7], v132, s[4:7], 0 offen offset:0
    buffer_load_dwordx4 v[8:11], v132, s[4:7], 0 offen offset:128
    buffer_load_dwordx4 v[12:15], v132, s[4:7], 0 offen offset:256
    buffer_load_dwordx4 v[16:19], v132, s[4:7], 0 offen offset:384
    buffer_load_dwordx4 v[20:23], v132, s[4:7], 0 offen offset:512
    buffer_load_dwordx4 v[24:27], v132, s[4:7], 0 offen offset:640
    buffer_load_dwordx4 v[28:31], v132, s[4:7], 0 offen offset:768
    buffer_load_dwordx4 v[32:35], v133, s[4:7], 0 offen offset:0
    buffer_load_dwordx4 v[36:39], v133, s[4:7], 0 offen offset:128
    buffer_load_dwordx4 v[40:43], v133, s[4:7], 0 offen offset:256
    buffer_load_dwordx4 v[44:47], v133, s[4:7], 0 offen offset:384
    buffer_load_dwordx4 v[48:51], v133, s[4:7], 0 offen offset:512
    buffer_load_dwordx4 v[52:55], v133, s[4:7], 0 offen offset:640
    buffer_load_dwordx4 v[56:59], v133, s[4:7], 0 offen offset:768
    s_branch L_nox_2
L_nox2_3:
    s_cmp_lt_u32 s44, 4
    s_cbranch_scc1 L_nox_2
    s_mov_b32 s10, 1204224
    s_mov_b32 s11, 0x20000
    s_sub_u32 s50, s46, 24
    s_lshl_b32 s50, s50, 2
    s_add_u32 s50, s50, s44
    s_sub_u32 s50, s50, 4
    s_and_b32 s51, s45, 1
    s_mul_i32 s51, s51, 1280
    v_mul_u32_u24 v4, 5958, v1
    v_lshrrev_b32 v4, 16, v4
    v_mul_u32_u24 v5, 11, v4
    v_sub_u32 v5, v1, v5
    v_lshlrev_b32 v4, 5, v4
    v_add_u32 v4, s50, v4
    v_mul_u32_u24 v4, 2688, v4
    v_lshl_add_u32 v4, v5, 7, v4
    v_add_u32 v4, s51, v4
    v_mov_b32 v6, 0x40000000
    v_cmp_gt_u32 vcc, 55, v1
    s_mov_b32 s77, 0
    s_nop 0
    v_cndmask_b32 v4, v6, v4, vcc
    buffer_load_dword v5, v4, s[8:11], s77 offen
    s_add_u32 s77, s77, 430080
L_nox_2:
    v_mov_b32 v2, 163584
    v_mov_b32 v60, 0
    v_mov_b32 v61, 0
    v_mov_b32 v62, 0
    v_mov_b32 v63, 0
    ds_write_b128 v2, v[60:63]
    ds_write_b128 v2, v[60:63] offset:16
    ds_write_b128 v2, v[60:63] offset:32
    ds_write_b128 v2, v[60:63] offset:48
    ds_write_b128 v2, v[60:63] offset:64
    s_mov_b32 s10, 0x126000
    s_mov_b32 s11, 0x20000
    s_mov_b32 s14, 0x62000
    s_mov_b32 s15, 0x20000
    s_mov_b32 s18, 0x700000
    s_mov_b32 s19, 0x20000
    s_mov_b32 s22, 0x700000
    s_mov_b32 s23, 0x20000
    s_mov_b32 s26, 0xe00
    s_mov_b32 s27, 0x20000
    s_mov_b32 s30, 0x1000
    s_mov_b32 s31, 0x20000
    s_mov_b32 s34, 0x1c0000
    s_mov_b32 s35, 0x20000
    s_mov_b32 s38, 0x100
    s_mov_b32 s39, 0x20000
    s_mov_b32 s42, 0xb90000
    s_mov_b32 s43, 0x20000
    s_mov_b32 s66, 0x00003f80
    s_mov_b32 s67, 0x3f800000
    s_and_b32 s76, s44, 3
    s_and_b32 s48, s45, 1
    s_mul_i32 s48, s48, 3
    s_add_u32 s69, s48, s49
    s_lshr_b32 s48, s46, 4
    s_lshl_b32 s70, s45, 1
    s_add_u32 s70, s70, s48
    s_and_b32 s71, s46, 15
    s_mul_i32 s48, s45, 28
    s_add_u32 s48, s48, s46
    s_lshr_b32 s73, s48, 3
    s_and_b32 s72, s48, 7
    s_mul_i32 s48, s46, 37
    s_lshr_b32 s48, s48, 8
    s_lshl_b32 s74, s45, 2
    s_add_u32 s74, s74, s48
    s_mul_i32 s48, s48, 7
    s_sub_u32 s75, s46, s48
    s_waitcnt lgkmcnt(0)
    s_barrier
    s_cmp_ge_u32 s46, 24
    s_cbranch_scc1 L_hwg
    s_cmp_ge_u32 s44, 4
    s_cbranch_scc1 L_p1b
    v_and_b32 v206, 31, v1
    v_lshrrev_b32 v207, 1, v206
    v_and_b32 v207, 7, v207
    v_lshrrev_b32 v208, 5, v1
    v_mul_u32_u24 v206, 896, v206
    v_add_u32 v206, 100352, v206
    v_add_u32 v209, 0, v208
    v_xor_b32 v209, v209, v207
    v_lshl_add_u32 v200, v209, 4, v206
    v_add_u32 v209, 2, v208
    v_xor_b32 v209, v209, v207
    v_lshl_add_u32 v201, v209, 4, v206
    v_add_u32 v209, 4, v208
    v_xor_b32 v209, v209, v207
    v_lshl_add_u32 v202, v209, 4, v206
    v_add_u32 v209, 6, v208
    v_xor_b32 v209, v209, v207
    v_lshl_add_u32 v203, v209, 4, v206
    v_bfe_u32 v206, v1, 2, 2
    v_lshl_add_u32 v206, v208, 3, v206
    v_mul_u32_u24 v206, 448, v206
    v_bfe_u32 v207, v1, 4, 1
    v_lshl_add_u32 v206, v207, 5, v206
    v_and_b32 v207, 3, v1
    v_lshl_add_u32 v206, v207, 3, v206
    s_mul_i32 s48, s44, 112
    v_add_u32 v204, s48, v206
    v_add_u32 v205, 57344, v204
    v_lshrrev_b32 v206, 3, v1
    s_lshl_b32 s48, s47, 4
    v_add_u32 v206, s48, v206
    v_lshrrev_b32 v207, 1, v206
    v_xor_b32 v207, v207, v1
    v_and_b32 v207, 7, v207
    v_lshlrev_b32 v212, 2, v206
    v_add_u32 v212, 157696, v212
    v_mul_u32_u24 v206, 896, v206
    v_add_u32 v206, 100352, v206
    v_lshl_add_u32 v210, v207, 4, v206
    v_xor_b32 v207, 4, v207
    v_lshl_add_u32 v211, v207, 4, v206
    v_add_u32 v211, 7168, v211
    v_mov_b32 v214, 0
    v_mov_b32 v215, 0
    v_mov_b32 v216, 0
    v_mov_b32 v217, 0
    v_lshrrev_b32 v244, 3, v0
    v_and_b32 v245, 7, v0
    v_mul_u32_u24 v246, 272, v244
    v_lshl_add_u32 v246, v245, 5, v246
    v_add_u32 v246, 90112, v246
    s_lshl_b32 s48, s74, 6
    v_add_u32 v244, s48, v244
    v_mul_u32_u24 v247, 896, v244
    v_lshl_add_u32 v247, v245, 4, v247
    s_lshl_b32 s48, s75, 7
    v_add_u32 v247, s48, v247
    v_lshlrev_b32 v244, 1, v244
    s_waitcnt vmcnt(7)
    v_dot2c_f32_bf16 v214, 0x3f803f80, v4
    v_dot2c_f32_bf16 v216, v4, v4
    v_dot2c_f32_bf16 v214, 0x3f803f80, v5
    v_dot2c_f32_bf16 v216, v5, v5
    v_dot2c_f32_bf16 v214, 0x3f803f80, v6
    v_dot2c_f32_bf16 v216, v6, v6
    v_dot2c_f32_bf16 v214, 0x3f803f80, v7
    v_dot2c_f32_bf16 v216, v7, v7
    v_dot2c_f32_bf16 v214, 0x3f803f80, v8
    v_dot2c_f32_bf16 v216, v8, v8
    v_dot2c_f32_bf16 v214, 0x3f803f80, v9
    v_dot2c_f32_bf16 v216, v9, v9
    v_dot2c_f32_bf16 v214, 0x3f803f80, v10
    v_dot2c_f32_bf16 v216, v10, v10
    v_dot2c_f32_bf16 v214, 0x3f803f80, v11
    v_dot2c_f32_bf16 v216, v11, v11
    v_dot2c_f32_bf16 v214, 0x3f803f80, v12
    v_dot2c_f32_bf16 v216, v12, v12
    v_dot2c_f32_bf16 v214, 0x3f803f80, v13
    v_dot2c_f32_bf16 v216, v13, v13
    v_dot2c_f32_bf16 v214, 0x3f803f80, v14
    v_dot2c_f32_bf16 v216, v14, v14
    v_dot2c_f32_bf16 v214, 0x3f803f80, v15
    v_dot2c_f32_bf16 v216, v15, v15
    v_dot2c_f32_bf16 v214, 0x3f803f80, v16
    v_dot2c_f32_bf16 v216, v16, v16
    v_dot2c_f32_bf16 v214, 0x3f803f80, v17
    v_dot2c_f32_bf16 v216, v17, v17
    v_dot2c_f32_bf16 v214, 0x3f803f80, v18
    v_dot2c_f32_bf16 v216, v18, v18
    v_dot2c_f32_bf16 v214, 0x3f803f80, v19
    v_dot2c_f32_bf16 v216, v19, v19
    v_dot2c_f32_bf16 v214, 0x3f803f80, v20
    v_dot2c_f32_bf16 v216, v20, v20
    v_dot2c_f32_bf16 v214, 0x3f803f80, v21
    v_dot2c_f32_bf16 v216, v21, v21
    v_dot2c_f32_bf16 v214, 0x3f803f80, v22
    v_dot2c_f32_bf16 v216, v22, v22
    v_dot2c_f32_bf16 v214, 0x3f803f80, v23
    v_dot2c_f32_bf16 v216, v23, v23
    v_dot2c_f32_bf16 v214, 0x3f803f80, v24
    v_dot2c_f32_bf16 v216, v24, v24
    v_dot2c_f32_bf16 v214, 0x3f803f80, v25
    v_dot2c_f32_bf16 v216, v25, v25
    v_dot2c_f32_bf16 v214, 0x3f803f80, v26
    v_dot2c_f32_bf16 v216, v26, v26
    v_dot2c_f32_bf16 v214, 0x3f803f80, v27
    v_dot2c_f32_bf16 v216, v27, v27
    v_dot2c_f32_bf16 v214, 0x3f803f80, v28
    v_dot2c_f32_bf16 v216, v28, v28
    v_dot2c_f32_bf16 v214, 0x3f803f80, v29
    v_dot2c_f32_bf16 v216, v29, v29
    v_dot2c_f32_bf16 v214, 0x3f803f80, v30
    v_dot2c_f32_bf16 v216, v30, v30
    v_dot2c_f32_bf16 v214, 0x3f803f80, v31
    v_dot2c_f32_bf16 v216, v31, v31
    s_waitcnt vmcnt(3)
    v_dot2c_f32_bf16 v215, 0x3f803f80, v32
    v_dot2c_f32_bf16 v217, v32, v32
    v_dot2c_f32_bf16 v215, 0x3f803f80, v33
    v_dot2c_f32_bf16 v217, v33, v33
    v_dot2c_f32_bf16 v215, 0x3f803f80, v34
    v_dot2c_f32_bf16 v217, v34, v34
    v_dot2c_f32_bf16 v215, 0x3f803f80, v35
    v_dot2c_f32_bf16 v217, v35, v35
    v_dot2c_f32_bf16 v215, 0x3f803f80, v36
    v_dot2c_f32_bf16 v217, v36, v36
    v_dot2c_f32_bf16 v215, 0x3f803f80, v37
    v_dot2c_f32_bf16 v217, v37, v37
    v_dot2c_f32_bf16 v215, 0x3f803f80, v38
    v_dot2c_f32_bf16 v217, v38, v38
    v_dot2c_f32_bf16 v215, 0x3f803f80, v39
    v_dot2c_f32_bf16 v217, v39, v39
    v_dot2c_f32_bf16 v215, 0x3f803f80, v40
    v_dot2c_f32_bf16 v217, v40, v40
    v_dot2c_f32_bf16 v215, 0x3f803f80, v41
    v_dot2c_f32_bf16 v217, v41, v41
    v_dot2c_f32_bf16 v215, 0x3f803f80, v42
    v_dot2c_f32_bf16 v217, v42, v42
    v_dot2c_f32_bf16 v215, 0x3f803f80, v43
    v_dot2c_f32_bf16 v217, v43, v43
    v_dot2c_f32_bf16 v215, 0x3f803f80, v44
    v_dot2c_f32_bf16 v217, v44, v44
    v_dot2c_f32_bf16 v215, 0x3f803f80, v45
    v_dot2c_f32_bf16 v217, v45, v45
    v_dot2c_f32_bf16 v215, 0x3f803f80, v46
    v_dot2c_f32_bf16 v217, v46, v46
    v_dot2c_f32_bf16 v215, 0x3f803f80, v47
    v_dot2c_f32_bf16 v217, v47, v47
    s_waitcnt vmcnt(0)
    v_dot2c_f32_bf16 v215, 0x3f803f80, v48
    v_dot2c_f32_bf16 v217, v48, v48
    v_dot2c_f32_bf16 v215, 0x3f803f80, v49
    v_dot2c_f32_bf16 v217, v49, v49
    v_dot2c_f32_bf16 v215, 0x3f803f80, v50
    v_dot2c_f32_bf16 v217, v50, v50
    v_dot2c_f32_bf16 v215, 0x3f803f80, v51
    v_dot2c_f32_bf16 v217, v51, v51
    v_dot2c_f32_bf16 v215, 0x3f803f80, v52
    v_dot2c_f32_bf16 v217, v52, v52
    v_dot2c_f32_bf16 v215, 0x3f803f80, v53
    v_dot2c_f32_bf16 v217, v53, v53
    v_dot2c_f32_bf16 v215, 0x3f803f80, v54
    v_dot2c_f32_bf16 v217, v54, v54
    v_dot2c_f32_bf16 v215, 0x3f803f80, v55
    v_dot2c_f32_bf16 v217, v55, v55
    v_dot2c_f32_bf16 v215, 0x3f803f80, v56
    v_dot2c_f32_bf16 v217, v56, v56
    v_dot2c_f32_bf16 v215, 0x3f803f80, v57
    v_dot2c_f32_bf16 v217, v57, v57
    v_dot2c_f32_bf16 v215, 0x3f803f80, v58
    v_dot2c_f32_bf16 v217, v58, v58
    v_dot2c_f32_bf16 v215, 0x3f803f80, v59
    v_dot2c_f32_bf16 v217, v59, v59
    s_nop 1
    v_add_f32_dpp v214, v214, v214 quad_perm:[1,0,3,2] row_mask:0xf bank_mask:0xf
    v_add_f32_dpp v215, v215, v215 quad_perm:[1,0,3,2] row_mask:0xf bank_mask:0xf
    v_add_f32_dpp v216, v216, v216 quad_perm:[1,0,3,2] row_mask:0xf bank_mask:0xf
    v_add_f32_dpp v217, v217, v217 quad_perm:[1,0,3,2] row_mask:0xf bank_mask:0xf
    v_add_f32_dpp v214, v214, v214 quad_perm:[2,3,0,1] row_mask:0xf bank_mask:0xf
    v_add_f32_dpp v215, v215, v215 quad_perm:[2,3,0,1] row_mask:0xf bank_mask:0xf
    v_add_f32_dpp v216, v216, v216 quad_perm:[2,3,0,1] row_mask:0xf bank_mask:0xf
    v_add_f32_dpp v217, v217, v217 quad_perm:[2,3,0,1] row_mask:0xf bank_mask:0xf
    v_add_f32_dpp v214, v214, v214 row_half_mirror row_mask:0xf bank_mask:0xf
    v_add_f32_dpp v215, v215, v215 row_half_mirror row_mask:0xf bank_mask:0xf
    v_add_f32_dpp v216, v216, v216 row_half_mirror row_mask:0xf bank_mask:0xf
    v_add_f32_dpp v217, v217, v217 row_half_mirror row_mask:0xf bank_mask:0xf
    v_mul_f32 v214, 0xbb124925, v214
    v_mul_f32 v215, 0xbb124925, v215
    s_mov_b32 s48, 0x3b124925
    v_dot2_f32_bf16 v60, v4, s66, v214
    v_dot2_f32_bf16 v61, v4, s67, v214
    v_dot2_f32_bf16 v62, v5, s66, v214
    v_dot2_f32_bf16 v63, v5, s67, v214
    v_dot2_f32_bf16 v64, v6, s66, v214
    v_dot2_f32_bf16 v65, v6, s67, v214
    v_dot2_f32_bf16 v66, v7, s66, v214
    v_dot2_f32_bf16 v67, v7, s67, v214
    v_cvt_pk_bf16_f32 v68, v60, v61
    v_cvt_pk_bf16_f32 v69, v62, v63
    v_cvt_pk_bf16_f32 v70, v64, v65
    v_cvt_pk_bf16_f32 v71, v66, v67
    ds_write_b128 v210, v[68:71] offset:0
    v_dot2_f32_bf16 v60, v32, s66, v215
    v_dot2_f32_bf16 v61, v32, s67, v215
    v_dot2_f32_bf16 v62, v33, s66, v215
    v_dot2_f32_bf16 v63, v33, s67, v215
    v_dot2_f32_bf16 v64, v34, s66, v215
    v_dot2_f32_bf16 v65, v34, s67, v215
    v_dot2_f32_bf16 v66, v35, s66, v215
    v_dot2_f32_bf16 v67, v35, s67, v215
    v_cvt_pk_bf16_f32 v72, v60, v61
    v_cvt_pk_bf16_f32 v73, v62, v63
    v_cvt_pk_bf16_f32 v74, v64, v65
    v_cvt_pk_bf16_f32 v75, v66, v67
    ds_write_b128 v211, v[72:75] offset:0
    v_dot2_f32_bf16 v60, v8, s66, v214
    v_dot2_f32_bf16 v61, v8, s67, v214
    v_dot2_f32_bf16 v62, v9, s66, v214
    v_dot2_f32_bf16 v63, v9, s67, v214
    v_dot2_f32_bf16 v64, v10, s66, v214
    v_dot2_f32_bf16 v65, v10, s67, v214
    v_dot2_f32_bf16 v66, v11, s66, v214
    v_dot2_f32_bf16 v67, v11, s67, v214
    v_cvt_pk_bf16_f32 v76, v60, v61
    v_cvt_pk_bf16_f32 v77, v62, v63
    v_cvt_pk_bf16_f32 v78, v64, v65
    v_cvt_pk_bf16_f32 v79, v66, v67
    ds_write_b128 v210, v[76:79] offset:128
    v_dot2_f32_bf16 v60, v36, s66, v215
    v_dot2_f32_bf16 v61, v36, s67, v215
    v_dot2_f32_bf16 v62, v37, s66, v215
    v_dot2_f32_bf16 v63, v37, s67, v215
    v_dot2_f32_bf16 v64, v38, s66, v215
    v_dot2_f32_bf16 v65, v38, s67, v215
    v_dot2_f32_bf16 v66, v39, s66, v215
    v_dot2_f32_bf16 v67, v39, s67, v215
    v_cvt_pk_bf16_f32 v80, v60, v61
    v_cvt_pk_bf16_f32 v81, v62, v63
    v_cvt_pk_bf16_f32 v82, v64, v65
    v_cvt_pk_bf16_f32 v83, v66, v67
    ds_write_b128 v211, v[80:83] offset:128
    v_dot2_f32_bf16 v60, v12, s66, v214
    v_dot2_f32_bf16 v61, v12, s67, v214
    v_dot2_f32_bf16 v62, v13, s66, v214
    v_dot2_f32_bf16 v63, v13, s67, v214
    v_dot2_f32_bf16 v64, v14, s66, v214
    v_dot2_f32_bf16 v65, v14, s67, v214
    v_dot2_f32_bf16 v66, v15, s66, v214
    v_dot2_f32_bf16 v67, v15, s67, v214
    v_cvt_pk_bf16_f32 v68, v60, v61
    v_cvt_pk_bf16_f32 v69, v62, v63
    v_cvt_pk_bf16_f32 v70, v64, v65
    v_cvt_pk_bf16_f32 v71, v66, v67
    ds_write_b128 v210, v[68:71] offset:256
    v_dot2_f32_bf16 v60, v40, s66, v215
    v_dot2_f32_bf16 v61, v40, s67, v215
    v_dot2_f32_bf16 v62, v41, s66, v215
    v_dot2_f32_bf16 v63, v41, s67, v215
    v_dot2_f32_bf16 v64, v42, s66, v215
    v_dot2_f32_bf16 v65, v42, s67, v215
    v_dot2_f32_bf16 v66, v43, s66, v215
    v_dot2_f32_bf16 v67, v43, s67, v215
    v_cvt_pk_bf16_f32 v72, v60, v61
    v_cvt_pk_bf16_f32 v73, v62, v63
    v_cvt_pk_bf16_f32 v74, v64, v65
    v_cvt_pk_bf16_f32 v75, v66, v67
    ds_write_b128 v211, v[72:75] offset:256
    v_dot2_f32_bf16 v60, v16, s66, v214
    v_dot2_f32_bf16 v61, v16, s67, v214
    v_dot2_f32_bf16 v62, v17, s66, v214
    v_dot2_f32_bf16 v63, v17, s67, v214
    v_dot2_f32_bf16 v64, v18, s66, v214
    v_dot2_f32_bf16 v65, v18, s67, v214
    v_dot2_f32_bf16 v66, v19, s66, v214
    v_dot2_f32_bf16 v67, v19, s67, v214
    v_cvt_pk_bf16_f32 v76, v60, v61
    v_cvt_pk_bf16_f32 v77, v62, v63
    v_cvt_pk_bf16_f32 v78, v64, v65
    v_cvt_pk_bf16_f32 v79, v66, v67
    ds_write_b128 v210, v[76:79] offset:384
    v_dot2_f32_bf16 v60, v44, s66, v215
    v_dot2_f32_bf16 v61, v44, s67, v215
    v_dot2_f32_bf16 v62, v45, s66, v215
    v_dot2_f32_bf16 v63, v45, s67, v215
    v_dot2_f32_bf16 v64, v46, s66, v215
    v_dot2_f32_bf16 v65, v46, s67, v215
    v_dot2_f32_bf16 v66, v47, s66, v215
    v_dot2_f32_bf16 v67, v47, s67, v215
    v_cvt_pk_bf16_f32 v80, v60, v61
    v_cvt_pk_bf16_f32 v81, v62, v63
    v_cvt_pk_bf16_f32 v82, v64, v65
    v_cvt_pk_bf16_f32 v83, v66, v67
    ds_write_b128 v211, v[80:83] offset:384
    v_dot2_f32_bf16 v60, v20, s66, v214
    v_dot2_f32_bf16 v61, v20, s67, v214
    v_dot2_f32_bf16 v62, v21, s66, v214
    v_dot2_f32_bf16 v63, v21, s67, v214
    v_dot2_f32_bf16 v64, v22, s66, v214
    v_dot2_f32_bf16 v65, v22, s67, v214
    v_dot2_f32_bf16 v66, v23, s66, v214
    v_dot2_f32_bf16 v67, v23, s67, v214
    v_cvt_pk_bf16_f32 v68, v60, v61
    v_cvt_pk_bf16_f32 v69, v62, v63
    v_cvt_pk_bf16_f32 v70, v64, v65
    v_cvt_pk_bf16_f32 v71, v66, v67
    ds_write_b128 v210, v[68:71] offset:512
    v_dot2_f32_bf16 v60, v48, s66, v215
    v_dot2_f32_bf16 v61, v48, s67, v215
    v_dot2_f32_bf16 v62, v49, s66, v215
    v_dot2_f32_bf16 v63, v49, s67, v215
    v_dot2_f32_bf16 v64, v50, s66, v215
    v_dot2_f32_bf16 v65, v50, s67, v215
    v_dot2_f32_bf16 v66, v51, s66, v215
    v_dot2_f32_bf16 v67, v51, s67, v215
    v_cvt_pk_bf16_f32 v72, v60, v61
    v_cvt_pk_bf16_f32 v73, v62, v63
    v_cvt_pk_bf16_f32 v74, v64, v65
    v_cvt_pk_bf16_f32 v75, v66, v67
    ds_write_b128 v211, v[72:75] offset:512
    v_dot2_f32_bf16 v60, v24, s66, v214
    v_dot2_f32_bf16 v61, v24, s67, v214
    v_dot2_f32_bf16 v62, v25, s66, v214
    v_dot2_f32_bf16 v63, v25, s67, v214
    v_dot2_f32_bf16 v64, v26, s66, v214
    v_dot2_f32_bf16 v65, v26, s67, v214
    v_dot2_f32_bf16 v66, v27, s66, v214
    v_dot2_f32_bf16 v67, v27, s67, v214
    v_cvt_pk_bf16_f32 v76, v60, v61
    v_cvt_pk_bf16_f32 v77, v62, v63
    v_cvt_pk_bf16_f32 v78, v64, v65
    v_cvt_pk_bf16_f32 v79, v66, v67
    ds_write_b128 v210, v[76:79] offset:640
    v_dot2_f32_bf16 v60, v52, s66, v215
    v_dot2_f32_bf16 v61, v52, s67, v215
    v_dot2_f32_bf16 v62, v53, s66, v215
    v_dot2_f32_bf16 v63, v53, s67, v215
    v_dot2_f32_bf16 v64, v54, s66, v215
    v_dot2_f32_bf16 v65, v54, s67, v215
    v_dot2_f32_bf16 v66, v55, s66, v215
    v_dot2_f32_bf16 v67, v55, s67, v215
    v_cvt_pk_bf16_f32 v80, v60, v61
    v_cvt_pk_bf16_f32 v81, v62, v63
    v_cvt_pk_bf16_f32 v82, v64, v65
    v_cvt_pk_bf16_f32 v83, v66, v67
    ds_write_b128 v211, v[80:83] offset:640
    v_dot2_f32_bf16 v60, v28, s66, v214
    v_dot2_f32_bf16 v61, v28, s67, v214
    v_dot2_f32_bf16 v62, v29, s66, v214
    v_dot2_f32_bf16 v63, v29, s67, v214
    v_dot2_f32_bf16 v64, v30, s66, v214
    v_dot2_f32_bf16 v65, v30, s67, v214
    v_dot2_f32_bf16 v66, v31, s66, v214
    v_dot2_f32_bf16 v67, v31, s67, v214
    v_cvt_pk_bf16_f32 v68, v60, v61
    v_cvt_pk_bf16_f32 v69, v62, v63
    v_cvt_pk_bf16_f32 v70, v64, v65
    v_cvt_pk_bf16_f32 v71, v66, v67
    ds_write_b128 v210, v[68:71] offset:768
    v_dot2_f32_bf16 v60, v56, s66, v215
    v_dot2_f32_bf16 v61, v56, s67, v215
    v_dot2_f32_bf16 v62, v57, s66, v215
    v_dot2_f32_bf16 v63, v57, s67, v215
    v_dot2_f32_bf16 v64, v58, s66, v215
    v_dot2_f32_bf16 v65, v58, s67, v215
    v_dot2_f32_bf16 v66, v59, s66, v215
    v_dot2_f32_bf16 v67, v59, s67, v215
    v_cvt_pk_bf16_f32 v72, v60, v61
    v_cvt_pk_bf16_f32 v73, v62, v63
    v_cvt_pk_bf16_f32 v74, v64, v65
    v_cvt_pk_bf16_f32 v75, v66, v67
    ds_write_b128 v211, v[72:75] offset:768
    v_mul_f32 v206, v214, v214
    v_fma_f32 v206, v216, s48, -v206
    v_max_f32 v206, 0, v206
    v_add_f32 v206, 0x3727c5ac, v206
    v_mul_f32 v207, v215, v215
    v_fma_f32 v207, v217, s48, -v207
    v_max_f32 v207, 0, v207
    v_add_f32 v207, 0x3727c5ac, v207
    v_rsq_f32 v206, v206
    v_rsq_f32 v207, v207
    s_nop 0
    ds_write_b32 v212, v206 offset:0
    ds_write_b32 v212, v207 offset:32
    s_waitcnt lgkmcnt(0)
    s_barrier
    s_setprio 1
    ds_read_b128 v[60:63], v200 offset:0
    ds_read_b64_tr_b16 v[68:69], v204 offset:0
    ds_read_b64_tr_b16 v[70:71], v204 offset:1792
    ds_read_b128 v[64:67], v200 offset:28672
    ds_read_b64_tr_b16 v[72:73], v204 offset:56
    ds_read_b64_tr_b16 v[74:75], v204 offset:1848
    ds_read_b128 v[76:79], v201 offset:0
    ds_read_b64_tr_b16 v[84:85], v204 offset:7168
    ds_read_b64_tr_b16 v[86:87], v204 offset:8960
    ds_read_b128 v[80:83], v201 offset:28672
    ds_read_b64_tr_b16 v[88:89], v204 offset:7224
    ds_read_b64_tr_b16 v[90:91], v204 offset:9016
    buffer_load_dwordx4 v[248:251], v247, s[4:7], 0 offen
    buffer_load_ushort v252, v244, s[28:31], 0 offen
    v_mov_b32 v222, 0
    buffer_load_dwordx2 v[220:221], v222, s[36:39], 0 offen sc1
    v_mov_b32 v206, 0x40000
    v_mov_b32 v207, 1
    s_lshl_b32 s48, s44, 2
    s_add_u32 s48, s48, 163648
    v_writelane_b32 v206, s48, 0
    s_cmp_ge_u32 s69, 4
    s_cbranch_scc1 L_p1v_5
    s_waitcnt lgkmcnt(0)
    s_barrier
    v_mfma_f32_32x32x16_bf16 v[136:151], v[68:71], v[60:63], 0
    ds_read_b128 v[92:95], v202 offset:0
    ds_read_b64_tr_b16 v[100:101], v204 offset:14336
    v_mfma_f32_32x32x16_bf16 v[152:167], v[72:75], v[60:63], 0
    ds_read_b64_tr_b16 v[102:103], v204 offset:16128
    ds_read_b128 v[96:99], v202 offset:28672
    v_mfma_f32_32x32x16_bf16 v[168:183], v[68:71], v[64:67], 0
    ds_read_b64_tr_b16 v[104:105], v204 offset:14392
    ds_read_b64_tr_b16 v[106:107], v204 offset:16184
    v_mfma_f32_32x32x16_bf16 v[184:199], v[72:75], v[64:67], 0
    ds_read_b128 v[108:111], v203 offset:0
    ds_read_b64_tr_b16 v[116:117], v204 offset:21504
    v_mfma_f32_32x32x16_bf16 v[136:151], v[84:87], v[76:79], v[136:151]
    ds_read_b64_tr_b16 v[118:119], v204 offset:23296
    ds_read_b128 v[112:115], v203 offset:28672
    v_mfma_f32_32x32x16_bf16 v[152:167], v[88:91], v[76:79], v[152:167]
    ds_read_b64_tr_b16 v[120:121], v204 offset:21560
    ds_read_b64_tr_b16 v[122:123], v204 offset:23352
    v_mfma_f32_32x32x16_bf16 v[168:183], v[84:87], v[80:83], v[168:183]
    v_mfma_f32_32x32x16_bf16 v[184:199], v[88:91], v[80:83], v[184:199]
    s_waitcnt lgkmcnt(0)
    s_barrier
    v_mfma_f32_32x32x16_bf16 v[136:151], v[100:103], v[92:95], v[136:151]
    ds_read_b128 v[60:63], v200 offset:128
    ds_read_b64_tr_b16 v[68:69], v204 offset:28672
    v_mfma_f32_32x32x16_bf16 v[152:167], v[104:107], v[92:95], v[152:167]
    ds_read_b64_tr_b16 v[70:71], v204 offset:30464
    ds_read_b128 v[64:67], v200 offset:28800
    v_mfma_f32_32x32x16_bf16 v[168:183], v[100:103], v[96:99], v[168:183]
    ds_read_b64_tr_b16 v[72:73], v204 offset:28728
    ds_read_b64_tr_b16 v[74:75], v204 offset:30520
    v_mfma_f32_32x32x16_bf16 v[184:199], v[104:107], v[96:99], v[184:199]
    ds_read_b128 v[76:79], v201 offset:128
    ds_read_b64_tr_b16 v[84:85], v204 offset:35840
    v_mfma_f32_32x32x16_bf16 v[136:151], v[116:119], v[108:111], v[136:151]
    ds_read_b64_tr_b16 v[86:87], v204 offset:37632
    ds_read_b128 v[80:83], v201 offset:28800
    v_mfma_f32_32x32x16_bf16 v[152:167], v[120:123], v[108:111], v[152:167]
    ds_read_b64_tr_b16 v[88:89], v204 offset:35896
    ds_read_b64_tr_b16 v[90:91], v204 offset:37688
    v_mfma_f32_32x32x16_bf16 v[168:183], v[116:119], v[112:115], v[168:183]
    v_mfma_f32_32x32x16_bf16 v[184:199], v[120:123], v[112:115], v[184:199]
    s_waitcnt lgkmcnt(0)
    s_barrier
    v_mfma_f32_32x32x16_bf16 v[136:151], v[68:71], v[60:63], v[136:151]
    ds_read_b128 v[92:95], v202 offset:128
    ds_read_b64_tr_b16 v[100:101], v204 offset:43008
    v_mfma_f32_32x32x16_bf16 v[152:167], v[72:75], v[60:63], v[152:167]
    ds_read_b64_tr_b16 v[102:103], v204 offset:44800
    ds_read_b128 v[96:99], v202 offset:28800
    v_mfma_f32_32x32x16_bf16 v[168:183], v[68:71], v[64:67], v[168:183]
    ds_read_b64_tr_b16 v[104:105], v204 offset:43064
    ds_read_b64_tr_b16 v[106:107], v204 offset:44856
    v_mfma_f32_32x32x16_bf16 v[184:199], v[72:75], v[64:67], v[184:199]
    ds_read_b128 v[108:111], v203 offset:128
    ds_read_b64_tr_b16 v[116:117], v204 offset:50176
    v_mfma_f32_32x32x16_bf16 v[136:151], v[84:87], v[76:79], v[136:151]
    ds_read_b64_tr_b16 v[118:119], v204 offset:51968
    ds_read_b128 v[112:115], v203 offset:28800
    v_mfma_f32_32x32x16_bf16 v[152:167], v[88:91], v[76:79], v[152:167]
    ds_read_b64_tr_b16 v[120:121], v204 offset:50232
    ds_read_b64_tr_b16 v[122:123], v204 offset:52024
    v_mfma_f32_32x32x16_bf16 v[168:183], v[84:87], v[80:83], v[168:183]
    v_mfma_f32_32x32x16_bf16 v[184:199], v[88:91], v[80:83], v[184:199]
    s_waitcnt lgkmcnt(0)
    s_barrier
    v_mfma_f32_32x32x16_bf16 v[136:151], v[100:103], v[92:95], v[136:151]
    ds_read_b128 v[60:63], v200 offset:256
    ds_read_b64_tr_b16 v[68:69], v205 offset:0
    v_mfma_f32_32x32x16_bf16 v[152:167], v[104:107], v[92:95], v[152:167]
    ds_read_b64_tr_b16 v[70:71], v205 offset:1792
    ds_read_b128 v[64:67], v200 offset:28928
    v_mfma_f32_32x32x16_bf16 v[168:183], v[100:103], v[96:99], v[168:183]
    ds_read_b64_tr_b16 v[72:73], v205 offset:56
    ds_read_b64_tr_b16 v[74:75], v205 offset:1848
    v_mfma_f32_32x32x16_bf16 v[184:199], v[104:107], v[96:99], v[184:199]
    ds_read_b128 v[76:79], v201 offset:256
    ds_read_b64_tr_b16 v[84:85], v205 offset:7168
    v_mfma_f32_32x32x16_bf16 v[136:151], v[116:119], v[108:111], v[136:151]
    ds_read_b64_tr_b16 v[86:87], v205 offset:8960
    ds_read_b128 v[80:83], v201 offset:28928
    v_mfma_f32_32x32x16_bf16 v[152:167], v[120:123], v[108:111], v[152:167]
    ds_read_b64_tr_b16 v[88:89], v205 offset:7224
    ds_read_b64_tr_b16 v[90:91], v205 offset:9016
    v_mfma_f32_32x32x16_bf16 v[168:183], v[116:119], v[112:115], v[168:183]
    v_mfma_f32_32x32x16_bf16 v[184:199], v[120:123], v[112:115], v[184:199]
    s_waitcnt lgkmcnt(0)
    s_barrier
    v_mfma_f32_32x32x16_bf16 v[136:151], v[68:71], v[60:63], v[136:151]
    ds_read_b128 v[92:95], v202 offset:256
    ds_read_b64_tr_b16 v[100:101], v205 offset:14336
    v_mfma_f32_32x32x16_bf16 v[152:167], v[72:75], v[60:63], v[152:167]
    ds_read_b64_tr_b16 v[102:103], v205 offset:16128
    ds_read_b128 v[96:99], v202 offset:28928
    v_mfma_f32_32x32x16_bf16 v[168:183], v[68:71], v[64:67], v[168:183]
    ds_read_b64_tr_b16 v[104:105], v205 offset:14392
    ds_read_b64_tr_b16 v[106:107], v205 offset:16184
    v_mfma_f32_32x32x16_bf16 v[184:199], v[72:75], v[64:67], v[184:199]
    ds_read_b128 v[108:111], v203 offset:256
    ds_read_b64_tr_b16 v[116:117], v205 offset:21504
    v_mfma_f32_32x32x16_bf16 v[136:151], v[84:87], v[76:79], v[136:151]
    ds_read_b64_tr_b16 v[118:119], v205 offset:23296
    ds_read_b128 v[112:115], v203 offset:28928
    v_mfma_f32_32x32x16_bf16 v[152:167], v[88:91], v[76:79], v[152:167]
    ds_read_b64_tr_b16 v[120:121], v205 offset:21560
    ds_read_b64_tr_b16 v[122:123], v205 offset:23352
    v_mfma_f32_32x32x16_bf16 v[168:183], v[84:87], v[80:83], v[168:183]
    v_mfma_f32_32x32x16_bf16 v[184:199], v[88:91], v[80:83], v[184:199]
    s_waitcnt lgkmcnt(0)
    s_barrier
    v_mfma_f32_32x32x16_bf16 v[136:151], v[100:103], v[92:95], v[136:151]
    ds_read_b128 v[60:63], v200 offset:384
    ds_read_b64_tr_b16 v[68:69], v205 offset:28672
    v_mfma_f32_32x32x16_bf16 v[152:167], v[104:107], v[92:95], v[152:167]
    ds_read_b64_tr_b16 v[70:71], v205 offset:30464
    ds_read_b128 v[64:67], v200 offset:29056
    v_mfma_f32_32x32x16_bf16 v[168:183], v[100:103], v[96:99], v[168:183]
    ds_read_b64_tr_b16 v[72:73], v205 offset:28728
    ds_read_b64_tr_b16 v[74:75], v205 offset:30520
    v_mfma_f32_32x32x16_bf16 v[184:199], v[104:107], v[96:99], v[184:199]
    ds_read_b128 v[76:79], v201 offset:384
    ds_read_b64_tr_b16 v[84:85], v205 offset:35840
    v_mfma_f32_32x32x16_bf16 v[136:151], v[116:119], v[108:111], v[136:151]
    ds_read_b64_tr_b16 v[86:87], v205 offset:37632
    ds_read_b128 v[80:83], v201 offset:29056
    v_mfma_f32_32x32x16_bf16 v[152:167], v[120:123], v[108:111], v[152:167]
    ds_read_b64_tr_b16 v[88:89], v205 offset:35896
    ds_read_b64_tr_b16 v[90:91], v205 offset:37688
    v_mfma_f32_32x32x16_bf16 v[168:183], v[116:119], v[112:115], v[168:183]
    v_mfma_f32_32x32x16_bf16 v[184:199], v[120:123], v[112:115], v[184:199]
    s_waitcnt lgkmcnt(0)
    s_barrier
    v_mfma_f32_32x32x16_bf16 v[136:151], v[68:71], v[60:63], v[136:151]
    ds_read_b128 v[92:95], v202 offset:384
    ds_read_b64_tr_b16 v[100:101], v204 offset:0
    v_mfma_f32_32x32x16_bf16 v[152:167], v[72:75], v[60:63], v[152:167]
    ds_read_b64_tr_b16 v[102:103], v204 offset:1792
    ds_read_b128 v[96:99], v202 offset:29056
    v_mfma_f32_32x32x16_bf16 v[168:183], v[68:71], v[64:67], v[168:183]
    ds_read_b64_tr_b16 v[104:105], v204 offset:56
    ds_read_b64_tr_b16 v[106:107], v204 offset:1848
    v_mfma_f32_32x32x16_bf16 v[184:199], v[72:75], v[64:67], v[184:199]
    ds_read_b128 v[108:111], v203 offset:384
    ds_read_b64_tr_b16 v[116:117], v204 offset:7168
    v_mfma_f32_32x32x16_bf16 v[136:151], v[84:87], v[76:79], v[136:151]
    ds_read_b64_tr_b16 v[118:119], v204 offset:8960
    ds_read_b128 v[112:115], v203 offset:29056
    v_mfma_f32_32x32x16_bf16 v[152:167], v[88:91], v[76:79], v[152:167]
    ds_read_b64_tr_b16 v[120:121], v204 offset:7224
    ds_read_b64_tr_b16 v[122:123], v204 offset:9016
    v_mfma_f32_32x32x16_bf16 v[168:183], v[84:87], v[80:83], v[168:183]
    v_mfma_f32_32x32x16_bf16 v[184:199], v[88:91], v[80:83], v[184:199]
    s_waitcnt lgkmcnt(0)
    s_barrier
    v_mfma_f32_32x32x16_bf16 v[136:151], v[100:103], v[92:95], v[136:151]
    ds_read_b128 v[60:63], v200 offset:512
    ds_read_b64_tr_b16 v[68:69], v204 offset:14336
    v_mfma_f32_32x32x16_bf16 v[152:167], v[104:107], v[92:95], v[152:167]
    ds_read_b64_tr_b16 v[70:71], v204 offset:16128
    ds_read_b128 v[64:67], v200 offset:29184
    v_mfma_f32_32x32x16_bf16 v[168:183], v[100:103], v[96:99], v[168:183]
    ds_read_b64_tr_b16 v[72:73], v204 offset:14392
    ds_read_b64_tr_b16 v[74:75], v204 offset:16184
    v_mfma_f32_32x32x16_bf16 v[184:199], v[104:107], v[96:99], v[184:199]
    ds_read_b128 v[76:79], v201 offset:512
    ds_read_b64_tr_b16 v[84:85], v204 offset:21504
    v_mfma_f32_32x32x16_bf16 v[136:151], v[116:119], v[108:111], v[136:151]
    ds_read_b64_tr_b16 v[86:87], v204 offset:23296
    ds_read_b128 v[80:83], v201 offset:29184
    v_mfma_f32_32x32x16_bf16 v[152:167], v[120:123], v[108:111], v[152:167]
    ds_read_b64_tr_b16 v[88:89], v204 offset:21560
    ds_read_b64_tr_b16 v[90:91], v204 offset:23352
    v_mfma_f32_32x32x16_bf16 v[168:183], v[116:119], v[112:115], v[168:183]
    v_mfma_f32_32x32x16_bf16 v[184:199], v[120:123], v[112:115], v[184:199]
    s_waitcnt lgkmcnt(0)
    s_barrier
    v_mfma_f32_32x32x16_bf16 v[136:151], v[68:71], v[60:63], v[136:151]
    ds_read_b128 v[92:95], v202 offset:512
    ds_read_b64_tr_b16 v[100:101], v204 offset:28672
    v_mfma_f32_32x32x16_bf16 v[152:167], v[72:75], v[60:63], v[152:167]
    ds_read_b64_tr_b16 v[102:103], v204 offset:30464
    ds_read_b128 v[96:99], v202 offset:29184
    v_mfma_f32_32x32x16_bf16 v[168:183], v[68:71], v[64:67], v[168:183]
    ds_read_b64_tr_b16 v[104:105], v204 offset:28728
    ds_read_b64_tr_b16 v[106:107], v204 offset:30520
    v_mfma_f32_32x32x16_bf16 v[184:199], v[72:75], v[64:67], v[184:199]
    ds_read_b128 v[108:111], v203 offset:512
    ds_read_b64_tr_b16 v[116:117], v204 offset:35840
    v_mfma_f32_32x32x16_bf16 v[136:151], v[84:87], v[76:79], v[136:151]
    ds_read_b64_tr_b16 v[118:119], v204 offset:37632
    ds_read_b128 v[112:115], v203 offset:29184
    v_mfma_f32_32x32x16_bf16 v[152:167], v[88:91], v[76:79], v[152:167]
    ds_read_b64_tr_b16 v[120:121], v204 offset:35896
    ds_read_b64_tr_b16 v[122:123], v204 offset:37688
    v_mfma_f32_32x32x16_bf16 v[168:183], v[84:87], v[80:83], v[168:183]
    v_mfma_f32_32x32x16_bf16 v[184:199], v[88:91], v[80:83], v[184:199]
    s_waitcnt lgkmcnt(0)
    ds_add_u32 v206, v207
    v_mfma_f32_32x32x16_bf16 v[136:151], v[100:103], v[92:95], v[136:151]
    ds_read_b128 v[60:63], v200 offset:640
    ds_read_b64_tr_b16 v[68:69], v204 offset:43008
    v_mfma_f32_32x32x16_bf16 v[152:167], v[104:107], v[92:95], v[152:167]
    ds_read_b64_tr_b16 v[70:71], v204 offset:44800
    ds_read_b128 v[64:67], v200 offset:29312
    v_mfma_f32_32x32x16_bf16 v[168:183], v[100:103], v[96:99], v[168:183]
    ds_read_b64_tr_b16 v[72:73], v204 offset:43064
    ds_read_b64_tr_b16 v[74:75], v204 offset:44856
    v_mfma_f32_32x32x16_bf16 v[184:199], v[104:107], v[96:99], v[184:199]
    ds_read_b128 v[76:79], v201 offset:640
    ds_read_b64_tr_b16 v[84:85], v204 offset:50176
    v_mfma_f32_32x32x16_bf16 v[136:151], v[116:119], v[108:111], v[136:151]
    ds_read_b64_tr_b16 v[86:87], v204 offset:51968
    ds_read_b128 v[80:83], v201 offset:29312
    v_mfma_f32_32x32x16_bf16 v[152:167], v[120:123], v[108:111], v[152:167]
    ds_read_b64_tr_b16 v[88:89], v204 offset:50232
    ds_read_b64_tr_b16 v[90:91], v204 offset:52024
    v_mfma_f32_32x32x16_bf16 v[168:183], v[116:119], v[112:115], v[168:183]
    v_mfma_f32_32x32x16_bf16 v[184:199], v[120:123], v[112:115], v[184:199]
    s_waitcnt lgkmcnt(0)
    ds_add_u32 v206, v207
    v_mfma_f32_32x32x16_bf16 v[136:151], v[68:71], v[60:63], v[136:151]
    ds_read_b128 v[92:95], v202 offset:640
    ds_read_b64_tr_b16 v[100:101], v205 offset:0
    v_mfma_f32_32x32x16_bf16 v[152:167], v[72:75], v[60:63], v[152:167]
    ds_read_b64_tr_b16 v[102:103], v205 offset:1792
    ds_read_b128 v[96:99], v202 offset:29312
    v_mfma_f32_32x32x16_bf16 v[168:183], v[68:71], v[64:67], v[168:183]
    ds_read_b64_tr_b16 v[104:105], v205 offset:56
    ds_read_b64_tr_b16 v[106:107], v205 offset:1848
    v_mfma_f32_32x32x16_bf16 v[184:199], v[72:75], v[64:67], v[184:199]
    ds_read_b128 v[108:111], v203 offset:640
    ds_read_b64_tr_b16 v[116:117], v205 offset:7168
    v_mfma_f32_32x32x16_bf16 v[136:151], v[84:87], v[76:79], v[136:151]
    ds_read_b64_tr_b16 v[118:119], v205 offset:8960
    ds_read_b128 v[112:115], v203 offset:29312
    v_mfma_f32_32x32x16_bf16 v[152:167], v[88:91], v[76:79], v[152:167]
    ds_read_b64_tr_b16 v[120:121], v205 offset:7224
    ds_read_b64_tr_b16 v[122:123], v205 offset:9016
    v_mfma_f32_32x32x16_bf16 v[168:183], v[84:87], v[80:83], v[168:183]
    v_mfma_f32_32x32x16_bf16 v[184:199], v[88:91], v[80:83], v[184:199]
    s_waitcnt lgkmcnt(0)
    ds_add_u32 v206, v207
    v_mfma_f32_32x32x16_bf16 v[136:151], v[100:103], v[92:95], v[136:151]
    ds_read_b128 v[60:63], v200 offset:768
    ds_read_b64_tr_b16 v[68:69], v205 offset:14336
    v_mfma_f32_32x32x16_bf16 v[152:167], v[104:107], v[92:95], v[152:167]
    ds_read_b64_tr_b16 v[70:71], v205 offset:16128
    ds_read_b128 v[64:67], v200 offset:29440
    v_mfma_f32_32x32x16_bf16 v[168:183], v[100:103], v[96:99], v[168:183]
    ds_read_b64_tr_b16 v[72:73], v205 offset:14392
    ds_read_b64_tr_b16 v[74:75], v205 offset:16184
    v_mfma_f32_32x32x16_bf16 v[184:199], v[104:107], v[96:99], v[184:199]
    ds_read_b128 v[76:79], v201 offset:768
    ds_read_b64_tr_b16 v[84:85], v205 offset:21504
    v_mfma_f32_32x32x16_bf16 v[136:151], v[116:119], v[108:111], v[136:151]
    ds_read_b64_tr_b16 v[86:87], v205 offset:23296
    ds_read_b128 v[80:83], v201 offset:29440
    v_mfma_f32_32x32x16_bf16 v[152:167], v[120:123], v[108:111], v[152:167]
    ds_read_b64_tr_b16 v[88:89], v205 offset:21560
    ds_read_b64_tr_b16 v[90:91], v205 offset:23352
    v_mfma_f32_32x32x16_bf16 v[168:183], v[116:119], v[112:115], v[168:183]
    v_mfma_f32_32x32x16_bf16 v[184:199], v[120:123], v[112:115], v[184:199]
    s_waitcnt lgkmcnt(0)
    ds_add_u32 v206, v207
    v_mfma_f32_32x32x16_bf16 v[136:151], v[68:71], v[60:63], v[136:151]
    ds_read_b128 v[92:95], v202 offset:768
    ds_read_b64_tr_b16 v[100:101], v205 offset:28672
    v_mfma_f32_32x32x16_bf16 v[152:167], v[72:75], v[60:63], v[152:167]
    ds_read_b64_tr_b16 v[102:103], v205 offset:30464
    ds_read_b128 v[96:99], v202 offset:29440
    v_mfma_f32_32x32x16_bf16 v[168:183], v[68:71], v[64:67], v[168:183]
    ds_read_b64_tr_b16 v[104:105], v205 offset:28728
    ds_read_b64_tr_b16 v[106:107], v205 offset:30520
    v_mfma_f32_32x32x16_bf16 v[184:199], v[72:75], v[64:67], v[184:199]
    ds_read_b128 v[108:111], v203 offset:768
    ds_read_b64_tr_b16 v[116:117], v205 offset:35840
    v_mfma_f32_32x32x16_bf16 v[136:151], v[84:87], v[76:79], v[136:151]
    ds_read_b64_tr_b16 v[118:119], v205 offset:37632
    ds_read_b128 v[112:115], v203 offset:29440
    v_mfma_f32_32x32x16_bf16 v[152:167], v[88:91], v[76:79], v[152:167]
    ds_read_b64_tr_b16 v[120:121], v205 offset:35896
    ds_read_b64_tr_b16 v[122:123], v205 offset:37688
    v_mfma_f32_32x32x16_bf16 v[168:183], v[84:87], v[80:83], v[168:183]
    v_mfma_f32_32x32x16_bf16 v[184:199], v[88:91], v[80:83], v[184:199]
    s_waitcnt lgkmcnt(0)
    ds_add_u32 v206, v207
    v_mfma_f32_32x32x16_bf16 v[136:151], v[100:103], v[92:95], v[136:151]
    v_mfma_f32_32x32x16_bf16 v[152:167], v[104:107], v[92:95], v[152:167]
    v_mfma_f32_32x32x16_bf16 v[168:183], v[100:103], v[96:99], v[168:183]
    v_mfma_f32_32x32x16_bf16 v[184:199], v[104:107], v[96:99], v[184:199]
    v_mfma_f32_32x32x16_bf16 v[136:151], v[116:119], v[108:111], v[136:151]
    v_mfma_f32_32x32x16_bf16 v[152:167], v[120:123], v[108:111], v[152:167]
    v_mfma_f32_32x32x16_bf16 v[168:183], v[116:119], v[112:115], v[168:183]
    v_mfma_f32_32x32x16_bf16 v[184:199], v[120:123], v[112:115], v[184:199]
    v_and_b32 v206, 31, v1
    v_lshlrev_b32 v206, 2, v206
    v_add_u32 v206, 157696, v206
    ds_read2_b32 v[214:215], v206 offset1:32
    s_cmp_lt_u32 s69, 2
    s_cselect_b32 s54, 0x3e8b97f6, 1.0
    s_mov_b32 s55, 4096
    s_mov_b32 s56, 0x240000
    s_cselect_b32 s55, 2048, s55
    s_cselect_b32 s56, 0x40000, s56
    s_and_b32 s48, s69, 1
    s_lshl_b32 s48, s48, 2
    s_add_u32 s48, s48, s44
    s_lshl_b32 s48, s48, 6
    s_add_u32 s48, s48, s68
    s_lshl_b32 s48, s48, 1
    s_mul_i32 s48, s48, s55
    s_add_u32 s50, s48, s56
    s_lshl_b32 s48, s55, 6
    s_add_u32 s51, s50, s48
    s_add_u32 s52, s50, s55
    s_add_u32 s53, s51, s55
    v_lshlrev_b32 v209, 4, v1
    v_cmp_gt_u32 vcc, 32, v1
    s_waitcnt lgkmcnt(0)
    v_mul_f32 v216, s54, v215
    v_mul_f32 v217, s54, v215
    v_mul_f32 v215, s54, v214
    v_mul_f32 v214, s54, v214
    v_pk_mul_f32 v[136:137], v[136:137], v[214:215]
    v_pk_mul_f32 v[138:139], v[138:139], v[214:215]
    v_pk_mul_f32 v[140:141], v[140:141], v[214:215]
    v_pk_mul_f32 v[142:143], v[142:143], v[214:215]
    v_pk_mul_f32 v[144:145], v[144:145], v[214:215]
    v_pk_mul_f32 v[146:147], v[146:147], v[214:215]
    v_pk_mul_f32 v[148:149], v[148:149], v[214:215]
    v_pk_mul_f32 v[150:151], v[150:151], v[214:215]
    v_cvt_pk_bf16_f32 v60, v136, v137
    v_cvt_pk_bf16_f32 v61, v138, v139
    v_cvt_pk_bf16_f32 v62, v140, v141
    v_cvt_pk_bf16_f32 v63, v142, v143
    v_cvt_pk_bf16_f32 v64, v144, v145
    v_cvt_pk_bf16_f32 v65, v146, v147
    v_cvt_pk_bf16_f32 v66, v148, v149
    v_cvt_pk_bf16_f32 v67, v150, v151
    v_cndmask_b32 v66, 0, v66, vcc
    v_cndmask_b32 v67, 0, v67, vcc
    buffer_store_dwordx4 v[60:63], v209, s[40:43], s50 offen offset:0 sc1
    buffer_store_dwordx4 v[64:67], v209, s[40:43], s50 offen offset:1024 sc1
    v_pk_mul_f32 v[152:153], v[152:153], v[214:215]
    v_pk_mul_f32 v[154:155], v[154:155], v[214:215]
    v_pk_mul_f32 v[156:157], v[156:157], v[214:215]
    v_pk_mul_f32 v[158:159], v[158:159], v[214:215]
    v_pk_mul_f32 v[160:161], v[160:161], v[214:215]
    v_pk_mul_f32 v[162:163], v[162:163], v[214:215]
    v_pk_mul_f32 v[164:165], v[164:165], v[214:215]
    v_pk_mul_f32 v[166:167], v[166:167], v[214:215]
    v_cvt_pk_bf16_f32 v68, v152, v153
    v_cvt_pk_bf16_f32 v69, v154, v155
    v_cvt_pk_bf16_f32 v70, v156, v157
    v_cvt_pk_bf16_f32 v71, v158, v159
    v_cvt_pk_bf16_f32 v72, v160, v161
    v_cvt_pk_bf16_f32 v73, v162, v163
    v_cvt_pk_bf16_f32 v74, v164, v165
    v_cvt_pk_bf16_f32 v75, v166, v167
    v_cndmask_b32 v74, 0, v74, vcc
    v_cndmask_b32 v75, 0, v75, vcc
    buffer_store_dwordx4 v[68:71], v209, s[40:43], s51 offen offset:0 sc1
    buffer_store_dwordx4 v[72:75], v209, s[40:43], s51 offen offset:1024 sc1
    v_pk_mul_f32 v[168:169], v[168:169], v[216:217]
    v_pk_mul_f32 v[170:171], v[170:171], v[216:217]
    v_pk_mul_f32 v[172:173], v[172:173], v[216:217]
    v_pk_mul_f32 v[174:175], v[174:175], v[216:217]
    v_pk_mul_f32 v[176:177], v[176:177], v[216:217]
    v_pk_mul_f32 v[178:179], v[178:179], v[216:217]
    v_pk_mul_f32 v[180:181], v[180:181], v[216:217]
    v_pk_mul_f32 v[182:183], v[182:183], v[216:217]
    v_cvt_pk_bf16_f32 v76, v168, v169
    v_cvt_pk_bf16_f32 v77, v170, v171
    v_cvt_pk_bf16_f32 v78, v172, v173
    v_cvt_pk_bf16_f32 v79, v174, v175
    v_cvt_pk_bf16_f32 v80, v176, v177
    v_cvt_pk_bf16_f32 v81, v178, v179
    v_cvt_pk_bf16_f32 v82, v180, v181
    v_cvt_pk_bf16_f32 v83, v182, v183
    v_cndmask_b32 v82, 0, v82, vcc
    v_cndmask_b32 v83, 0, v83, vcc
    buffer_store_dwordx4 v[76:79], v209, s[40:43], s52 offen offset:0 sc1
    buffer_store_dwordx4 v[80:83], v209, s[40:43], s52 offen offset:1024 sc1
    v_pk_mul_f32 v[184:185], v[184:185], v[216:217]
    v_pk_mul_f32 v[186:187], v[186:187], v[216:217]
    v_pk_mul_f32 v[188:189], v[188:189], v[216:217]
    v_pk_mul_f32 v[190:191], v[190:191], v[216:217]
    v_pk_mul_f32 v[192:193], v[192:193], v[216:217]
    v_pk_mul_f32 v[194:195], v[194:195], v[216:217]
    v_pk_mul_f32 v[196:197], v[196:197], v[216:217]
    v_pk_mul_f32 v[198:199], v[198:199], v[216:217]
    v_cvt_pk_bf16_f32 v84, v184, v185
    v_cvt_pk_bf16_f32 v85, v186, v187
    v_cvt_pk_bf16_f32 v86, v188, v189
    v_cvt_pk_bf16_f32 v87, v190, v191
    v_cvt_pk_bf16_f32 v88, v192, v193
    v_cvt_pk_bf16_f32 v89, v194, v195
    v_cvt_pk_bf16_f32 v90, v196, v197
    v_cvt_pk_bf16_f32 v91, v198, v199
    v_cndmask_b32 v90, 0, v90, vcc
    v_cndmask_b32 v91, 0, v91, vcc
    buffer_store_dwordx4 v[84:87], v209, s[40:43], s53 offen offset:0 sc1
    buffer_store_dwordx4 v[88:91], v209, s[40:43], s53 offen offset:1024 sc1
    s_branch L_p1e_6
L_p1v_5:
    s_waitcnt lgkmcnt(0)
    s_barrier
    v_mfma_f32_32x32x16_bf16 v[136:151], v[60:63], v[68:71], 0
    ds_read_b128 v[92:95], v202 offset:0
    ds_read_b64_tr_b16 v[100:101], v204 offset:14336
    v_mfma_f32_32x32x16_bf16 v[152:167], v[60:63], v[72:75], 0
    ds_read_b64_tr_b16 v[102:103], v204 offset:16128
    ds_read_b128 v[96:99], v202 offset:28672
    v_mfma_f32_32x32x16_bf16 v[168:183], v[64:67], v[68:71], 0
    ds_read_b64_tr_b16 v[104:105], v204 offset:14392
    ds_read_b64_tr_b16 v[106:107], v204 offset:16184
    v_mfma_f32_32x32x16_bf16 v[184:199], v[64:67], v[72:75], 0
    ds_read_b128 v[108:111], v203 offset:0
    ds_read_b64_tr_b16 v[116:117], v204 offset:21504
    v_mfma_f32_32x32x16_bf16 v[136:151], v[76:79], v[84:87], v[136:151]
    ds_read_b64_tr_b16 v[118:119], v204 offset:23296
    ds_read_b128 v[112:115], v203 offset:28672
    v_mfma_f32_32x32x16_bf16 v[152:167], v[76:79], v[88:91], v[152:167]
    ds_read_b64_tr_b16 v[120:121], v204 offset:21560
    ds_read_b64_tr_b16 v[122:123], v204 offset:23352
    v_mfma_f32_32x32x16_bf16 v[168:183], v[80:83], v[84:87], v[168:183]
    v_mfma_f32_32x32x16_bf16 v[184:199], v[80:83], v[88:91], v[184:199]
    s_waitcnt lgkmcnt(0)
    s_barrier
    v_mfma_f32_32x32x16_bf16 v[136:151], v[92:95], v[100:103], v[136:151]
    ds_read_b128 v[60:63], v200 offset:128
    ds_read_b64_tr_b16 v[68:69], v204 offset:28672
    v_mfma_f32_32x32x16_bf16 v[152:167], v[92:95], v[104:107], v[152:167]
    ds_read_b64_tr_b16 v[70:71], v204 offset:30464
    ds_read_b128 v[64:67], v200 offset:28800
    v_mfma_f32_32x32x16_bf16 v[168:183], v[96:99], v[100:103], v[168:183]
    ds_read_b64_tr_b16 v[72:73], v204 offset:28728
    ds_read_b64_tr_b16 v[74:75], v204 offset:30520
    v_mfma_f32_32x32x16_bf16 v[184:199], v[96:99], v[104:107], v[184:199]
    ds_read_b128 v[76:79], v201 offset:128
    ds_read_b64_tr_b16 v[84:85], v204 offset:35840
    v_mfma_f32_32x32x16_bf16 v[136:151], v[108:111], v[116:119], v[136:151]
    ds_read_b64_tr_b16 v[86:87], v204 offset:37632
    ds_read_b128 v[80:83], v201 offset:28800
    v_mfma_f32_32x32x16_bf16 v[152:167], v[108:111], v[120:123], v[152:167]
    ds_read_b64_tr_b16 v[88:89], v204 offset:35896
    ds_read_b64_tr_b16 v[90:91], v204 offset:37688
    v_mfma_f32_32x32x16_bf16 v[168:183], v[112:115], v[116:119], v[168:183]
    v_mfma_f32_32x32x16_bf16 v[184:199], v[112:115], v[120:123], v[184:199]
    s_waitcnt lgkmcnt(0)
    s_barrier
    v_mfma_f32_32x32x16_bf16 v[136:151], v[60:63], v[68:71], v[136:151]
    ds_read_b128 v[92:95], v202 offset:128
    ds_read_b64_tr_b16 v[100:101], v204 offset:43008
    v_mfma_f32_32x32x16_bf16 v[152:167], v[60:63], v[72:75], v[152:167]
    ds_read_b64_tr_b16 v[102:103], v204 offset:44800
    ds_read_b128 v[96:99], v202 offset:28800
    v_mfma_f32_32x32x16_bf16 v[168:183], v[64:67], v[68:71], v[168:183]
    ds_read_b64_tr_b16 v[104:105], v204 offset:43064
    ds_read_b64_tr_b16 v[106:107], v204 offset:44856
    v_mfma_f32_32x32x16_bf16 v[184:199], v[64:67], v[72:75], v[184:199]
    ds_read_b128 v[108:111], v203 offset:128
    ds_read_b64_tr_b16 v[116:117], v204 offset:50176
    v_mfma_f32_32x32x16_bf16 v[136:151], v[76:79], v[84:87], v[136:151]
    ds_read_b64_tr_b16 v[118:119], v204 offset:51968
    ds_read_b128 v[112:115], v203 offset:28800
    v_mfma_f32_32x32x16_bf16 v[152:167], v[76:79], v[88:91], v[152:167]
    ds_read_b64_tr_b16 v[120:121], v204 offset:50232
    ds_read_b64_tr_b16 v[122:123], v204 offset:52024
    v_mfma_f32_32x32x16_bf16 v[168:183], v[80:83], v[84:87], v[168:183]
    v_mfma_f32_32x32x16_bf16 v[184:199], v[80:83], v[88:91], v[184:199]
    s_waitcnt lgkmcnt(0)
    s_barrier
    v_mfma_f32_32x32x16_bf16 v[136:151], v[92:95], v[100:103], v[136:151]
    ds_read_b128 v[60:63], v200 offset:256
    ds_read_b64_tr_b16 v[68:69], v205 offset:0
    v_mfma_f32_32x32x16_bf16 v[152:167], v[92:95], v[104:107], v[152:167]
    ds_read_b64_tr_b16 v[70:71], v205 offset:1792
    ds_read_b128 v[64:67], v200 offset:28928
    v_mfma_f32_32x32x16_bf16 v[168:183], v[96:99], v[100:103], v[168:183]
    ds_read_b64_tr_b16 v[72:73], v205 offset:56
    ds_read_b64_tr_b16 v[74:75], v205 offset:1848
    v_mfma_f32_32x32x16_bf16 v[184:199], v[96:99], v[104:107], v[184:199]
    ds_read_b128 v[76:79], v201 offset:256
    ds_read_b64_tr_b16 v[84:85], v205 offset:7168
    v_mfma_f32_32x32x16_bf16 v[136:151], v[108:111], v[116:119], v[136:151]
    ds_read_b64_tr_b16 v[86:87], v205 offset:8960
    ds_read_b128 v[80:83], v201 offset:28928
    v_mfma_f32_32x32x16_bf16 v[152:167], v[108:111], v[120:123], v[152:167]
    ds_read_b64_tr_b16 v[88:89], v205 offset:7224
    ds_read_b64_tr_b16 v[90:91], v205 offset:9016
    v_mfma_f32_32x32x16_bf16 v[168:183], v[112:115], v[116:119], v[168:183]
    v_mfma_f32_32x32x16_bf16 v[184:199], v[112:115], v[120:123], v[184:199]
    s_waitcnt lgkmcnt(0)
    s_barrier
    v_mfma_f32_32x32x16_bf16 v[136:151], v[60:63], v[68:71], v[136:151]
    ds_read_b128 v[92:95], v202 offset:256
    ds_read_b64_tr_b16 v[100:101], v205 offset:14336
    v_mfma_f32_32x32x16_bf16 v[152:167], v[60:63], v[72:75], v[152:167]
    ds_read_b64_tr_b16 v[102:103], v205 offset:16128
    ds_read_b128 v[96:99], v202 offset:28928
    v_mfma_f32_32x32x16_bf16 v[168:183], v[64:67], v[68:71], v[168:183]
    ds_read_b64_tr_b16 v[104:105], v205 offset:14392
    ds_read_b64_tr_b16 v[106:107], v205 offset:16184
    v_mfma_f32_32x32x16_bf16 v[184:199], v[64:67], v[72:75], v[184:199]
    ds_read_b128 v[108:111], v203 offset:256
    ds_read_b64_tr_b16 v[116:117], v205 offset:21504
    v_mfma_f32_32x32x16_bf16 v[136:151], v[76:79], v[84:87], v[136:151]
    ds_read_b64_tr_b16 v[118:119], v205 offset:23296
    ds_read_b128 v[112:115], v203 offset:28928
    v_mfma_f32_32x32x16_bf16 v[152:167], v[76:79], v[88:91], v[152:167]
    ds_read_b64_tr_b16 v[120:121], v205 offset:21560
    ds_read_b64_tr_b16 v[122:123], v205 offset:23352
    v_mfma_f32_32x32x16_bf16 v[168:183], v[80:83], v[84:87], v[168:183]
    v_mfma_f32_32x32x16_bf16 v[184:199], v[80:83], v[88:91], v[184:199]
    s_waitcnt lgkmcnt(0)
    s_barrier
    v_mfma_f32_32x32x16_bf16 v[136:151], v[92:95], v[100:103], v[136:151]
    ds_read_b128 v[60:63], v200 offset:384
    ds_read_b64_tr_b16 v[68:69], v205 offset:28672
    v_mfma_f32_32x32x16_bf16 v[152:167], v[92:95], v[104:107], v[152:167]
    ds_read_b64_tr_b16 v[70:71], v205 offset:30464
    ds_read_b128 v[64:67], v200 offset:29056
    v_mfma_f32_32x32x16_bf16 v[168:183], v[96:99], v[100:103], v[168:183]
    ds_read_b64_tr_b16 v[72:73], v205 offset:28728
    ds_read_b64_tr_b16 v[74:75], v205 offset:30520
    v_mfma_f32_32x32x16_bf16 v[184:199], v[96:99], v[104:107], v[184:199]
    ds_read_b128 v[76:79], v201 offset:384
    ds_read_b64_tr_b16 v[84:85], v205 offset:35840
    v_mfma_f32_32x32x16_bf16 v[136:151], v[108:111], v[116:119], v[136:151]
    ds_read_b64_tr_b16 v[86:87], v205 offset:37632
    ds_read_b128 v[80:83], v201 offset:29056
    v_mfma_f32_32x32x16_bf16 v[152:167], v[108:111], v[120:123], v[152:167]
    ds_read_b64_tr_b16 v[88:89], v205 offset:35896
    ds_read_b64_tr_b16 v[90:91], v205 offset:37688
    v_mfma_f32_32x32x16_bf16 v[168:183], v[112:115], v[116:119], v[168:183]
    v_mfma_f32_32x32x16_bf16 v[184:199], v[112:115], v[120:123], v[184:199]
    s_waitcnt lgkmcnt(0)
    s_barrier
    v_mfma_f32_32x32x16_bf16 v[136:151], v[60:63], v[68:71], v[136:151]
    ds_read_b128 v[92:95], v202 offset:384
    ds_read_b64_tr_b16 v[100:101], v204 offset:0
    v_mfma_f32_32x32x16_bf16 v[152:167], v[60:63], v[72:75], v[152:167]
    ds_read_b64_tr_b16 v[102:103], v204 offset:1792
    ds_read_b128 v[96:99], v202 offset:29056
    v_mfma_f32_32x32x16_bf16 v[168:183], v[64:67], v[68:71], v[168:183]
    ds_read_b64_tr_b16 v[104:105], v204 offset:56
    ds_read_b64_tr_b16 v[106:107], v204 offset:1848
    v_mfma_f32_32x32x16_bf16 v[184:199], v[64:67], v[72:75], v[184:199]
    ds_read_b128 v[108:111], v203 offset:384
    ds_read_b64_tr_b16 v[116:117], v204 offset:7168
    v_mfma_f32_32x32x16_bf16 v[136:151], v[76:79], v[84:87], v[136:151]
    ds_read_b64_tr_b16 v[118:119], v204 offset:8960
    ds_read_b128 v[112:115], v203 offset:29056
    v_mfma_f32_32x32x16_bf16 v[152:167], v[76:79], v[88:91], v[152:167]
    ds_read_b64_tr_b16 v[120:121], v204 offset:7224
    ds_read_b64_tr_b16 v[122:123], v204 offset:9016
    v_mfma_f32_32x32x16_bf16 v[168:183], v[80:83], v[84:87], v[168:183]
    v_mfma_f32_32x32x16_bf16 v[184:199], v[80:83], v[88:91], v[184:199]
    s_waitcnt lgkmcnt(0)
    s_barrier
    v_mfma_f32_32x32x16_bf16 v[136:151], v[92:95], v[100:103], v[136:151]
    ds_read_b128 v[60:63], v200 offset:512
    ds_read_b64_tr_b16 v[68:69], v204 offset:14336
    v_mfma_f32_32x32x16_bf16 v[152:167], v[92:95], v[104:107], v[152:167]
    ds_read_b64_tr_b16 v[70:71], v204 offset:16128
    ds_read_b128 v[64:67], v200 offset:29184
    v_mfma_f32_32x32x16_bf16 v[168:183], v[96:99], v[100:103], v[168:183]
    ds_read_b64_tr_b16 v[72:73], v204 offset:14392
    ds_read_b64_tr_b16 v[74:75], v204 offset:16184
    v_mfma_f32_32x32x16_bf16 v[184:199], v[96:99], v[104:107], v[184:199]
    ds_read_b128 v[76:79], v201 offset:512
    ds_read_b64_tr_b16 v[84:85], v204 offset:21504
    v_mfma_f32_32x32x16_bf16 v[136:151], v[108:111], v[116:119], v[136:151]
    ds_read_b64_tr_b16 v[86:87], v204 offset:23296
    ds_read_b128 v[80:83], v201 offset:29184
    v_mfma_f32_32x32x16_bf16 v[152:167], v[108:111], v[120:123], v[152:167]
    ds_read_b64_tr_b16 v[88:89], v204 offset:21560
    ds_read_b64_tr_b16 v[90:91], v204 offset:23352
    v_mfma_f32_32x32x16_bf16 v[168:183], v[112:115], v[116:119], v[168:183]
    v_mfma_f32_32x32x16_bf16 v[184:199], v[112:115], v[120:123], v[184:199]
    s_waitcnt lgkmcnt(0)
    s_barrier
    v_mfma_f32_32x32x16_bf16 v[136:151], v[60:63], v[68:71], v[136:151]
    ds_read_b128 v[92:95], v202 offset:512
    ds_read_b64_tr_b16 v[100:101], v204 offset:28672
    v_mfma_f32_32x32x16_bf16 v[152:167], v[60:63], v[72:75], v[152:167]
    ds_read_b64_tr_b16 v[102:103], v204 offset:30464
    ds_read_b128 v[96:99], v202 offset:29184
    v_mfma_f32_32x32x16_bf16 v[168:183], v[64:67], v[68:71], v[168:183]
    ds_read_b64_tr_b16 v[104:105], v204 offset:28728
    ds_read_b64_tr_b16 v[106:107], v204 offset:30520
    v_mfma_f32_32x32x16_bf16 v[184:199], v[64:67], v[72:75], v[184:199]
    ds_read_b128 v[108:111], v203 offset:512
    ds_read_b64_tr_b16 v[116:117], v204 offset:35840
    v_mfma_f32_32x32x16_bf16 v[136:151], v[76:79], v[84:87], v[136:151]
    ds_read_b64_tr_b16 v[118:119], v204 offset:37632
    ds_read_b128 v[112:115], v203 offset:29184
    v_mfma_f32_32x32x16_bf16 v[152:167], v[76:79], v[88:91], v[152:167]
    ds_read_b64_tr_b16 v[120:121], v204 offset:35896
    ds_read_b64_tr_b16 v[122:123], v204 offset:37688
    v_mfma_f32_32x32x16_bf16 v[168:183], v[80:83], v[84:87], v[168:183]
    v_mfma_f32_32x32x16_bf16 v[184:199], v[80:83], v[88:91], v[184:199]
    s_waitcnt lgkmcnt(0)
    ds_add_u32 v206, v207
    v_mfma_f32_32x32x16_bf16 v[136:151], v[92:95], v[100:103], v[136:151]
    ds_read_b128 v[60:63], v200 offset:640
    ds_read_b64_tr_b16 v[68:69], v204 offset:43008
    v_mfma_f32_32x32x16_bf16 v[152:167], v[92:95], v[104:107], v[152:167]
    ds_read_b64_tr_b16 v[70:71], v204 offset:44800
    ds_read_b128 v[64:67], v200 offset:29312
    v_mfma_f32_32x32x16_bf16 v[168:183], v[96:99], v[100:103], v[168:183]
    ds_read_b64_tr_b16 v[72:73], v204 offset:43064
    ds_read_b64_tr_b16 v[74:75], v204 offset:44856
    v_mfma_f32_32x32x16_bf16 v[184:199], v[96:99], v[104:107], v[184:199]
    ds_read_b128 v[76:79], v201 offset:640
    ds_read_b64_tr_b16 v[84:85], v204 offset:50176
    v_mfma_f32_32x32x16_bf16 v[136:151], v[108:111], v[116:119], v[136:151]
    ds_read_b64_tr_b16 v[86:87], v204 offset:51968
    ds_read_b128 v[80:83], v201 offset:29312
    v_mfma_f32_32x32x16_bf16 v[152:167], v[108:111], v[120:123], v[152:167]
    ds_read_b64_tr_b16 v[88:89], v204 offset:50232
    ds_read_b64_tr_b16 v[90:91], v204 offset:52024
    v_mfma_f32_32x32x16_bf16 v[168:183], v[112:115], v[116:119], v[168:183]
    v_mfma_f32_32x32x16_bf16 v[184:199], v[112:115], v[120:123], v[184:199]
    s_waitcnt lgkmcnt(0)
    ds_add_u32 v206, v207
    v_mfma_f32_32x32x16_bf16 v[136:151], v[60:63], v[68:71], v[136:151]
    ds_read_b128 v[92:95], v202 offset:640
    ds_read_b64_tr_b16 v[100:101], v205 offset:0
    v_mfma_f32_32x32x16_bf16 v[152:167], v[60:63], v[72:75], v[152:167]
    ds_read_b64_tr_b16 v[102:103], v205 offset:1792
    ds_read_b128 v[96:99], v202 offset:29312
    v_mfma_f32_32x32x16_bf16 v[168:183], v[64:67], v[68:71], v[168:183]
    ds_read_b64_tr_b16 v[104:105], v205 offset:56
    ds_read_b64_tr_b16 v[106:107], v205 offset:1848
    v_mfma_f32_32x32x16_bf16 v[184:199], v[64:67], v[72:75], v[184:199]
    ds_read_b128 v[108:111], v203 offset:640
    ds_read_b64_tr_b16 v[116:117], v205 offset:7168
    v_mfma_f32_32x32x16_bf16 v[136:151], v[76:79], v[84:87], v[136:151]
    ds_read_b64_tr_b16 v[118:119], v205 offset:8960
    ds_read_b128 v[112:115], v203 offset:29312
    v_mfma_f32_32x32x16_bf16 v[152:167], v[76:79], v[88:91], v[152:167]
    ds_read_b64_tr_b16 v[120:121], v205 offset:7224
    ds_read_b64_tr_b16 v[122:123], v205 offset:9016
    v_mfma_f32_32x32x16_bf16 v[168:183], v[80:83], v[84:87], v[168:183]
    v_mfma_f32_32x32x16_bf16 v[184:199], v[80:83], v[88:91], v[184:199]
    s_waitcnt lgkmcnt(0)
    ds_add_u32 v206, v207
    v_mfma_f32_32x32x16_bf16 v[136:151], v[92:95], v[100:103], v[136:151]
    ds_read_b128 v[60:63], v200 offset:768
    ds_read_b64_tr_b16 v[68:69], v205 offset:14336
    v_mfma_f32_32x32x16_bf16 v[152:167], v[92:95], v[104:107], v[152:167]
    ds_read_b64_tr_b16 v[70:71], v205 offset:16128
    ds_read_b128 v[64:67], v200 offset:29440
    v_mfma_f32_32x32x16_bf16 v[168:183], v[96:99], v[100:103], v[168:183]
    ds_read_b64_tr_b16 v[72:73], v205 offset:14392
    ds_read_b64_tr_b16 v[74:75], v205 offset:16184
    v_mfma_f32_32x32x16_bf16 v[184:199], v[96:99], v[104:107], v[184:199]
    ds_read_b128 v[76:79], v201 offset:768
    ds_read_b64_tr_b16 v[84:85], v205 offset:21504
    v_mfma_f32_32x32x16_bf16 v[136:151], v[108:111], v[116:119], v[136:151]
    ds_read_b64_tr_b16 v[86:87], v205 offset:23296
    ds_read_b128 v[80:83], v201 offset:29440
    v_mfma_f32_32x32x16_bf16 v[152:167], v[108:111], v[120:123], v[152:167]
    ds_read_b64_tr_b16 v[88:89], v205 offset:21560
    ds_read_b64_tr_b16 v[90:91], v205 offset:23352
    v_mfma_f32_32x32x16_bf16 v[168:183], v[112:115], v[116:119], v[168:183]
    v_mfma_f32_32x32x16_bf16 v[184:199], v[112:115], v[120:123], v[184:199]
    s_waitcnt lgkmcnt(0)
    ds_add_u32 v206, v207
    v_mfma_f32_32x32x16_bf16 v[136:151], v[60:63], v[68:71], v[136:151]
    ds_read_b128 v[92:95], v202 offset:768
    ds_read_b64_tr_b16 v[100:101], v205 offset:28672
    v_mfma_f32_32x32x16_bf16 v[152:167], v[60:63], v[72:75], v[152:167]
    ds_read_b64_tr_b16 v[102:103], v205 offset:30464
    ds_read_b128 v[96:99], v202 offset:29440
    v_mfma_f32_32x32x16_bf16 v[168:183], v[64:67], v[68:71], v[168:183]
    ds_read_b64_tr_b16 v[104:105], v205 offset:28728
    ds_read_b64_tr_b16 v[106:107], v205 offset:30520
    v_mfma_f32_32x32x16_bf16 v[184:199], v[64:67], v[72:75], v[184:199]
    ds_read_b128 v[108:111], v203 offset:768
    ds_read_b64_tr_b16 v[116:117], v205 offset:35840
    v_mfma_f32_32x32x16_bf16 v[136:151], v[76:79], v[84:87], v[136:151]
    ds_read_b64_tr_b16 v[118:119], v205 offset:37632
    ds_read_b128 v[112:115], v203 offset:29440
    v_mfma_f32_32x32x16_bf16 v[152:167], v[76:79], v[88:91], v[152:167]
    ds_read_b64_tr_b16 v[120:121], v205 offset:35896
    ds_read_b64_tr_b16 v[122:123], v205 offset:37688
    v_mfma_f32_32x32x16_bf16 v[168:183], v[80:83], v[84:87], v[168:183]
    v_mfma_f32_32x32x16_bf16 v[184:199], v[80:83], v[88:91], v[184:199]
    s_waitcnt lgkmcnt(0)
    ds_add_u32 v206, v207
    v_mfma_f32_32x32x16_bf16 v[136:151], v[92:95], v[100:103], v[136:151]
    v_mfma_f32_32x32x16_bf16 v[152:167], v[92:95], v[104:107], v[152:167]
    v_mfma_f32_32x32x16_bf16 v[168:183], v[96:99], v[100:103], v[168:183]
    v_mfma_f32_32x32x16_bf16 v[184:199], v[96:99], v[104:107], v[184:199]
    v_mfma_f32_32x32x16_bf16 v[136:151], v[108:111], v[116:119], v[136:151]
    v_mfma_f32_32x32x16_bf16 v[152:167], v[108:111], v[120:123], v[152:167]
    v_mfma_f32_32x32x16_bf16 v[168:183], v[112:115], v[116:119], v[168:183]
    v_mfma_f32_32x32x16_bf16 v[184:199], v[112:115], v[120:123], v[184:199]
    v_lshrrev_b32 v206, 5, v1
    v_lshlrev_b32 v206, 4, v206
    v_add_u32 v206, 157696, v206
    ds_read_b128 v[92:95], v206 offset:0
    ds_read_b128 v[96:99], v206 offset:32
    ds_read_b128 v[100:103], v206 offset:64
    ds_read_b128 v[104:107], v206 offset:96
    ds_read_b128 v[108:111], v206 offset:128
    ds_read_b128 v[112:115], v206 offset:160
    ds_read_b128 v[116:119], v206 offset:192
    ds_read_b128 v[120:123], v206 offset:224
    s_mov_b32 s55, 4096
    s_mov_b32 s56, 0x240800
    s_and_b32 s48, s69, 1
    s_lshl_b32 s48, s48, 2
    s_add_u32 s48, s48, s44
    s_lshl_b32 s48, s48, 6
    s_add_u32 s48, s48, s68
    s_lshl_b32 s48, s48, 1
    s_mul_i32 s48, s48, s55
    s_add_u32 s50, s48, s56
    s_lshl_b32 s48, s55, 6
    s_add_u32 s51, s50, s48
    s_add_u32 s52, s50, s55
    s_add_u32 s53, s51, s55
    v_lshlrev_b32 v209, 4, v1
    v_and_b32 v206, 31, v1
    v_mov_b32 v207, 0x3f803f80
    v_cmp_eq_u32 vcc, 28, v206
    s_nop 1
    v_cndmask_b32 v207, 0, v207, vcc
    v_cmp_gt_u32 vcc, 28, v206
    s_waitcnt lgkmcnt(0)
    v_pk_mul_f32 v[136:137], v[136:137], v[92:93]
    v_pk_mul_f32 v[138:139], v[138:139], v[94:95]
    v_pk_mul_f32 v[140:141], v[140:141], v[96:97]
    v_pk_mul_f32 v[142:143], v[142:143], v[98:99]
    v_pk_mul_f32 v[144:145], v[144:145], v[100:101]
    v_pk_mul_f32 v[146:147], v[146:147], v[102:103]
    v_pk_mul_f32 v[148:149], v[148:149], v[104:105]
    v_pk_mul_f32 v[150:151], v[150:151], v[106:107]
    v_cvt_pk_bf16_f32 v60, v136, v137
    v_cvt_pk_bf16_f32 v61, v138, v139
    v_cvt_pk_bf16_f32 v62, v140, v141
    v_cvt_pk_bf16_f32 v63, v142, v143
    v_cvt_pk_bf16_f32 v64, v144, v145
    v_cvt_pk_bf16_f32 v65, v146, v147
    v_cvt_pk_bf16_f32 v66, v148, v149
    v_cvt_pk_bf16_f32 v67, v150, v151
    v_cndmask_b32 v60, v207, v60, vcc
    v_cndmask_b32 v61, v207, v61, vcc
    v_cndmask_b32 v62, v207, v62, vcc
    v_cndmask_b32 v63, v207, v63, vcc
    v_cndmask_b32 v64, v207, v64, vcc
    v_cndmask_b32 v65, v207, v65, vcc
    v_cndmask_b32 v66, v207, v66, vcc
    v_cndmask_b32 v67, v207, v67, vcc
    buffer_store_dwordx4 v[60:63], v209, s[40:43], s50 offen offset:0 sc1
    buffer_store_dwordx4 v[64:67], v209, s[40:43], s50 offen offset:1024 sc1
    v_pk_mul_f32 v[152:153], v[152:153], v[92:93]
    v_pk_mul_f32 v[154:155], v[154:155], v[94:95]
    v_pk_mul_f32 v[156:157], v[156:157], v[96:97]
    v_pk_mul_f32 v[158:159], v[158:159], v[98:99]
    v_pk_mul_f32 v[160:161], v[160:161], v[100:101]
    v_pk_mul_f32 v[162:163], v[162:163], v[102:103]
    v_pk_mul_f32 v[164:165], v[164:165], v[104:105]
    v_pk_mul_f32 v[166:167], v[166:167], v[106:107]
    v_cvt_pk_bf16_f32 v68, v152, v153
    v_cvt_pk_bf16_f32 v69, v154, v155
    v_cvt_pk_bf16_f32 v70, v156, v157
    v_cvt_pk_bf16_f32 v71, v158, v159
    v_cvt_pk_bf16_f32 v72, v160, v161
    v_cvt_pk_bf16_f32 v73, v162, v163
    v_cvt_pk_bf16_f32 v74, v164, v165
    v_cvt_pk_bf16_f32 v75, v166, v167
    v_cndmask_b32 v68, v207, v68, vcc
    v_cndmask_b32 v69, v207, v69, vcc
    v_cndmask_b32 v70, v207, v70, vcc
    v_cndmask_b32 v71, v207, v71, vcc
    v_cndmask_b32 v72, v207, v72, vcc
    v_cndmask_b32 v73, v207, v73, vcc
    v_cndmask_b32 v74, v207, v74, vcc
    v_cndmask_b32 v75, v207, v75, vcc
    buffer_store_dwordx4 v[68:71], v209, s[40:43], s51 offen offset:0 sc1
    buffer_store_dwordx4 v[72:75], v209, s[40:43], s51 offen offset:1024 sc1
    v_pk_mul_f32 v[168:169], v[168:169], v[108:109]
    v_pk_mul_f32 v[170:171], v[170:171], v[110:111]
    v_pk_mul_f32 v[172:173], v[172:173], v[112:113]
    v_pk_mul_f32 v[174:175], v[174:175], v[114:115]
    v_pk_mul_f32 v[176:177], v[176:177], v[116:117]
    v_pk_mul_f32 v[178:179], v[178:179], v[118:119]
    v_pk_mul_f32 v[180:181], v[180:181], v[120:121]
    v_pk_mul_f32 v[182:183], v[182:183], v[122:123]
    v_cvt_pk_bf16_f32 v76, v168, v169
    v_cvt_pk_bf16_f32 v77, v170, v171
    v_cvt_pk_bf16_f32 v78, v172, v173
    v_cvt_pk_bf16_f32 v79, v174, v175
    v_cvt_pk_bf16_f32 v80, v176, v177
    v_cvt_pk_bf16_f32 v81, v178, v179
    v_cvt_pk_bf16_f32 v82, v180, v181
    v_cvt_pk_bf16_f32 v83, v182, v183
    v_cndmask_b32 v76, v207, v76, vcc
    v_cndmask_b32 v77, v207, v77, vcc
    v_cndmask_b32 v78, v207, v78, vcc
    v_cndmask_b32 v79, v207, v79, vcc
    v_cndmask_b32 v80, v207, v80, vcc
    v_cndmask_b32 v81, v207, v81, vcc
    v_cndmask_b32 v82, v207, v82, vcc
    v_cndmask_b32 v83, v207, v83, vcc
    buffer_store_dwordx4 v[76:79], v209, s[40:43], s52 offen offset:0 sc1
    buffer_store_dwordx4 v[80:83], v209, s[40:43], s52 offen offset:1024 sc1
    v_pk_mul_f32 v[184:185], v[184:185], v[108:109]
    v_pk_mul_f32 v[186:187], v[186:187], v[110:111]
    v_pk_mul_f32 v[188:189], v[188:189], v[112:113]
    v_pk_mul_f32 v[190:191], v[190:191], v[114:115]
    v_pk_mul_f32 v[192:193], v[192:193], v[116:117]
    v_pk_mul_f32 v[194:195], v[194:195], v[118:119]
    v_pk_mul_f32 v[196:197], v[196:197], v[120:121]
    v_pk_mul_f32 v[198:199], v[198:199], v[122:123]
    v_cvt_pk_bf16_f32 v84, v184, v185
    v_cvt_pk_bf16_f32 v85, v186, v187
    v_cvt_pk_bf16_f32 v86, v188, v189
    v_cvt_pk_bf16_f32 v87, v190, v191
    v_cvt_pk_bf16_f32 v88, v192, v193
    v_cvt_pk_bf16_f32 v89, v194, v195
    v_cvt_pk_bf16_f32 v90, v196, v197
    v_cvt_pk_bf16_f32 v91, v198, v199
    v_cndmask_b32 v84, v207, v84, vcc
    v_cndmask_b32 v85, v207, v85, vcc
    v_cndmask_b32 v86, v207, v86, vcc
    v_cndmask_b32 v87, v207, v87, vcc
    v_cndmask_b32 v88, v207, v88, vcc
    v_cndmask_b32 v89, v207, v89, vcc
    v_cndmask_b32 v90, v207, v90, vcc
    v_cndmask_b32 v91, v207, v91, vcc
    buffer_store_dwordx4 v[84:87], v209, s[40:43], s53 offen offset:0 sc1
    buffer_store_dwordx4 v[88:91], v209, s[40:43], s53 offen offset:1024 sc1
L_p1e_6:
    v_mov_b32 v206, 163628
    v_mov_b32 v207, 1
    s_mov_b64 exec, 1
    ds_add_u32 v206, v207
    s_mov_b64 exec, -1
    s_setprio 0
    s_mul_i32 s101, s68, 6
    s_add_u32 s101, s101, s69
    s_waitcnt vmcnt(0)
    s_mov_b32 s80, 0
    s_branch L_tagf_9
L_tag_7:
    v_mov_b32 v222, 0
    buffer_load_dwordx2 v[220:221], v222, s[36:39], 0 offen sc1
    s_add_u32 s80, s80, 1
    s_cmp_ge_u32 s80, 0x100000
    s_waitcnt vmcnt(0)
    s_cbranch_scc1 L_tage_8
L_tagf_9:
    v_readfirstlane_b32 s64, v220
    v_readfirstlane_b32 s65, v221
    s_cmp_eq_u32 s64, 0
    s_cbranch_scc1 L_tag_7
L_tage_8:
    v_mov_b32 v4, 163624
    v_mov_b32 v5, 1
    s_mov_b64 exec, 1
    ds_add_rtn_u32 v5, v4, v5
    s_mov_b64 exec, -1
    s_waitcnt lgkmcnt(0)
    v_readfirstlane_b32 s48, v5
    s_cmp_lg_u32 s48, 3
    s_cbranch_scc1 L_nsig_10
    s_lshl_b32 s101, s101, 7
    v_lshl_add_u32 v8, v1, 4, s101
    v_mov_b32 v4, s64
    v_mov_b32 v5, s65
    v_mov_b32 v6, s64
    v_mov_b32 v7, s65
    s_mov_b64 exec, 0xff
    buffer_store_dwordx4 v[4:7], v8, s[40:43], 0 offen sc1
    s_mov_b64 exec, -1
L_nsig_10:
    v_mov_b32 v10, 163584
    v_mov_b32 v11, 1
    s_mov_b64 exec, 1
    ds_add_u32 v10, v11
    s_mov_b64 exec, -1
L_a:
    v_lshlrev_b32 v212, 4, v1
    s_lshr_b32 s48, s70, 3
    s_lshl_b32 s49, s44, 3
    v_and_b32 v213, 7, v1
    v_add_u32 v213, s49, v213
    v_lshrrev_b32 v214, 3, v1
    v_lshl_add_u32 v214, v214, 1, 2
    s_lshl_b32 s49, s71, 1
    v_and_b32 v215, 1, v1
    v_add_u32 v215, s49, v215
    v_cmp_gt_u32 vcc, 16, v1
    s_nop 0
    s_lshl_b32 s50, s70, 6
    v_cndmask_b32 v213, v215, v213, vcc
    v_cndmask_b32 v214, 0, v214, vcc
    v_mul_u32_u24 v213, 6, v213
    v_add3_u32 v213, v213, v214, s48
    v_lshlrev_b32 v213, 7, v213
    s_lshl_b32 s49, s44, 4
    s_add_u32 s49, s49, s50
    s_lshl_b32 s49, s49, 12
    s_add_u32 s77, s49, 0x240000
    s_lshl_b32 s49, s71, 2
    s_add_u32 s50, s50, s49
    s_xor_b32 s51, s44, 0
    s_add_u32 s51, s51, s50
    s_lshl_b32 s51, s51, 11
    s_add_u32 s51, s51, 0x40000
    s_xor_b32 s52, s44, 1
    s_add_u32 s52, s52, s50
    s_lshl_b32 s52, s52, 11
    s_add_u32 s52, s52, 0x40000
    s_xor_b32 s53, s44, 2
    s_add_u32 s53, s53, s50
    s_lshl_b32 s53, s53, 11
    s_add_u32 s53, s53, 0x40000
    s_xor_b32 s54, s44, 3
    s_add_u32 s54, s54, s50
    s_lshl_b32 s54, s54, 11
    s_add_u32 s54, s54, 0x40000
    v_mov_b32 v216, 163616
    s_mov_b32 s80, 0
L_ev_11:
    s_sleep 4
    ds_read_b32 v217, v216
    s_add_u32 s80, s80, 1
    s_waitcnt lgkmcnt(0)
    v_readfirstlane_b32 s48, v217
    s_cmp_ge_u32 s80, 0x400000
    s_cbranch_scc1 L_eve_12
    s_cmp_lt_u32 s48, 4
    s_cbranch_scc1 L_ev_11
L_eve_12:
    s_setprio 1
    s_mov_b64 exec, 0x3ffff
    s_mov_b32 s80, 0
    s_branch L_pollf_15
L_poll_13:
    s_sleep 2
L_pollf_15:
    buffer_load_dwordx2 v[214:215], v213, s[40:43], 0 offen sc1
    s_add_u32 s80, s80, 1
    s_cmp_ge_u32 s80, 0x100000
    s_waitcnt vmcnt(0)
    s_cbranch_scc1 L_polle_14
    v_cmp_ne_u64 vcc, s[64:65], v[214:215]
    s_cbranch_vccnz L_poll_13
L_polle_14:
    s_mov_b64 exec, -1
    buffer_load_dwordx4 v[12:15], v212, s[40:43], s52 offen offset:0 sc1
    buffer_load_dwordx4 v[16:19], v212, s[40:43], s52 offen offset:1024 sc1
    buffer_load_dwordx4 v[148:151], v212, s[40:43], s77 offen offset:0 sc1
    buffer_load_dwordx4 v[152:155], v212, s[40:43], s77 offen offset:1024 sc1
    buffer_load_dwordx4 v[20:23], v212, s[40:43], s53 offen offset:0 sc1
    buffer_load_dwordx4 v[24:27], v212, s[40:43], s53 offen offset:1024 sc1
    buffer_load_dwordx4 v[156:159], v212, s[40:43], s77 offen offset:2048 sc1
    buffer_load_dwordx4 v[160:163], v212, s[40:43], s77 offen offset:3072 sc1
    s_add_u32 s77, s77, 4096
    buffer_load_dwordx4 v[28:31], v212, s[40:43], s54 offen offset:0 sc1
    buffer_load_dwordx4 v[32:35], v212, s[40:43], s54 offen offset:1024 sc1
    buffer_load_dwordx4 v[4:7], v212, s[40:43], s51 offen offset:0 sc1
    buffer_load_dwordx4 v[8:11], v212, s[40:43], s51 offen offset:1024 sc1
    buffer_load_dwordx4 v[164:167], v212, s[40:43], s77 offen offset:0 sc1
    buffer_load_dwordx4 v[168:171], v212, s[40:43], s77 offen offset:1024 sc1
    buffer_load_dwordx4 v[172:175], v212, s[40:43], s77 offen offset:2048 sc1
    buffer_load_dwordx4 v[176:179], v212, s[40:43], s77 offen offset:3072 sc1
    s_add_u32 s77, s77, 4096
    buffer_load_dwordx4 v[180:183], v212, s[40:43], s77 offen offset:0 sc1
    buffer_load_dwordx4 v[184:187], v212, s[40:43], s77 offen offset:1024 sc1
    buffer_load_dwordx4 v[188:191], v212, s[40:43], s77 offen offset:2048 sc1
    buffer_load_dwordx4 v[192:195], v212, s[40:43], s77 offen offset:3072 sc1
    s_add_u32 s77, s77, 4096
    v_mov_b32 v213, 163604
    v_mov_b32 v214, 1
    s_mov_b64 exec, 1
    ds_add_u32 v213, v214
    s_mov_b64 exec, -1
    s_waitcnt vmcnt(16)
    v_mfma_f32_32x32x16_bf16 v[100:115], v[148:151], v[12:15], 0
    v_mfma_f32_32x32x16_bf16 v[100:115], v[152:155], v[16:19], v[100:115]
    s_xor_b32 s48, s44, 1
    s_mul_i32 s48, s48, 12288
    s_add_u32 s48, s48, 98304
    v_add_u32 v213, s48, v212
    s_xor_b32 s48, s44, 2
    s_mul_i32 s48, s48, 12288
    s_add_u32 s48, s48, 102400
    v_add_u32 v214, s48, v212
    s_xor_b32 s48, s44, 3
    s_mul_i32 s48, s48, 12288
    s_add_u32 s48, s48, 106496
    v_add_u32 v215, s48, v212
    v_mov_b32 v216, 163592
    s_waitcnt vmcnt(14)
    v_mfma_f32_32x32x16_bf16 v[116:131], v[148:151], v[20:23], 0
    v_exp_f32 v100, v100
    v_exp_f32 v101, v101
    v_exp_f32 v102, v102
    v_exp_f32 v103, v103
    v_cvt_pk_bf16_f32 v132, v100, v101
    v_cvt_pk_bf16_f32 v133, v102, v103
    v_mfma_f32_32x32x16_bf16 v[116:131], v[152:155], v[24:27], v[116:131]
    v_exp_f32 v104, v104
    v_exp_f32 v105, v105
    v_exp_f32 v106, v106
    v_exp_f32 v107, v107
    v_cvt_pk_bf16_f32 v134, v104, v105
    v_cvt_pk_bf16_f32 v135, v106, v107
    v_exp_f32 v108, v108
    v_exp_f32 v109, v109
    v_exp_f32 v110, v110
    v_exp_f32 v111, v111
    v_cvt_pk_bf16_f32 v136, v108, v109
    v_cvt_pk_bf16_f32 v137, v110, v111
    v_exp_f32 v112, v112
    v_exp_f32 v113, v113
    v_exp_f32 v114, v114
    v_exp_f32 v115, v115
    v_cvt_pk_bf16_f32 v138, v112, v113
    v_cvt_pk_bf16_f32 v139, v114, v115
    s_waitcnt vmcnt(10)
    v_mfma_f32_32x32x16_bf16 v[100:115], v[148:151], v[28:31], 0
    v_exp_f32 v116, v116
    v_exp_f32 v117, v117
    v_exp_f32 v118, v118
    v_exp_f32 v119, v119
    v_cvt_pk_bf16_f32 v140, v116, v117
    v_cvt_pk_bf16_f32 v141, v118, v119
    v_mfma_f32_32x32x16_bf16 v[100:115], v[152:155], v[32:35], v[100:115]
    v_exp_f32 v120, v120
    v_exp_f32 v121, v121
    v_exp_f32 v122, v122
    v_exp_f32 v123, v123
    v_cvt_pk_bf16_f32 v142, v120, v121
    v_cvt_pk_bf16_f32 v143, v122, v123
    v_mfma_f32_32x32x16_bf16 v[52:67], v[156:159], v[132:135], 0
    v_exp_f32 v124, v124
    v_exp_f32 v125, v125
    v_exp_f32 v126, v126
    v_exp_f32 v127, v127
    v_cvt_pk_bf16_f32 v144, v124, v125
    v_cvt_pk_bf16_f32 v145, v126, v127
    v_mfma_f32_32x32x16_bf16 v[52:67], v[160:163], v[136:139], v[52:67]
    buffer_load_dwordx4 v[196:199], v212, s[40:43], s77 offen offset:0 sc1
    v_exp_f32 v128, v128
    v_exp_f32 v129, v129
    v_exp_f32 v130, v130
    v_exp_f32 v131, v131
    v_cvt_pk_bf16_f32 v146, v128, v129
    v_cvt_pk_bf16_f32 v147, v130, v131
    s_waitcnt vmcnt(9)
    v_mfma_f32_32x32x16_bf16 v[116:131], v[148:151], v[4:7], 0
    v_exp_f32 v100, v100
    v_exp_f32 v101, v101
    v_exp_f32 v102, v102
    v_exp_f32 v103, v103
    v_cvt_pk_bf16_f32 v132, v100, v101
    v_cvt_pk_bf16_f32 v133, v102, v103
    v_mfma_f32_32x32x16_bf16 v[116:131], v[152:155], v[8:11], v[116:131]
    v_exp_f32 v104, v104
    v_exp_f32 v105, v105
    v_exp_f32 v106, v106
    v_exp_f32 v107, v107
    v_cvt_pk_bf16_f32 v134, v104, v105
    v_cvt_pk_bf16_f32 v135, v106, v107
    v_mfma_f32_32x32x16_bf16 v[68:83], v[156:159], v[140:143], 0
    v_exp_f32 v108, v108
    v_exp_f32 v109, v109
    v_exp_f32 v110, v110
    v_exp_f32 v111, v111
    v_cvt_pk_bf16_f32 v136, v108, v109
    v_cvt_pk_bf16_f32 v137, v110, v111
    v_mfma_f32_32x32x16_bf16 v[68:83], v[160:163], v[144:147], v[68:83]
    buffer_load_dwordx4 v[200:203], v212, s[40:43], s77 offen offset:1024 sc1
    v_exp_f32 v112, v112
    v_exp_f32 v113, v113
    v_exp_f32 v114, v114
    v_exp_f32 v115, v115
    v_cvt_pk_bf16_f32 v138, v112, v113
    v_cvt_pk_bf16_f32 v139, v114, v115
    s_waitcnt vmcnt(6)
    v_mfma_f32_32x32x16_bf16 v[100:115], v[164:167], v[12:15], 0
    v_exp_f32 v116, v116
    v_exp_f32 v117, v117
    v_exp_f32 v118, v118
    v_exp_f32 v119, v119
    v_cvt_pk_bf16_f32 v140, v116, v117
    v_cvt_pk_bf16_f32 v141, v118, v119
    v_mfma_f32_32x32x16_bf16 v[100:115], v[168:171], v[16:19], v[100:115]
    v_exp_f32 v120, v120
    v_exp_f32 v121, v121
    v_exp_f32 v122, v122
    v_exp_f32 v123, v123
    v_cvt_pk_bf16_f32 v142, v120, v121
    v_cvt_pk_bf16_f32 v143, v122, v123
    v_mfma_f32_32x32x16_bf16 v[84:99], v[156:159], v[132:135], 0
    v_exp_f32 v124, v124
    v_exp_f32 v125, v125
    v_exp_f32 v126, v126
    v_exp_f32 v127, v127
    v_cvt_pk_bf16_f32 v144, v124, v125
    v_cvt_pk_bf16_f32 v145, v126, v127
    v_mfma_f32_32x32x16_bf16 v[84:99], v[160:163], v[136:139], v[84:99]
    buffer_load_dwordx4 v[204:207], v212, s[40:43], s77 offen offset:2048 sc1
    v_exp_f32 v128, v128
    v_exp_f32 v129, v129
    v_exp_f32 v130, v130
    v_exp_f32 v131, v131
    v_cvt_pk_bf16_f32 v146, v128, v129
    v_cvt_pk_bf16_f32 v147, v130, v131
    v_mfma_f32_32x32x16_bf16 v[116:131], v[164:167], v[20:23], 0
    v_exp_f32 v100, v100
    v_exp_f32 v101, v101
    v_exp_f32 v102, v102
    v_exp_f32 v103, v103
    v_cvt_pk_bf16_f32 v132, v100, v101
    v_cvt_pk_bf16_f32 v133, v102, v103
    v_mfma_f32_32x32x16_bf16 v[116:131], v[168:171], v[24:27], v[116:131]
    v_exp_f32 v104, v104
    v_exp_f32 v105, v105
    v_exp_f32 v106, v106
    v_exp_f32 v107, v107
    v_cvt_pk_bf16_f32 v134, v104, v105
    v_cvt_pk_bf16_f32 v135, v106, v107
    v_mfma_f32_32x32x16_bf16 v[36:51], v[156:159], v[140:143], 0
    v_exp_f32 v108, v108
    v_exp_f32 v109, v109
    v_exp_f32 v110, v110
    v_exp_f32 v111, v111
    v_cvt_pk_bf16_f32 v136, v108, v109
    v_cvt_pk_bf16_f32 v137, v110, v111
    v_mfma_f32_32x32x16_bf16 v[36:51], v[160:163], v[144:147], v[36:51]
    buffer_load_dwordx4 v[208:211], v212, s[40:43], s77 offen offset:3072 sc1
    s_add_u32 s77, s77, 4096
    v_exp_f32 v112, v112
    v_exp_f32 v113, v113
    v_exp_f32 v114, v114
    v_exp_f32 v115, v115
    v_cvt_pk_bf16_f32 v138, v112, v113
    v_cvt_pk_bf16_f32 v139, v114, v115
    v_mfma_f32_32x32x16_bf16 v[100:115], v[164:167], v[28:31], 0
    v_exp_f32 v116, v116
    v_exp_f32 v117, v117
    v_exp_f32 v118, v118
    v_exp_f32 v119, v119
    v_cvt_pk_bf16_f32 v140, v116, v117
    v_cvt_pk_bf16_f32 v141, v118, v119
    v_mfma_f32_32x32x16_bf16 v[100:115], v[168:171], v[32:35], v[100:115]
    v_exp_f32 v120, v120
    v_exp_f32 v121, v121
    v_exp_f32 v122, v122
    v_exp_f32 v123, v123
    v_cvt_pk_bf16_f32 v142, v120, v121
    v_cvt_pk_bf16_f32 v143, v122, v123
    v_mfma_f32_32x32x16_bf16 v[52:67], v[172:175], v[132:135], v[52:67]
    v_exp_f32 v124, v124
    v_exp_f32 v125, v125
    v_exp_f32 v126, v126
    v_exp_f32 v127, v127
    v_cvt_pk_bf16_f32 v144, v124, v125
    v_cvt_pk_bf16_f32 v145, v126, v127
    v_mfma_f32_32x32x16_bf16 v[52:67], v[176:179], v[136:139], v[52:67]
    buffer_load_dwordx4 v[148:151], v212, s[40:43], s77 offen offset:0 sc1
    v_exp_f32 v128, v128
    v_exp_f32 v129, v129
    v_exp_f32 v130, v130
    v_exp_f32 v131, v131
    v_cvt_pk_bf16_f32 v146, v128, v129
    v_cvt_pk_bf16_f32 v147, v130, v131
    v_mfma_f32_32x32x16_bf16 v[116:131], v[164:167], v[4:7], 0
    v_exp_f32 v100, v100
    v_exp_f32 v101, v101
    v_exp_f32 v102, v102
    v_exp_f32 v103, v103
    v_cvt_pk_bf16_f32 v132, v100, v101
    v_cvt_pk_bf16_f32 v133, v102, v103
    v_mfma_f32_32x32x16_bf16 v[116:131], v[168:171], v[8:11], v[116:131]
    v_exp_f32 v104, v104
    v_exp_f32 v105, v105
    v_exp_f32 v106, v106
    v_exp_f32 v107, v107
    v_cvt_pk_bf16_f32 v134, v104, v105
    v_cvt_pk_bf16_f32 v135, v106, v107
    v_mfma_f32_32x32x16_bf16 v[68:83], v[172:175], v[140:143], v[68:83]
    v_exp_f32 v108, v108
    v_exp_f32 v109, v109
    v_exp_f32 v110, v110
    v_exp_f32 v111, v111
    v_cvt_pk_bf16_f32 v136, v108, v109
    v_cvt_pk_bf16_f32 v137, v110, v111
    v_mfma_f32_32x32x16_bf16 v[68:83], v[176:179], v[144:147], v[68:83]
    buffer_load_dwordx4 v[152:155], v212, s[40:43], s77 offen offset:1024 sc1
    v_exp_f32 v112, v112
    v_exp_f32 v113, v113
    v_exp_f32 v114, v114
    v_exp_f32 v115, v115
    v_cvt_pk_bf16_f32 v138, v112, v113
    v_cvt_pk_bf16_f32 v139, v114, v115
    s_waitcnt vmcnt(6)
    v_mfma_f32_32x32x16_bf16 v[100:115], v[180:183], v[12:15], 0
    v_exp_f32 v116, v116
    v_exp_f32 v117, v117
    v_exp_f32 v118, v118
    v_exp_f32 v119, v119
    v_cvt_pk_bf16_f32 v140, v116, v117
    v_cvt_pk_bf16_f32 v141, v118, v119
    v_mfma_f32_32x32x16_bf16 v[100:115], v[184:187], v[16:19], v[100:115]
    v_exp_f32 v120, v120
    v_exp_f32 v121, v121
    v_exp_f32 v122, v122
    v_exp_f32 v123, v123
    v_cvt_pk_bf16_f32 v142, v120, v121
    v_cvt_pk_bf16_f32 v143, v122, v123
    v_mfma_f32_32x32x16_bf16 v[84:99], v[172:175], v[132:135], v[84:99]
    v_exp_f32 v124, v124
    v_exp_f32 v125, v125
    v_exp_f32 v126, v126
    v_exp_f32 v127, v127
    v_cvt_pk_bf16_f32 v144, v124, v125
    v_cvt_pk_bf16_f32 v145, v126, v127
    v_mfma_f32_32x32x16_bf16 v[84:99], v[176:179], v[136:139], v[84:99]
    buffer_load_dwordx4 v[156:159], v212, s[40:43], s77 offen offset:2048 sc1
    v_exp_f32 v128, v128
    v_exp_f32 v129, v129
    v_exp_f32 v130, v130
    v_exp_f32 v131, v131
    v_cvt_pk_bf16_f32 v146, v128, v129
    v_cvt_pk_bf16_f32 v147, v130, v131
    v_mfma_f32_32x32x16_bf16 v[116:131], v[180:183], v[20:23], 0
    v_exp_f32 v100, v100
    v_exp_f32 v101, v101
    v_exp_f32 v102, v102
    v_exp_f32 v103, v103
    v_cvt_pk_bf16_f32 v132, v100, v101
    v_cvt_pk_bf16_f32 v133, v102, v103
    v_mfma_f32_32x32x16_bf16 v[116:131], v[184:187], v[24:27], v[116:131]
    v_exp_f32 v104, v104
    v_exp_f32 v105, v105
    v_exp_f32 v106, v106
    v_exp_f32 v107, v107
    v_cvt_pk_bf16_f32 v134, v104, v105
    v_cvt_pk_bf16_f32 v135, v106, v107
    v_mfma_f32_32x32x16_bf16 v[36:51], v[172:175], v[140:143], v[36:51]
    v_exp_f32 v108, v108
    v_exp_f32 v109, v109
    v_exp_f32 v110, v110
    v_exp_f32 v111, v111
    v_cvt_pk_bf16_f32 v136, v108, v109
    v_cvt_pk_bf16_f32 v137, v110, v111
    v_mfma_f32_32x32x16_bf16 v[36:51], v[176:179], v[144:147], v[36:51]
    buffer_load_dwordx4 v[160:163], v212, s[40:43], s77 offen offset:3072 sc1
    s_add_u32 s77, s77, 4096
    v_exp_f32 v112, v112
    v_exp_f32 v113, v113
    v_exp_f32 v114, v114
    v_exp_f32 v115, v115
    v_cvt_pk_bf16_f32 v138, v112, v113
    v_cvt_pk_bf16_f32 v139, v114, v115
    v_mfma_f32_32x32x16_bf16 v[100:115], v[180:183], v[28:31], 0
    v_exp_f32 v116, v116
    v_exp_f32 v117, v117
    v_exp_f32 v118, v118
    v_exp_f32 v119, v119
    v_cvt_pk_bf16_f32 v140, v116, v117
    v_cvt_pk_bf16_f32 v141, v118, v119
    v_mfma_f32_32x32x16_bf16 v[100:115], v[184:187], v[32:35], v[100:115]
    v_exp_f32 v120, v120
    v_exp_f32 v121, v121
    v_exp_f32 v122, v122
    v_exp_f32 v123, v123
    v_cvt_pk_bf16_f32 v142, v120, v121
    v_cvt_pk_bf16_f32 v143, v122, v123
    v_mfma_f32_32x32x16_bf16 v[52:67], v[188:191], v[132:135], v[52:67]
    v_exp_f32 v124, v124
    v_exp_f32 v125, v125
    v_exp_f32 v126, v126
    v_exp_f32 v127, v127
    v_cvt_pk_bf16_f32 v144, v124, v125
    v_cvt_pk_bf16_f32 v145, v126, v127
    v_mfma_f32_32x32x16_bf16 v[52:67], v[192:195], v[136:139], v[52:67]
    buffer_load_dwordx4 v[164:167], v212, s[40:43], s77 offen offset:0 sc1
    v_exp_f32 v128, v128
    v_exp_f32 v129, v129
    v_exp_f32 v130, v130
    v_exp_f32 v131, v131
    v_cvt_pk_bf16_f32 v146, v128, v129
    v_cvt_pk_bf16_f32 v147, v130, v131
    v_mfma_f32_32x32x16_bf16 v[116:131], v[180:183], v[4:7], 0
    v_exp_f32 v100, v100
    v_exp_f32 v101, v101
    v_exp_f32 v102, v102
    v_exp_f32 v103, v103
    v_cvt_pk_bf16_f32 v132, v100, v101
    v_cvt_pk_bf16_f32 v133, v102, v103
    v_mfma_f32_32x32x16_bf16 v[116:131], v[184:187], v[8:11], v[116:131]
    v_exp_f32 v104, v104
    v_exp_f32 v105, v105
    v_exp_f32 v106, v106
    v_exp_f32 v107, v107
    v_cvt_pk_bf16_f32 v134, v104, v105
    v_cvt_pk_bf16_f32 v135, v106, v107
    v_mfma_f32_32x32x16_bf16 v[68:83], v[188:191], v[140:143], v[68:83]
    v_exp_f32 v108, v108
    v_exp_f32 v109, v109
    v_exp_f32 v110, v110
    v_exp_f32 v111, v111
    v_cvt_pk_bf16_f32 v136, v108, v109
    v_cvt_pk_bf16_f32 v137, v110, v111
    v_mfma_f32_32x32x16_bf16 v[68:83], v[192:195], v[144:147], v[68:83]
    buffer_load_dwordx4 v[168:171], v212, s[40:43], s77 offen offset:1024 sc1
    v_exp_f32 v112, v112
    v_exp_f32 v113, v113
    v_exp_f32 v114, v114
    v_exp_f32 v115, v115
    v_cvt_pk_bf16_f32 v138, v112, v113
    v_cvt_pk_bf16_f32 v139, v114, v115
    s_waitcnt vmcnt(6)
    v_mfma_f32_32x32x16_bf16 v[100:115], v[196:199], v[12:15], 0
    v_exp_f32 v116, v116
    v_exp_f32 v117, v117
    v_exp_f32 v118, v118
    v_exp_f32 v119, v119
    v_cvt_pk_bf16_f32 v140, v116, v117
    v_cvt_pk_bf16_f32 v141, v118, v119
    v_mfma_f32_32x32x16_bf16 v[100:115], v[200:203], v[16:19], v[100:115]
    v_exp_f32 v120, v120
    v_exp_f32 v121, v121
    v_exp_f32 v122, v122
    v_exp_f32 v123, v123
    v_cvt_pk_bf16_f32 v142, v120, v121
    v_cvt_pk_bf16_f32 v143, v122, v123
    v_mfma_f32_32x32x16_bf16 v[84:99], v[188:191], v[132:135], v[84:99]
    v_exp_f32 v124, v124
    v_exp_f32 v125, v125
    v_exp_f32 v126, v126
    v_exp_f32 v127, v127
    v_cvt_pk_bf16_f32 v144, v124, v125
    v_cvt_pk_bf16_f32 v145, v126, v127
    v_mfma_f32_32x32x16_bf16 v[84:99], v[192:195], v[136:139], v[84:99]
    buffer_load_dwordx4 v[172:175], v212, s[40:43], s77 offen offset:2048 sc1
    v_exp_f32 v128, v128
    v_exp_f32 v129, v129
    v_exp_f32 v130, v130
    v_exp_f32 v131, v131
    v_cvt_pk_bf16_f32 v146, v128, v129
    v_cvt_pk_bf16_f32 v147, v130, v131
    v_mfma_f32_32x32x16_bf16 v[116:131], v[196:199], v[20:23], 0
    v_exp_f32 v100, v100
    v_exp_f32 v101, v101
    v_exp_f32 v102, v102
    v_exp_f32 v103, v103
    v_cvt_pk_bf16_f32 v132, v100, v101
    v_cvt_pk_bf16_f32 v133, v102, v103
    v_mfma_f32_32x32x16_bf16 v[116:131], v[200:203], v[24:27], v[116:131]
    v_exp_f32 v104, v104
    v_exp_f32 v105, v105
    v_exp_f32 v106, v106
    v_exp_f32 v107, v107
    v_cvt_pk_bf16_f32 v134, v104, v105
    v_cvt_pk_bf16_f32 v135, v106, v107
    v_mfma_f32_32x32x16_bf16 v[36:51], v[188:191], v[140:143], v[36:51]
    v_exp_f32 v108, v108
    v_exp_f32 v109, v109
    v_exp_f32 v110, v110
    v_exp_f32 v111, v111
    v_cvt_pk_bf16_f32 v136, v108, v109
    v_cvt_pk_bf16_f32 v137, v110, v111
    v_mfma_f32_32x32x16_bf16 v[36:51], v[192:195], v[144:147], v[36:51]
    buffer_load_dwordx4 v[176:179], v212, s[40:43], s77 offen offset:3072 sc1
    s_add_u32 s77, s77, 4096
    v_exp_f32 v112, v112
    v_exp_f32 v113, v113
    v_exp_f32 v114, v114
    v_exp_f32 v115, v115
    v_cvt_pk_bf16_f32 v138, v112, v113
    v_cvt_pk_bf16_f32 v139, v114, v115
    v_mfma_f32_32x32x16_bf16 v[100:115], v[196:199], v[28:31], 0
    v_exp_f32 v116, v116
    v_exp_f32 v117, v117
    v_exp_f32 v118, v118
    v_exp_f32 v119, v119
    v_cvt_pk_bf16_f32 v140, v116, v117
    v_cvt_pk_bf16_f32 v141, v118, v119
    v_mfma_f32_32x32x16_bf16 v[100:115], v[200:203], v[32:35], v[100:115]
    v_exp_f32 v120, v120
    v_exp_f32 v121, v121
    v_exp_f32 v122, v122
    v_exp_f32 v123, v123
    v_cvt_pk_bf16_f32 v142, v120, v121
    v_cvt_pk_bf16_f32 v143, v122, v123
    v_mfma_f32_32x32x16_bf16 v[52:67], v[204:207], v[132:135], v[52:67]
    v_exp_f32 v124, v124
    v_exp_f32 v125, v125
    v_exp_f32 v126, v126
    v_exp_f32 v127, v127
    v_cvt_pk_bf16_f32 v144, v124, v125
    v_cvt_pk_bf16_f32 v145, v126, v127
    v_mfma_f32_32x32x16_bf16 v[52:67], v[208:211], v[136:139], v[52:67]
    buffer_load_dwordx4 v[180:183], v212, s[40:43], s77 offen offset:0 sc1
    v_exp_f32 v128, v128
    v_exp_f32 v129, v129
    v_exp_f32 v130, v130
    v_exp_f32 v131, v131
    v_cvt_pk_bf16_f32 v146, v128, v129
    v_cvt_pk_bf16_f32 v147, v130, v131
    v_mfma_f32_32x32x16_bf16 v[116:131], v[196:199], v[4:7], 0
    v_exp_f32 v100, v100
    v_exp_f32 v101, v101
    v_exp_f32 v102, v102
    v_exp_f32 v103, v103
    v_cvt_pk_bf16_f32 v132, v100, v101
    v_cvt_pk_bf16_f32 v133, v102, v103
    v_mfma_f32_32x32x16_bf16 v[116:131], v[200:203], v[8:11], v[116:131]
    v_exp_f32 v104, v104
    v_exp_f32 v105, v105
    v_exp_f32 v106, v106
    v_exp_f32 v107, v107
    v_cvt_pk_bf16_f32 v134, v104, v105
    v_cvt_pk_bf16_f32 v135, v106, v107
    v_mfma_f32_32x32x16_bf16 v[68:83], v[204:207], v[140:143], v[68:83]
    v_exp_f32 v108, v108
    v_exp_f32 v109, v109
    v_exp_f32 v110, v110
    v_exp_f32 v111, v111
    v_cvt_pk_bf16_f32 v136, v108, v109
    v_cvt_pk_bf16_f32 v137, v110, v111
    v_mfma_f32_32x32x16_bf16 v[68:83], v[208:211], v[144:147], v[68:83]
    buffer_load_dwordx4 v[184:187], v212, s[40:43], s77 offen offset:1024 sc1
    v_exp_f32 v112, v112
    v_exp_f32 v113, v113
    v_exp_f32 v114, v114
    v_exp_f32 v115, v115
    v_cvt_pk_bf16_f32 v138, v112, v113
    v_cvt_pk_bf16_f32 v139, v114, v115
    s_waitcnt vmcnt(6)
    v_mfma_f32_32x32x16_bf16 v[100:115], v[148:151], v[12:15], 0
    v_exp_f32 v116, v116
    v_exp_f32 v117, v117
    v_exp_f32 v118, v118
    v_exp_f32 v119, v119
    v_cvt_pk_bf16_f32 v140, v116, v117
    v_cvt_pk_bf16_f32 v141, v118, v119
    v_mfma_f32_32x32x16_bf16 v[100:115], v[152:155], v[16:19], v[100:115]
    v_exp_f32 v120, v120
    v_exp_f32 v121, v121
    v_exp_f32 v122, v122
    v_exp_f32 v123, v123
    v_cvt_pk_bf16_f32 v142, v120, v121
    v_cvt_pk_bf16_f32 v143, v122, v123
    v_mfma_f32_32x32x16_bf16 v[84:99], v[204:207], v[132:135], v[84:99]
    v_exp_f32 v124, v124
    v_exp_f32 v125, v125
    v_exp_f32 v126, v126
    v_exp_f32 v127, v127
    v_cvt_pk_bf16_f32 v144, v124, v125
    v_cvt_pk_bf16_f32 v145, v126, v127
    v_mfma_f32_32x32x16_bf16 v[84:99], v[208:211], v[136:139], v[84:99]
    buffer_load_dwordx4 v[188:191], v212, s[40:43], s77 offen offset:2048 sc1
    v_exp_f32 v128, v128
    v_exp_f32 v129, v129
    v_exp_f32 v130, v130
    v_exp_f32 v131, v131
    v_cvt_pk_bf16_f32 v146, v128, v129
    v_cvt_pk_bf16_f32 v147, v130, v131
    v_mfma_f32_32x32x16_bf16 v[116:131], v[148:151], v[20:23], 0
    v_exp_f32 v100, v100
    v_exp_f32 v101, v101
    v_exp_f32 v102, v102
    v_exp_f32 v103, v103
    v_cvt_pk_bf16_f32 v132, v100, v101
    v_cvt_pk_bf16_f32 v133, v102, v103
    v_mfma_f32_32x32x16_bf16 v[116:131], v[152:155], v[24:27], v[116:131]
    v_exp_f32 v104, v104
    v_exp_f32 v105, v105
    v_exp_f32 v106, v106
    v_exp_f32 v107, v107
    v_cvt_pk_bf16_f32 v134, v104, v105
    v_cvt_pk_bf16_f32 v135, v106, v107
    v_mfma_f32_32x32x16_bf16 v[36:51], v[204:207], v[140:143], v[36:51]
    v_exp_f32 v108, v108
    v_exp_f32 v109, v109
    v_exp_f32 v110, v110
    v_exp_f32 v111, v111
    v_cvt_pk_bf16_f32 v136, v108, v109
    v_cvt_pk_bf16_f32 v137, v110, v111
    v_mfma_f32_32x32x16_bf16 v[36:51], v[208:211], v[144:147], v[36:51]
    buffer_load_dwordx4 v[192:195], v212, s[40:43], s77 offen offset:3072 sc1
    s_add_u32 s77, s77, 4096
    v_exp_f32 v112, v112
    v_exp_f32 v113, v113
    v_exp_f32 v114, v114
    v_exp_f32 v115, v115
    v_cvt_pk_bf16_f32 v138, v112, v113
    v_cvt_pk_bf16_f32 v139, v114, v115
    v_mfma_f32_32x32x16_bf16 v[100:115], v[148:151], v[28:31], 0
    v_exp_f32 v116, v116
    v_exp_f32 v117, v117
    v_exp_f32 v118, v118
    v_exp_f32 v119, v119
    v_cvt_pk_bf16_f32 v140, v116, v117
    v_cvt_pk_bf16_f32 v141, v118, v119
    v_mfma_f32_32x32x16_bf16 v[100:115], v[152:155], v[32:35], v[100:115]
    v_exp_f32 v120, v120
    v_exp_f32 v121, v121
    v_exp_f32 v122, v122
    v_exp_f32 v123, v123
    v_cvt_pk_bf16_f32 v142, v120, v121
    v_cvt_pk_bf16_f32 v143, v122, v123
    v_mfma_f32_32x32x16_bf16 v[52:67], v[156:159], v[132:135], v[52:67]
    v_exp_f32 v124, v124
    v_exp_f32 v125, v125
    v_exp_f32 v126, v126
    v_exp_f32 v127, v127
    v_cvt_pk_bf16_f32 v144, v124, v125
    v_cvt_pk_bf16_f32 v145, v126, v127
    v_mfma_f32_32x32x16_bf16 v[52:67], v[160:163], v[136:139], v[52:67]
    buffer_load_dwordx4 v[196:199], v212, s[40:43], s77 offen offset:0 sc1
    v_exp_f32 v128, v128
    v_exp_f32 v129, v129
    v_exp_f32 v130, v130
    v_exp_f32 v131, v131
    v_cvt_pk_bf16_f32 v146, v128, v129
    v_cvt_pk_bf16_f32 v147, v130, v131
    v_mfma_f32_32x32x16_bf16 v[116:131], v[148:151], v[4:7], 0
    v_exp_f32 v100, v100
    v_exp_f32 v101, v101
    v_exp_f32 v102, v102
    v_exp_f32 v103, v103
    v_cvt_pk_bf16_f32 v132, v100, v101
    v_cvt_pk_bf16_f32 v133, v102, v103
    v_mfma_f32_32x32x16_bf16 v[116:131], v[152:155], v[8:11], v[116:131]
    v_exp_f32 v104, v104
    v_exp_f32 v105, v105
    v_exp_f32 v106, v106
    v_exp_f32 v107, v107
    v_cvt_pk_bf16_f32 v134, v104, v105
    v_cvt_pk_bf16_f32 v135, v106, v107
    v_mfma_f32_32x32x16_bf16 v[68:83], v[156:159], v[140:143], v[68:83]
    v_exp_f32 v108, v108
    v_exp_f32 v109, v109
    v_exp_f32 v110, v110
    v_exp_f32 v111, v111
    v_cvt_pk_bf16_f32 v136, v108, v109
    v_cvt_pk_bf16_f32 v137, v110, v111
    v_mfma_f32_32x32x16_bf16 v[68:83], v[160:163], v[144:147], v[68:83]
    buffer_load_dwordx4 v[200:203], v212, s[40:43], s77 offen offset:1024 sc1
    v_exp_f32 v112, v112
    v_exp_f32 v113, v113
    v_exp_f32 v114, v114
    v_exp_f32 v115, v115
    v_cvt_pk_bf16_f32 v138, v112, v113
    v_cvt_pk_bf16_f32 v139, v114, v115
    s_waitcnt vmcnt(6)
    v_mfma_f32_32x32x16_bf16 v[100:115], v[164:167], v[12:15], 0
    v_exp_f32 v116, v116
    v_exp_f32 v117, v117
    v_exp_f32 v118, v118
    v_exp_f32 v119, v119
    v_cvt_pk_bf16_f32 v140, v116, v117
    v_cvt_pk_bf16_f32 v141, v118, v119
    v_mfma_f32_32x32x16_bf16 v[100:115], v[168:171], v[16:19], v[100:115]
    v_exp_f32 v120, v120
    v_exp_f32 v121, v121
    v_exp_f32 v122, v122
    v_exp_f32 v123, v123
    v_cvt_pk_bf16_f32 v142, v120, v121
    v_cvt_pk_bf16_f32 v143, v122, v123
    v_mfma_f32_32x32x16_bf16 v[84:99], v[156:159], v[132:135], v[84:99]
    v_exp_f32 v124, v124
    v_exp_f32 v125, v125
    v_exp_f32 v126, v126
    v_exp_f32 v127, v127
    v_cvt_pk_bf16_f32 v144, v124, v125
    v_cvt_pk_bf16_f32 v145, v126, v127
    v_mfma_f32_32x32x16_bf16 v[84:99], v[160:163], v[136:139], v[84:99]
    buffer_load_dwordx4 v[204:207], v212, s[40:43], s77 offen offset:2048 sc1
    v_exp_f32 v128, v128
    v_exp_f32 v129, v129
    v_exp_f32 v130, v130
    v_exp_f32 v131, v131
    v_cvt_pk_bf16_f32 v146, v128, v129
    v_cvt_pk_bf16_f32 v147, v130, v131
    v_mfma_f32_32x32x16_bf16 v[116:131], v[164:167], v[20:23], 0
    v_exp_f32 v100, v100
    v_exp_f32 v101, v101
    v_exp_f32 v102, v102
    v_exp_f32 v103, v103
    v_cvt_pk_bf16_f32 v132, v100, v101
    v_cvt_pk_bf16_f32 v133, v102, v103
    v_mfma_f32_32x32x16_bf16 v[116:131], v[168:171], v[24:27], v[116:131]
    v_exp_f32 v104, v104
    v_exp_f32 v105, v105
    v_exp_f32 v106, v106
    v_exp_f32 v107, v107
    v_cvt_pk_bf16_f32 v134, v104, v105
    v_cvt_pk_bf16_f32 v135, v106, v107
    v_mfma_f32_32x32x16_bf16 v[36:51], v[156:159], v[140:143], v[36:51]
    v_exp_f32 v108, v108
    v_exp_f32 v109, v109
    v_exp_f32 v110, v110
    v_exp_f32 v111, v111
    v_cvt_pk_bf16_f32 v136, v108, v109
    v_cvt_pk_bf16_f32 v137, v110, v111
    v_mfma_f32_32x32x16_bf16 v[36:51], v[160:163], v[144:147], v[36:51]
    buffer_load_dwordx4 v[208:211], v212, s[40:43], s77 offen offset:3072 sc1
    s_add_u32 s77, s77, 4096
    v_exp_f32 v112, v112
    v_exp_f32 v113, v113
    v_exp_f32 v114, v114
    v_exp_f32 v115, v115
    v_cvt_pk_bf16_f32 v138, v112, v113
    v_cvt_pk_bf16_f32 v139, v114, v115
    v_mfma_f32_32x32x16_bf16 v[100:115], v[164:167], v[28:31], 0
    v_exp_f32 v116, v116
    v_exp_f32 v117, v117
    v_exp_f32 v118, v118
    v_exp_f32 v119, v119
    v_cvt_pk_bf16_f32 v140, v116, v117
    v_cvt_pk_bf16_f32 v141, v118, v119
    v_mfma_f32_32x32x16_bf16 v[100:115], v[168:171], v[32:35], v[100:115]
    v_exp_f32 v120, v120
    v_exp_f32 v121, v121
    v_exp_f32 v122, v122
    v_exp_f32 v123, v123
    v_cvt_pk_bf16_f32 v142, v120, v121
    v_cvt_pk_bf16_f32 v143, v122, v123
    v_mfma_f32_32x32x16_bf16 v[52:67], v[172:175], v[132:135], v[52:67]
    v_exp_f32 v124, v124
    v_exp_f32 v125, v125
    v_exp_f32 v126, v126
    v_exp_f32 v127, v127
    v_cvt_pk_bf16_f32 v144, v124, v125
    v_cvt_pk_bf16_f32 v145, v126, v127
    v_mfma_f32_32x32x16_bf16 v[52:67], v[176:179], v[136:139], v[52:67]
    buffer_load_dwordx4 v[148:151], v212, s[40:43], s77 offen offset:0 sc1
    v_exp_f32 v128, v128
    v_exp_f32 v129, v129
    v_exp_f32 v130, v130
    v_exp_f32 v131, v131
    v_cvt_pk_bf16_f32 v146, v128, v129
    v_cvt_pk_bf16_f32 v147, v130, v131
    v_mfma_f32_32x32x16_bf16 v[116:131], v[164:167], v[4:7], 0
    v_exp_f32 v100, v100
    v_exp_f32 v101, v101
    v_exp_f32 v102, v102
    v_exp_f32 v103, v103
    v_cvt_pk_bf16_f32 v132, v100, v101
    v_cvt_pk_bf16_f32 v133, v102, v103
    v_mfma_f32_32x32x16_bf16 v[116:131], v[168:171], v[8:11], v[116:131]
    v_exp_f32 v104, v104
    v_exp_f32 v105, v105
    v_exp_f32 v106, v106
    v_exp_f32 v107, v107
    v_cvt_pk_bf16_f32 v134, v104, v105
    v_cvt_pk_bf16_f32 v135, v106, v107
    v_mfma_f32_32x32x16_bf16 v[68:83], v[172:175], v[140:143], v[68:83]
    v_exp_f32 v108, v108
    v_exp_f32 v109, v109
    v_exp_f32 v110, v110
    v_exp_f32 v111, v111
    v_cvt_pk_bf16_f32 v136, v108, v109
    v_cvt_pk_bf16_f32 v137, v110, v111
    v_mfma_f32_32x32x16_bf16 v[68:83], v[176:179], v[144:147], v[68:83]
    buffer_load_dwordx4 v[152:155], v212, s[40:43], s77 offen offset:1024 sc1
    v_exp_f32 v112, v112
    v_exp_f32 v113, v113
    v_exp_f32 v114, v114
    v_exp_f32 v115, v115
    v_cvt_pk_bf16_f32 v138, v112, v113
    v_cvt_pk_bf16_f32 v139, v114, v115
    s_waitcnt vmcnt(6)
    v_mfma_f32_32x32x16_bf16 v[100:115], v[180:183], v[12:15], 0
    v_exp_f32 v116, v116
    v_exp_f32 v117, v117
    v_exp_f32 v118, v118
    v_exp_f32 v119, v119
    v_cvt_pk_bf16_f32 v140, v116, v117
    v_cvt_pk_bf16_f32 v141, v118, v119
    v_mfma_f32_32x32x16_bf16 v[100:115], v[184:187], v[16:19], v[100:115]
    v_exp_f32 v120, v120
    v_exp_f32 v121, v121
    v_exp_f32 v122, v122
    v_exp_f32 v123, v123
    v_cvt_pk_bf16_f32 v142, v120, v121
    v_cvt_pk_bf16_f32 v143, v122, v123
    v_mfma_f32_32x32x16_bf16 v[84:99], v[172:175], v[132:135], v[84:99]
    v_exp_f32 v124, v124
    v_exp_f32 v125, v125
    v_exp_f32 v126, v126
    v_exp_f32 v127, v127
    v_cvt_pk_bf16_f32 v144, v124, v125
    v_cvt_pk_bf16_f32 v145, v126, v127
    v_mfma_f32_32x32x16_bf16 v[84:99], v[176:179], v[136:139], v[84:99]
    buffer_load_dwordx4 v[156:159], v212, s[40:43], s77 offen offset:2048 sc1
    v_exp_f32 v128, v128
    v_exp_f32 v129, v129
    v_exp_f32 v130, v130
    v_exp_f32 v131, v131
    v_cvt_pk_bf16_f32 v146, v128, v129
    v_cvt_pk_bf16_f32 v147, v130, v131
    v_mfma_f32_32x32x16_bf16 v[116:131], v[180:183], v[20:23], 0
    v_exp_f32 v100, v100
    v_exp_f32 v101, v101
    v_exp_f32 v102, v102
    v_exp_f32 v103, v103
    v_cvt_pk_bf16_f32 v132, v100, v101
    v_cvt_pk_bf16_f32 v133, v102, v103
    v_mfma_f32_32x32x16_bf16 v[116:131], v[184:187], v[24:27], v[116:131]
    v_exp_f32 v104, v104
    v_exp_f32 v105, v105
    v_exp_f32 v106, v106
    v_exp_f32 v107, v107
    v_cvt_pk_bf16_f32 v134, v104, v105
    v_cvt_pk_bf16_f32 v135, v106, v107
    v_mfma_f32_32x32x16_bf16 v[36:51], v[172:175], v[140:143], v[36:51]
    v_exp_f32 v108, v108
    v_exp_f32 v109, v109
    v_exp_f32 v110, v110
    v_exp_f32 v111, v111
    v_cvt_pk_bf16_f32 v136, v108, v109
    v_cvt_pk_bf16_f32 v137, v110, v111
    v_mfma_f32_32x32x16_bf16 v[36:51], v[176:179], v[144:147], v[36:51]
    buffer_load_dwordx4 v[160:163], v212, s[40:43], s77 offen offset:3072 sc1
    s_add_u32 s77, s77, 4096
    v_exp_f32 v112, v112
    v_exp_f32 v113, v113
    v_exp_f32 v114, v114
    v_exp_f32 v115, v115
    v_cvt_pk_bf16_f32 v138, v112, v113
    v_cvt_pk_bf16_f32 v139, v114, v115
    v_mfma_f32_32x32x16_bf16 v[100:115], v[180:183], v[28:31], 0
    v_exp_f32 v116, v116
    v_exp_f32 v117, v117
    v_exp_f32 v118, v118
    v_exp_f32 v119, v119
    v_cvt_pk_bf16_f32 v140, v116, v117
    v_cvt_pk_bf16_f32 v141, v118, v119
    v_mfma_f32_32x32x16_bf16 v[100:115], v[184:187], v[32:35], v[100:115]
    v_exp_f32 v120, v120
    v_exp_f32 v121, v121
    v_exp_f32 v122, v122
    v_exp_f32 v123, v123
    v_cvt_pk_bf16_f32 v142, v120, v121
    v_cvt_pk_bf16_f32 v143, v122, v123
    v_mfma_f32_32x32x16_bf16 v[52:67], v[188:191], v[132:135], v[52:67]
    v_exp_f32 v124, v124
    v_exp_f32 v125, v125
    v_exp_f32 v126, v126
    v_exp_f32 v127, v127
    v_cvt_pk_bf16_f32 v144, v124, v125
    v_cvt_pk_bf16_f32 v145, v126, v127
    v_mfma_f32_32x32x16_bf16 v[52:67], v[192:195], v[136:139], v[52:67]
    buffer_load_dwordx4 v[164:167], v212, s[40:43], s77 offen offset:0 sc1
    v_exp_f32 v128, v128
    v_exp_f32 v129, v129
    v_exp_f32 v130, v130
    v_exp_f32 v131, v131
    v_cvt_pk_bf16_f32 v146, v128, v129
    v_cvt_pk_bf16_f32 v147, v130, v131
    v_mfma_f32_32x32x16_bf16 v[116:131], v[180:183], v[4:7], 0
    v_exp_f32 v100, v100
    v_exp_f32 v101, v101
    v_exp_f32 v102, v102
    v_exp_f32 v103, v103
    v_cvt_pk_bf16_f32 v132, v100, v101
    v_cvt_pk_bf16_f32 v133, v102, v103
    v_mfma_f32_32x32x16_bf16 v[116:131], v[184:187], v[8:11], v[116:131]
    v_exp_f32 v104, v104
    v_exp_f32 v105, v105
    v_exp_f32 v106, v106
    v_exp_f32 v107, v107
    v_cvt_pk_bf16_f32 v134, v104, v105
    v_cvt_pk_bf16_f32 v135, v106, v107
    v_mfma_f32_32x32x16_bf16 v[68:83], v[188:191], v[140:143], v[68:83]
    v_exp_f32 v108, v108
    v_exp_f32 v109, v109
    v_exp_f32 v110, v110
    v_exp_f32 v111, v111
    v_cvt_pk_bf16_f32 v136, v108, v109
    v_cvt_pk_bf16_f32 v137, v110, v111
    v_mfma_f32_32x32x16_bf16 v[68:83], v[192:195], v[144:147], v[68:83]
    buffer_load_dwordx4 v[168:171], v212, s[40:43], s77 offen offset:1024 sc1
    v_exp_f32 v112, v112
    v_exp_f32 v113, v113
    v_exp_f32 v114, v114
    v_exp_f32 v115, v115
    v_cvt_pk_bf16_f32 v138, v112, v113
    v_cvt_pk_bf16_f32 v139, v114, v115
    s_waitcnt vmcnt(6)
    v_mfma_f32_32x32x16_bf16 v[100:115], v[196:199], v[12:15], 0
    v_exp_f32 v116, v116
    v_exp_f32 v117, v117
    v_exp_f32 v118, v118
    v_exp_f32 v119, v119
    v_cvt_pk_bf16_f32 v140, v116, v117
    v_cvt_pk_bf16_f32 v141, v118, v119
    v_mfma_f32_32x32x16_bf16 v[100:115], v[200:203], v[16:19], v[100:115]
    v_exp_f32 v120, v120
    v_exp_f32 v121, v121
    v_exp_f32 v122, v122
    v_exp_f32 v123, v123
    v_cvt_pk_bf16_f32 v142, v120, v121
    v_cvt_pk_bf16_f32 v143, v122, v123
    v_mfma_f32_32x32x16_bf16 v[84:99], v[188:191], v[132:135], v[84:99]
    v_exp_f32 v124, v124
    v_exp_f32 v125, v125
    v_exp_f32 v126, v126
    v_exp_f32 v127, v127
    v_cvt_pk_bf16_f32 v144, v124, v125
    v_cvt_pk_bf16_f32 v145, v126, v127
    v_mfma_f32_32x32x16_bf16 v[84:99], v[192:195], v[136:139], v[84:99]
    buffer_load_dwordx4 v[172:175], v212, s[40:43], s77 offen offset:2048 sc1
    v_exp_f32 v128, v128
    v_exp_f32 v129, v129
    v_exp_f32 v130, v130
    v_exp_f32 v131, v131
    v_cvt_pk_bf16_f32 v146, v128, v129
    v_cvt_pk_bf16_f32 v147, v130, v131
    v_mfma_f32_32x32x16_bf16 v[116:131], v[196:199], v[20:23], 0
    v_exp_f32 v100, v100
    v_exp_f32 v101, v101
    v_exp_f32 v102, v102
    v_exp_f32 v103, v103
    v_cvt_pk_bf16_f32 v132, v100, v101
    v_cvt_pk_bf16_f32 v133, v102, v103
    v_mfma_f32_32x32x16_bf16 v[116:131], v[200:203], v[24:27], v[116:131]
    v_exp_f32 v104, v104
    v_exp_f32 v105, v105
    v_exp_f32 v106, v106
    v_exp_f32 v107, v107
    v_cvt_pk_bf16_f32 v134, v104, v105
    v_cvt_pk_bf16_f32 v135, v106, v107
    v_mfma_f32_32x32x16_bf16 v[36:51], v[188:191], v[140:143], v[36:51]
    v_exp_f32 v108, v108
    v_exp_f32 v109, v109
    v_exp_f32 v110, v110
    v_exp_f32 v111, v111
    v_cvt_pk_bf16_f32 v136, v108, v109
    v_cvt_pk_bf16_f32 v137, v110, v111
    v_mfma_f32_32x32x16_bf16 v[36:51], v[192:195], v[144:147], v[36:51]
    buffer_load_dwordx4 v[176:179], v212, s[40:43], s77 offen offset:3072 sc1
    s_add_u32 s77, s77, 4096
    v_exp_f32 v112, v112
    v_exp_f32 v113, v113
    v_exp_f32 v114, v114
    v_exp_f32 v115, v115
    v_cvt_pk_bf16_f32 v138, v112, v113
    v_cvt_pk_bf16_f32 v139, v114, v115
    v_mfma_f32_32x32x16_bf16 v[100:115], v[196:199], v[28:31], 0
    v_exp_f32 v116, v116
    v_exp_f32 v117, v117
    v_exp_f32 v118, v118
    v_exp_f32 v119, v119
    v_cvt_pk_bf16_f32 v140, v116, v117
    v_cvt_pk_bf16_f32 v141, v118, v119
    v_mfma_f32_32x32x16_bf16 v[100:115], v[200:203], v[32:35], v[100:115]
    v_exp_f32 v120, v120
    v_exp_f32 v121, v121
    v_exp_f32 v122, v122
    v_exp_f32 v123, v123
    v_cvt_pk_bf16_f32 v142, v120, v121
    v_cvt_pk_bf16_f32 v143, v122, v123
    v_mfma_f32_32x32x16_bf16 v[52:67], v[204:207], v[132:135], v[52:67]
    v_exp_f32 v124, v124
    v_exp_f32 v125, v125
    v_exp_f32 v126, v126
    v_exp_f32 v127, v127
    v_cvt_pk_bf16_f32 v144, v124, v125
    v_cvt_pk_bf16_f32 v145, v126, v127
    v_mfma_f32_32x32x16_bf16 v[52:67], v[208:211], v[136:139], v[52:67]
    buffer_load_dwordx4 v[180:183], v212, s[40:43], s77 offen offset:0 sc1
    v_exp_f32 v128, v128
    v_exp_f32 v129, v129
    v_exp_f32 v130, v130
    v_exp_f32 v131, v131
    v_cvt_pk_bf16_f32 v146, v128, v129
    v_cvt_pk_bf16_f32 v147, v130, v131
    v_mfma_f32_32x32x16_bf16 v[116:131], v[196:199], v[4:7], 0
    v_exp_f32 v100, v100
    v_exp_f32 v101, v101
    v_exp_f32 v102, v102
    v_exp_f32 v103, v103
    v_cvt_pk_bf16_f32 v132, v100, v101
    v_cvt_pk_bf16_f32 v133, v102, v103
    v_mfma_f32_32x32x16_bf16 v[116:131], v[200:203], v[8:11], v[116:131]
    v_exp_f32 v104, v104
    v_exp_f32 v105, v105
    v_exp_f32 v106, v106
    v_exp_f32 v107, v107
    v_cvt_pk_bf16_f32 v134, v104, v105
    v_cvt_pk_bf16_f32 v135, v106, v107
    v_mfma_f32_32x32x16_bf16 v[68:83], v[204:207], v[140:143], v[68:83]
    v_exp_f32 v108, v108
    v_exp_f32 v109, v109
    v_exp_f32 v110, v110
    v_exp_f32 v111, v111
    v_cvt_pk_bf16_f32 v136, v108, v109
    v_cvt_pk_bf16_f32 v137, v110, v111
    v_mfma_f32_32x32x16_bf16 v[68:83], v[208:211], v[144:147], v[68:83]
    buffer_load_dwordx4 v[184:187], v212, s[40:43], s77 offen offset:1024 sc1
    v_exp_f32 v112, v112
    v_exp_f32 v113, v113
    v_exp_f32 v114, v114
    v_exp_f32 v115, v115
    v_cvt_pk_bf16_f32 v138, v112, v113
    v_cvt_pk_bf16_f32 v139, v114, v115
    s_waitcnt vmcnt(6)
    v_mfma_f32_32x32x16_bf16 v[100:115], v[148:151], v[12:15], 0
    v_exp_f32 v116, v116
    v_exp_f32 v117, v117
    v_exp_f32 v118, v118
    v_exp_f32 v119, v119
    v_cvt_pk_bf16_f32 v140, v116, v117
    v_cvt_pk_bf16_f32 v141, v118, v119
    v_mfma_f32_32x32x16_bf16 v[100:115], v[152:155], v[16:19], v[100:115]
    v_exp_f32 v120, v120
    v_exp_f32 v121, v121
    v_exp_f32 v122, v122
    v_exp_f32 v123, v123
    v_cvt_pk_bf16_f32 v142, v120, v121
    v_cvt_pk_bf16_f32 v143, v122, v123
    v_mfma_f32_32x32x16_bf16 v[84:99], v[204:207], v[132:135], v[84:99]
    v_exp_f32 v124, v124
    v_exp_f32 v125, v125
    v_exp_f32 v126, v126
    v_exp_f32 v127, v127
    v_cvt_pk_bf16_f32 v144, v124, v125
    v_cvt_pk_bf16_f32 v145, v126, v127
    v_mfma_f32_32x32x16_bf16 v[84:99], v[208:211], v[136:139], v[84:99]
    buffer_load_dwordx4 v[188:191], v212, s[40:43], s77 offen offset:2048 sc1
    v_exp_f32 v128, v128
    v_exp_f32 v129, v129
    v_exp_f32 v130, v130
    v_exp_f32 v131, v131
    v_cvt_pk_bf16_f32 v146, v128, v129
    v_cvt_pk_bf16_f32 v147, v130, v131
    v_mfma_f32_32x32x16_bf16 v[116:131], v[148:151], v[20:23], 0
    v_exp_f32 v100, v100
    v_exp_f32 v101, v101
    v_exp_f32 v102, v102
    v_exp_f32 v103, v103
    v_cvt_pk_bf16_f32 v132, v100, v101
    v_cvt_pk_bf16_f32 v133, v102, v103
    v_mfma_f32_32x32x16_bf16 v[116:131], v[152:155], v[24:27], v[116:131]
    v_exp_f32 v104, v104
    v_exp_f32 v105, v105
    v_exp_f32 v106, v106
    v_exp_f32 v107, v107
    v_cvt_pk_bf16_f32 v134, v104, v105
    v_cvt_pk_bf16_f32 v135, v106, v107
    v_mfma_f32_32x32x16_bf16 v[36:51], v[204:207], v[140:143], v[36:51]
    v_exp_f32 v108, v108
    v_exp_f32 v109, v109
    v_exp_f32 v110, v110
    v_exp_f32 v111, v111
    v_cvt_pk_bf16_f32 v136, v108, v109
    v_cvt_pk_bf16_f32 v137, v110, v111
    v_mfma_f32_32x32x16_bf16 v[36:51], v[208:211], v[144:147], v[36:51]
    buffer_load_dwordx4 v[192:195], v212, s[40:43], s77 offen offset:3072 sc1
    s_add_u32 s77, s77, 4096
    v_exp_f32 v112, v112
    v_exp_f32 v113, v113
    v_exp_f32 v114, v114
    v_exp_f32 v115, v115
    v_cvt_pk_bf16_f32 v138, v112, v113
    v_cvt_pk_bf16_f32 v139, v114, v115
    v_mfma_f32_32x32x16_bf16 v[100:115], v[148:151], v[28:31], 0
    v_exp_f32 v116, v116
    v_exp_f32 v117, v117
    v_exp_f32 v118, v118
    v_exp_f32 v119, v119
    v_cvt_pk_bf16_f32 v140, v116, v117
    v_cvt_pk_bf16_f32 v141, v118, v119
    v_mfma_f32_32x32x16_bf16 v[100:115], v[152:155], v[32:35], v[100:115]
    v_exp_f32 v120, v120
    v_exp_f32 v121, v121
    v_exp_f32 v122, v122
    v_exp_f32 v123, v123
    v_cvt_pk_bf16_f32 v142, v120, v121
    v_cvt_pk_bf16_f32 v143, v122, v123
    v_mfma_f32_32x32x16_bf16 v[52:67], v[156:159], v[132:135], v[52:67]
    v_exp_f32 v124, v124
    v_exp_f32 v125, v125
    v_exp_f32 v126, v126
    v_exp_f32 v127, v127
    v_cvt_pk_bf16_f32 v144, v124, v125
    v_cvt_pk_bf16_f32 v145, v126, v127
    v_mfma_f32_32x32x16_bf16 v[52:67], v[160:163], v[136:139], v[52:67]
    buffer_load_dwordx4 v[196:199], v212, s[40:43], s77 offen offset:0 sc1
    v_exp_f32 v128, v128
    v_exp_f32 v129, v129
    v_exp_f32 v130, v130
    v_exp_f32 v131, v131
    v_cvt_pk_bf16_f32 v146, v128, v129
    v_cvt_pk_bf16_f32 v147, v130, v131
    v_mfma_f32_32x32x16_bf16 v[116:131], v[148:151], v[4:7], 0
    v_exp_f32 v100, v100
    v_exp_f32 v101, v101
    v_exp_f32 v102, v102
    v_exp_f32 v103, v103
    v_cvt_pk_bf16_f32 v132, v100, v101
    v_cvt_pk_bf16_f32 v133, v102, v103
    v_mfma_f32_32x32x16_bf16 v[116:131], v[152:155], v[8:11], v[116:131]
    v_exp_f32 v104, v104
    v_exp_f32 v105, v105
    v_exp_f32 v106, v106
    v_exp_f32 v107, v107
    v_cvt_pk_bf16_f32 v134, v104, v105
    v_cvt_pk_bf16_f32 v135, v106, v107
    v_mfma_f32_32x32x16_bf16 v[68:83], v[156:159], v[140:143], v[68:83]
    v_exp_f32 v108, v108
    v_exp_f32 v109, v109
    v_exp_f32 v110, v110
    v_exp_f32 v111, v111
    v_cvt_pk_bf16_f32 v136, v108, v109
    v_cvt_pk_bf16_f32 v137, v110, v111
    v_mfma_f32_32x32x16_bf16 v[68:83], v[160:163], v[144:147], v[68:83]
    buffer_load_dwordx4 v[200:203], v212, s[40:43], s77 offen offset:1024 sc1
    v_exp_f32 v112, v112
    v_exp_f32 v113, v113
    v_exp_f32 v114, v114
    v_exp_f32 v115, v115
    v_cvt_pk_bf16_f32 v138, v112, v113
    v_cvt_pk_bf16_f32 v139, v114, v115
    s_waitcnt vmcnt(6)
    v_mfma_f32_32x32x16_bf16 v[100:115], v[164:167], v[12:15], 0
    v_exp_f32 v116, v116
    v_exp_f32 v117, v117
    v_exp_f32 v118, v118
    v_exp_f32 v119, v119
    v_cvt_pk_bf16_f32 v140, v116, v117
    v_cvt_pk_bf16_f32 v141, v118, v119
    v_mfma_f32_32x32x16_bf16 v[100:115], v[168:171], v[16:19], v[100:115]
    v_exp_f32 v120, v120
    v_exp_f32 v121, v121
    v_exp_f32 v122, v122
    v_exp_f32 v123, v123
    v_cvt_pk_bf16_f32 v142, v120, v121
    v_cvt_pk_bf16_f32 v143, v122, v123
    v_mfma_f32_32x32x16_bf16 v[84:99], v[156:159], v[132:135], v[84:99]
    v_exp_f32 v124, v124
    v_exp_f32 v125, v125
    v_exp_f32 v126, v126
    v_exp_f32 v127, v127
    v_cvt_pk_bf16_f32 v144, v124, v125
    v_cvt_pk_bf16_f32 v145, v126, v127
    v_mfma_f32_32x32x16_bf16 v[84:99], v[160:163], v[136:139], v[84:99]
    buffer_load_dwordx4 v[204:207], v212, s[40:43], s77 offen offset:2048 sc1
    v_exp_f32 v128, v128
    v_exp_f32 v129, v129
    v_exp_f32 v130, v130
    v_exp_f32 v131, v131
    v_cvt_pk_bf16_f32 v146, v128, v129
    v_cvt_pk_bf16_f32 v147, v130, v131
    v_mfma_f32_32x32x16_bf16 v[116:131], v[164:167], v[20:23], 0
    v_exp_f32 v100, v100
    v_exp_f32 v101, v101
    v_exp_f32 v102, v102
    v_exp_f32 v103, v103
    v_cvt_pk_bf16_f32 v132, v100, v101
    v_cvt_pk_bf16_f32 v133, v102, v103
    v_mfma_f32_32x32x16_bf16 v[116:131], v[168:171], v[24:27], v[116:131]
    v_exp_f32 v104, v104
    v_exp_f32 v105, v105
    v_exp_f32 v106, v106
    v_exp_f32 v107, v107
    v_cvt_pk_bf16_f32 v134, v104, v105
    v_cvt_pk_bf16_f32 v135, v106, v107
    v_mfma_f32_32x32x16_bf16 v[36:51], v[156:159], v[140:143], v[36:51]
    v_exp_f32 v108, v108
    v_exp_f32 v109, v109
    v_exp_f32 v110, v110
    v_exp_f32 v111, v111
    v_cvt_pk_bf16_f32 v136, v108, v109
    v_cvt_pk_bf16_f32 v137, v110, v111
    v_mfma_f32_32x32x16_bf16 v[36:51], v[160:163], v[144:147], v[36:51]
    buffer_load_dwordx4 v[208:211], v212, s[40:43], s77 offen offset:3072 sc1
    s_add_u32 s77, s77, 4096
    v_exp_f32 v112, v112
    v_exp_f32 v113, v113
    v_exp_f32 v114, v114
    v_exp_f32 v115, v115
    v_cvt_pk_bf16_f32 v138, v112, v113
    v_cvt_pk_bf16_f32 v139, v114, v115
    v_mfma_f32_32x32x16_bf16 v[100:115], v[164:167], v[28:31], 0
    v_exp_f32 v116, v116
    v_exp_f32 v117, v117
    v_exp_f32 v118, v118
    v_exp_f32 v119, v119
    v_cvt_pk_bf16_f32 v140, v116, v117
    v_cvt_pk_bf16_f32 v141, v118, v119
    v_mfma_f32_32x32x16_bf16 v[100:115], v[168:171], v[32:35], v[100:115]
    v_exp_f32 v120, v120
    v_exp_f32 v121, v121
    v_exp_f32 v122, v122
    v_exp_f32 v123, v123
    v_cvt_pk_bf16_f32 v142, v120, v121
    v_cvt_pk_bf16_f32 v143, v122, v123
    v_mfma_f32_32x32x16_bf16 v[52:67], v[172:175], v[132:135], v[52:67]
    v_exp_f32 v124, v124
    v_exp_f32 v125, v125
    v_exp_f32 v126, v126
    v_exp_f32 v127, v127
    v_cvt_pk_bf16_f32 v144, v124, v125
    v_cvt_pk_bf16_f32 v145, v126, v127
    v_mfma_f32_32x32x16_bf16 v[52:67], v[176:179], v[136:139], v[52:67]
    buffer_load_dwordx4 v[148:151], v212, s[40:43], s77 offen offset:0 sc1
    v_exp_f32 v128, v128
    v_exp_f32 v129, v129
    v_exp_f32 v130, v130
    v_exp_f32 v131, v131
    v_cvt_pk_bf16_f32 v146, v128, v129
    v_cvt_pk_bf16_f32 v147, v130, v131
    v_mfma_f32_32x32x16_bf16 v[116:131], v[164:167], v[4:7], 0
    v_exp_f32 v100, v100
    v_exp_f32 v101, v101
    v_exp_f32 v102, v102
    v_exp_f32 v103, v103
    v_cvt_pk_bf16_f32 v132, v100, v101
    v_cvt_pk_bf16_f32 v133, v102, v103
    v_mfma_f32_32x32x16_bf16 v[116:131], v[168:171], v[8:11], v[116:131]
    v_exp_f32 v104, v104
    v_exp_f32 v105, v105
    v_exp_f32 v106, v106
    v_exp_f32 v107, v107
    v_cvt_pk_bf16_f32 v134, v104, v105
    v_cvt_pk_bf16_f32 v135, v106, v107
    v_mfma_f32_32x32x16_bf16 v[68:83], v[172:175], v[140:143], v[68:83]
    v_exp_f32 v108, v108
    v_exp_f32 v109, v109
    v_exp_f32 v110, v110
    v_exp_f32 v111, v111
    v_cvt_pk_bf16_f32 v136, v108, v109
    v_cvt_pk_bf16_f32 v137, v110, v111
    v_mfma_f32_32x32x16_bf16 v[68:83], v[176:179], v[144:147], v[68:83]
    buffer_load_dwordx4 v[152:155], v212, s[40:43], s77 offen offset:1024 sc1
    v_exp_f32 v112, v112
    v_exp_f32 v113, v113
    v_exp_f32 v114, v114
    v_exp_f32 v115, v115
    v_cvt_pk_bf16_f32 v138, v112, v113
    v_cvt_pk_bf16_f32 v139, v114, v115
    s_waitcnt vmcnt(6)
    v_mfma_f32_32x32x16_bf16 v[100:115], v[180:183], v[12:15], 0
    v_exp_f32 v116, v116
    v_exp_f32 v117, v117
    v_exp_f32 v118, v118
    v_exp_f32 v119, v119
    v_cvt_pk_bf16_f32 v140, v116, v117
    v_cvt_pk_bf16_f32 v141, v118, v119
    v_mfma_f32_32x32x16_bf16 v[100:115], v[184:187], v[16:19], v[100:115]
    v_exp_f32 v120, v120
    v_exp_f32 v121, v121
    v_exp_f32 v122, v122
    v_exp_f32 v123, v123
    v_cvt_pk_bf16_f32 v142, v120, v121
    v_cvt_pk_bf16_f32 v143, v122, v123
    v_mfma_f32_32x32x16_bf16 v[84:99], v[172:175], v[132:135], v[84:99]
    v_exp_f32 v124, v124
    v_exp_f32 v125, v125
    v_exp_f32 v126, v126
    v_exp_f32 v127, v127
    v_cvt_pk_bf16_f32 v144, v124, v125
    v_cvt_pk_bf16_f32 v145, v126, v127
    v_mfma_f32_32x32x16_bf16 v[84:99], v[176:179], v[136:139], v[84:99]
    buffer_load_dwordx4 v[156:159], v212, s[40:43], s77 offen offset:2048 sc1
    v_exp_f32 v128, v128
    v_exp_f32 v129, v129
    v_exp_f32 v130, v130
    v_exp_f32 v131, v131
    v_cvt_pk_bf16_f32 v146, v128, v129
    v_cvt_pk_bf16_f32 v147, v130, v131
    v_mfma_f32_32x32x16_bf16 v[116:131], v[180:183], v[20:23], 0
    v_exp_f32 v100, v100
    v_exp_f32 v101, v101
    v_exp_f32 v102, v102
    v_exp_f32 v103, v103
    v_cvt_pk_bf16_f32 v132, v100, v101
    v_cvt_pk_bf16_f32 v133, v102, v103
    v_mfma_f32_32x32x16_bf16 v[116:131], v[184:187], v[24:27], v[116:131]
    v_exp_f32 v104, v104
    v_exp_f32 v105, v105
    v_exp_f32 v106, v106
    v_exp_f32 v107, v107
    v_cvt_pk_bf16_f32 v134, v104, v105
    v_cvt_pk_bf16_f32 v135, v106, v107
    v_mfma_f32_32x32x16_bf16 v[36:51], v[172:175], v[140:143], v[36:51]
    v_exp_f32 v108, v108
    v_exp_f32 v109, v109
    v_exp_f32 v110, v110
    v_exp_f32 v111, v111
    v_cvt_pk_bf16_f32 v136, v108, v109
    v_cvt_pk_bf16_f32 v137, v110, v111
    v_mfma_f32_32x32x16_bf16 v[36:51], v[176:179], v[144:147], v[36:51]
    buffer_load_dwordx4 v[160:163], v212, s[40:43], s77 offen offset:3072 sc1
    s_add_u32 s77, s77, 4096
    v_exp_f32 v112, v112
    v_exp_f32 v113, v113
    v_exp_f32 v114, v114
    v_exp_f32 v115, v115
    v_cvt_pk_bf16_f32 v138, v112, v113
    v_cvt_pk_bf16_f32 v139, v114, v115
    v_mfma_f32_32x32x16_bf16 v[100:115], v[180:183], v[28:31], 0
    v_exp_f32 v116, v116
    v_exp_f32 v117, v117
    v_exp_f32 v118, v118
    v_exp_f32 v119, v119
    v_cvt_pk_bf16_f32 v140, v116, v117
    v_cvt_pk_bf16_f32 v141, v118, v119
    v_mfma_f32_32x32x16_bf16 v[100:115], v[184:187], v[32:35], v[100:115]
    v_exp_f32 v120, v120
    v_exp_f32 v121, v121
    v_exp_f32 v122, v122
    v_exp_f32 v123, v123
    v_cvt_pk_bf16_f32 v142, v120, v121
    v_cvt_pk_bf16_f32 v143, v122, v123
    v_mfma_f32_32x32x16_bf16 v[52:67], v[188:191], v[132:135], v[52:67]
    v_exp_f32 v124, v124
    v_exp_f32 v125, v125
    v_exp_f32 v126, v126
    v_exp_f32 v127, v127
    v_cvt_pk_bf16_f32 v144, v124, v125
    v_cvt_pk_bf16_f32 v145, v126, v127
    v_mfma_f32_32x32x16_bf16 v[52:67], v[192:195], v[136:139], v[52:67]
    buffer_load_dwordx4 v[164:167], v212, s[40:43], s77 offen offset:0 sc1
    v_exp_f32 v128, v128
    v_exp_f32 v129, v129
    v_exp_f32 v130, v130
    v_exp_f32 v131, v131
    v_cvt_pk_bf16_f32 v146, v128, v129
    v_cvt_pk_bf16_f32 v147, v130, v131
    v_mfma_f32_32x32x16_bf16 v[116:131], v[180:183], v[4:7], 0
    v_exp_f32 v100, v100
    v_exp_f32 v101, v101
    v_exp_f32 v102, v102
    v_exp_f32 v103, v103
    v_cvt_pk_bf16_f32 v132, v100, v101
    v_cvt_pk_bf16_f32 v133, v102, v103
    v_mfma_f32_32x32x16_bf16 v[116:131], v[184:187], v[8:11], v[116:131]
    v_exp_f32 v104, v104
    v_exp_f32 v105, v105
    v_exp_f32 v106, v106
    v_exp_f32 v107, v107
    v_cvt_pk_bf16_f32 v134, v104, v105
    v_cvt_pk_bf16_f32 v135, v106, v107
    v_mfma_f32_32x32x16_bf16 v[68:83], v[188:191], v[140:143], v[68:83]
    v_exp_f32 v108, v108
    v_exp_f32 v109, v109
    v_exp_f32 v110, v110
    v_exp_f32 v111, v111
    v_cvt_pk_bf16_f32 v136, v108, v109
    v_cvt_pk_bf16_f32 v137, v110, v111
    v_mfma_f32_32x32x16_bf16 v[68:83], v[192:195], v[144:147], v[68:83]
    buffer_load_dwordx4 v[168:171], v212, s[40:43], s77 offen offset:1024 sc1
    v_exp_f32 v112, v112
    v_exp_f32 v113, v113
    v_exp_f32 v114, v114
    v_exp_f32 v115, v115
    v_cvt_pk_bf16_f32 v138, v112, v113
    v_cvt_pk_bf16_f32 v139, v114, v115
    s_waitcnt vmcnt(6)
    v_mfma_f32_32x32x16_bf16 v[100:115], v[196:199], v[12:15], 0
    v_exp_f32 v116, v116
    v_exp_f32 v117, v117
    v_exp_f32 v118, v118
    v_exp_f32 v119, v119
    v_cvt_pk_bf16_f32 v140, v116, v117
    v_cvt_pk_bf16_f32 v141, v118, v119
    v_mfma_f32_32x32x16_bf16 v[100:115], v[200:203], v[16:19], v[100:115]
    v_exp_f32 v120, v120
    v_exp_f32 v121, v121
    v_exp_f32 v122, v122
    v_exp_f32 v123, v123
    v_cvt_pk_bf16_f32 v142, v120, v121
    v_cvt_pk_bf16_f32 v143, v122, v123
    v_mfma_f32_32x32x16_bf16 v[84:99], v[188:191], v[132:135], v[84:99]
    v_exp_f32 v124, v124
    v_exp_f32 v125, v125
    v_exp_f32 v126, v126
    v_exp_f32 v127, v127
    v_cvt_pk_bf16_f32 v144, v124, v125
    v_cvt_pk_bf16_f32 v145, v126, v127
    v_mfma_f32_32x32x16_bf16 v[84:99], v[192:195], v[136:139], v[84:99]
    buffer_load_dwordx4 v[172:175], v212, s[40:43], s77 offen offset:2048 sc1
    v_exp_f32 v128, v128
    v_exp_f32 v129, v129
    v_exp_f32 v130, v130
    v_exp_f32 v131, v131
    v_cvt_pk_bf16_f32 v146, v128, v129
    v_cvt_pk_bf16_f32 v147, v130, v131
    v_mfma_f32_32x32x16_bf16 v[116:131], v[196:199], v[20:23], 0
    v_exp_f32 v100, v100
    v_exp_f32 v101, v101
    v_exp_f32 v102, v102
    v_exp_f32 v103, v103
    v_cvt_pk_bf16_f32 v132, v100, v101
    v_cvt_pk_bf16_f32 v133, v102, v103
    v_mfma_f32_32x32x16_bf16 v[116:131], v[200:203], v[24:27], v[116:131]
    v_exp_f32 v104, v104
    v_exp_f32 v105, v105
    v_exp_f32 v106, v106
    v_exp_f32 v107, v107
    v_cvt_pk_bf16_f32 v134, v104, v105
    v_cvt_pk_bf16_f32 v135, v106, v107
    v_mfma_f32_32x32x16_bf16 v[36:51], v[188:191], v[140:143], v[36:51]
    v_exp_f32 v108, v108
    v_exp_f32 v109, v109
    v_exp_f32 v110, v110
    v_exp_f32 v111, v111
    v_cvt_pk_bf16_f32 v136, v108, v109
    v_cvt_pk_bf16_f32 v137, v110, v111
    v_mfma_f32_32x32x16_bf16 v[36:51], v[192:195], v[144:147], v[36:51]
    buffer_load_dwordx4 v[176:179], v212, s[40:43], s77 offen offset:3072 sc1
    s_add_u32 s77, s77, 4096
    v_exp_f32 v112, v112
    v_exp_f32 v113, v113
    v_exp_f32 v114, v114
    v_exp_f32 v115, v115
    v_cvt_pk_bf16_f32 v138, v112, v113
    v_cvt_pk_bf16_f32 v139, v114, v115
    v_mfma_f32_32x32x16_bf16 v[100:115], v[196:199], v[28:31], 0
    v_exp_f32 v116, v116
    v_exp_f32 v117, v117
    v_exp_f32 v118, v118
    v_exp_f32 v119, v119
    v_cvt_pk_bf16_f32 v140, v116, v117
    v_cvt_pk_bf16_f32 v141, v118, v119
    v_mfma_f32_32x32x16_bf16 v[100:115], v[200:203], v[32:35], v[100:115]
    v_exp_f32 v120, v120
    v_exp_f32 v121, v121
    v_exp_f32 v122, v122
    v_exp_f32 v123, v123
    v_cvt_pk_bf16_f32 v142, v120, v121
    v_cvt_pk_bf16_f32 v143, v122, v123
    v_mfma_f32_32x32x16_bf16 v[52:67], v[204:207], v[132:135], v[52:67]
    v_exp_f32 v124, v124
    v_exp_f32 v125, v125
    v_exp_f32 v126, v126
    v_exp_f32 v127, v127
    v_cvt_pk_bf16_f32 v144, v124, v125
    v_cvt_pk_bf16_f32 v145, v126, v127
    v_mfma_f32_32x32x16_bf16 v[52:67], v[208:211], v[136:139], v[52:67]
    buffer_load_dwordx4 v[180:183], v212, s[40:43], s77 offen offset:0 sc1
    v_exp_f32 v128, v128
    v_exp_f32 v129, v129
    v_exp_f32 v130, v130
    v_exp_f32 v131, v131
    v_cvt_pk_bf16_f32 v146, v128, v129
    v_cvt_pk_bf16_f32 v147, v130, v131
    v_mfma_f32_32x32x16_bf16 v[116:131], v[196:199], v[4:7], 0
    v_exp_f32 v100, v100
    v_exp_f32 v101, v101
    v_exp_f32 v102, v102
    v_exp_f32 v103, v103
    v_cvt_pk_bf16_f32 v132, v100, v101
    v_cvt_pk_bf16_f32 v133, v102, v103
    v_mfma_f32_32x32x16_bf16 v[116:131], v[200:203], v[8:11], v[116:131]
    v_exp_f32 v104, v104
    v_exp_f32 v105, v105
    v_exp_f32 v106, v106
    v_exp_f32 v107, v107
    v_cvt_pk_bf16_f32 v134, v104, v105
    v_cvt_pk_bf16_f32 v135, v106, v107
    v_mfma_f32_32x32x16_bf16 v[68:83], v[204:207], v[140:143], v[68:83]
    v_exp_f32 v108, v108
    v_exp_f32 v109, v109
    v_exp_f32 v110, v110
    v_exp_f32 v111, v111
    v_cvt_pk_bf16_f32 v136, v108, v109
    v_cvt_pk_bf16_f32 v137, v110, v111
    v_mfma_f32_32x32x16_bf16 v[68:83], v[208:211], v[144:147], v[68:83]
    buffer_load_dwordx4 v[184:187], v212, s[40:43], s77 offen offset:1024 sc1
    v_exp_f32 v112, v112
    v_exp_f32 v113, v113
    v_exp_f32 v114, v114
    v_exp_f32 v115, v115
    v_cvt_pk_bf16_f32 v138, v112, v113
    v_cvt_pk_bf16_f32 v139, v114, v115
    s_waitcnt vmcnt(6)
    v_mfma_f32_32x32x16_bf16 v[100:115], v[148:151], v[12:15], 0
    v_exp_f32 v116, v116
    v_exp_f32 v117, v117
    v_exp_f32 v118, v118
    v_exp_f32 v119, v119
    v_cvt_pk_bf16_f32 v140, v116, v117
    v_cvt_pk_bf16_f32 v141, v118, v119
    v_mfma_f32_32x32x16_bf16 v[100:115], v[152:155], v[16:19], v[100:115]
    v_exp_f32 v120, v120
    v_exp_f32 v121, v121
    v_exp_f32 v122, v122
    v_exp_f32 v123, v123
    v_cvt_pk_bf16_f32 v142, v120, v121
    v_cvt_pk_bf16_f32 v143, v122, v123
    v_mfma_f32_32x32x16_bf16 v[84:99], v[204:207], v[132:135], v[84:99]
    v_exp_f32 v124, v124
    v_exp_f32 v125, v125
    v_exp_f32 v126, v126
    v_exp_f32 v127, v127
    v_cvt_pk_bf16_f32 v144, v124, v125
    v_cvt_pk_bf16_f32 v145, v126, v127
    v_mfma_f32_32x32x16_bf16 v[84:99], v[208:211], v[136:139], v[84:99]
    buffer_load_dwordx4 v[188:191], v212, s[40:43], s77 offen offset:2048 sc1
    v_exp_f32 v128, v128
    v_exp_f32 v129, v129
    v_exp_f32 v130, v130
    v_exp_f32 v131, v131
    v_cvt_pk_bf16_f32 v146, v128, v129
    v_cvt_pk_bf16_f32 v147, v130, v131
    v_mfma_f32_32x32x16_bf16 v[116:131], v[148:151], v[20:23], 0
    v_exp_f32 v100, v100
    v_exp_f32 v101, v101
    v_exp_f32 v102, v102
    v_exp_f32 v103, v103
    v_cvt_pk_bf16_f32 v132, v100, v101
    v_cvt_pk_bf16_f32 v133, v102, v103
    v_mfma_f32_32x32x16_bf16 v[116:131], v[152:155], v[24:27], v[116:131]
    v_exp_f32 v104, v104
    v_exp_f32 v105, v105
    v_exp_f32 v106, v106
    v_exp_f32 v107, v107
    v_cvt_pk_bf16_f32 v134, v104, v105
    v_cvt_pk_bf16_f32 v135, v106, v107
    v_mfma_f32_32x32x16_bf16 v[36:51], v[204:207], v[140:143], v[36:51]
    v_exp_f32 v108, v108
    v_exp_f32 v109, v109
    v_exp_f32 v110, v110
    v_exp_f32 v111, v111
    v_cvt_pk_bf16_f32 v136, v108, v109
    v_cvt_pk_bf16_f32 v137, v110, v111
    v_mfma_f32_32x32x16_bf16 v[36:51], v[208:211], v[144:147], v[36:51]
    buffer_load_dwordx4 v[192:195], v212, s[40:43], s77 offen offset:3072 sc1
    s_add_u32 s77, s77, 4096
    v_exp_f32 v112, v112
    v_exp_f32 v113, v113
    v_exp_f32 v114, v114
    v_exp_f32 v115, v115
    v_cvt_pk_bf16_f32 v138, v112, v113
    v_cvt_pk_bf16_f32 v139, v114, v115
    v_mfma_f32_32x32x16_bf16 v[100:115], v[148:151], v[28:31], 0
    v_exp_f32 v116, v116
    v_exp_f32 v117, v117
    v_exp_f32 v118, v118
    v_exp_f32 v119, v119
    v_cvt_pk_bf16_f32 v140, v116, v117
    v_cvt_pk_bf16_f32 v141, v118, v119
    v_mfma_f32_32x32x16_bf16 v[100:115], v[152:155], v[32:35], v[100:115]
    v_exp_f32 v120, v120
    v_exp_f32 v121, v121
    v_exp_f32 v122, v122
    v_exp_f32 v123, v123
    v_cvt_pk_bf16_f32 v142, v120, v121
    v_cvt_pk_bf16_f32 v143, v122, v123
    v_mfma_f32_32x32x16_bf16 v[52:67], v[156:159], v[132:135], v[52:67]
    v_exp_f32 v124, v124
    v_exp_f32 v125, v125
    v_exp_f32 v126, v126
    v_exp_f32 v127, v127
    v_cvt_pk_bf16_f32 v144, v124, v125
    v_cvt_pk_bf16_f32 v145, v126, v127
    v_mfma_f32_32x32x16_bf16 v[52:67], v[160:163], v[136:139], v[52:67]
    buffer_load_dwordx4 v[196:199], v212, s[40:43], s77 offen offset:0 sc1
    v_exp_f32 v128, v128
    v_exp_f32 v129, v129
    v_exp_f32 v130, v130
    v_exp_f32 v131, v131
    v_cvt_pk_bf16_f32 v146, v128, v129
    v_cvt_pk_bf16_f32 v147, v130, v131
    v_mfma_f32_32x32x16_bf16 v[116:131], v[148:151], v[4:7], 0
    v_exp_f32 v100, v100
    v_exp_f32 v101, v101
    v_exp_f32 v102, v102
    v_exp_f32 v103, v103
    v_cvt_pk_bf16_f32 v132, v100, v101
    v_cvt_pk_bf16_f32 v133, v102, v103
    v_mfma_f32_32x32x16_bf16 v[116:131], v[152:155], v[8:11], v[116:131]
    v_exp_f32 v104, v104
    v_exp_f32 v105, v105
    v_exp_f32 v106, v106
    v_exp_f32 v107, v107
    v_cvt_pk_bf16_f32 v134, v104, v105
    v_cvt_pk_bf16_f32 v135, v106, v107
    v_mfma_f32_32x32x16_bf16 v[68:83], v[156:159], v[140:143], v[68:83]
    v_exp_f32 v108, v108
    v_exp_f32 v109, v109
    v_exp_f32 v110, v110
    v_exp_f32 v111, v111
    v_cvt_pk_bf16_f32 v136, v108, v109
    v_cvt_pk_bf16_f32 v137, v110, v111
    v_mfma_f32_32x32x16_bf16 v[68:83], v[160:163], v[144:147], v[68:83]
    buffer_load_dwordx4 v[200:203], v212, s[40:43], s77 offen offset:1024 sc1
    v_exp_f32 v112, v112
    v_exp_f32 v113, v113
    v_exp_f32 v114, v114
    v_exp_f32 v115, v115
    v_cvt_pk_bf16_f32 v138, v112, v113
    v_cvt_pk_bf16_f32 v139, v114, v115
    s_waitcnt vmcnt(6)
    v_mfma_f32_32x32x16_bf16 v[100:115], v[164:167], v[12:15], 0
    v_exp_f32 v116, v116
    v_exp_f32 v117, v117
    v_exp_f32 v118, v118
    v_exp_f32 v119, v119
    v_cvt_pk_bf16_f32 v140, v116, v117
    v_cvt_pk_bf16_f32 v141, v118, v119
    v_mfma_f32_32x32x16_bf16 v[100:115], v[168:171], v[16:19], v[100:115]
    v_exp_f32 v120, v120
    v_exp_f32 v121, v121
    v_exp_f32 v122, v122
    v_exp_f32 v123, v123
    v_cvt_pk_bf16_f32 v142, v120, v121
    v_cvt_pk_bf16_f32 v143, v122, v123
    v_mfma_f32_32x32x16_bf16 v[84:99], v[156:159], v[132:135], v[84:99]
    v_exp_f32 v124, v124
    v_exp_f32 v125, v125
    v_exp_f32 v126, v126
    v_exp_f32 v127, v127
    v_cvt_pk_bf16_f32 v144, v124, v125
    v_cvt_pk_bf16_f32 v145, v126, v127
    v_mfma_f32_32x32x16_bf16 v[84:99], v[160:163], v[136:139], v[84:99]
    buffer_load_dwordx4 v[204:207], v212, s[40:43], s77 offen offset:2048 sc1
    v_exp_f32 v128, v128
    v_exp_f32 v129, v129
    v_exp_f32 v130, v130
    v_exp_f32 v131, v131
    v_cvt_pk_bf16_f32 v146, v128, v129
    v_cvt_pk_bf16_f32 v147, v130, v131
    v_mfma_f32_32x32x16_bf16 v[116:131], v[164:167], v[20:23], 0
    v_exp_f32 v100, v100
    v_exp_f32 v101, v101
    v_exp_f32 v102, v102
    v_exp_f32 v103, v103
    v_cvt_pk_bf16_f32 v132, v100, v101
    v_cvt_pk_bf16_f32 v133, v102, v103
    v_mfma_f32_32x32x16_bf16 v[116:131], v[168:171], v[24:27], v[116:131]
    v_exp_f32 v104, v104
    v_exp_f32 v105, v105
    v_exp_f32 v106, v106
    v_exp_f32 v107, v107
    v_cvt_pk_bf16_f32 v134, v104, v105
    v_cvt_pk_bf16_f32 v135, v106, v107
    v_mfma_f32_32x32x16_bf16 v[36:51], v[156:159], v[140:143], v[36:51]
    v_exp_f32 v108, v108
    v_exp_f32 v109, v109
    v_exp_f32 v110, v110
    v_exp_f32 v111, v111
    v_cvt_pk_bf16_f32 v136, v108, v109
    v_cvt_pk_bf16_f32 v137, v110, v111
    v_mfma_f32_32x32x16_bf16 v[36:51], v[160:163], v[144:147], v[36:51]
    buffer_load_dwordx4 v[208:211], v212, s[40:43], s77 offen offset:3072 sc1
    s_add_u32 s77, s77, 4096
    ds_read_b32 v217, v216
    v_exp_f32 v112, v112
    v_exp_f32 v113, v113
    v_exp_f32 v114, v114
    v_exp_f32 v115, v115
    v_cvt_pk_bf16_f32 v138, v112, v113
    v_cvt_pk_bf16_f32 v139, v114, v115
    v_mfma_f32_32x32x16_bf16 v[100:115], v[164:167], v[28:31], 0
    v_exp_f32 v116, v116
    v_exp_f32 v117, v117
    v_exp_f32 v118, v118
    v_exp_f32 v119, v119
    v_cvt_pk_bf16_f32 v140, v116, v117
    v_cvt_pk_bf16_f32 v141, v118, v119
    v_mfma_f32_32x32x16_bf16 v[100:115], v[168:171], v[32:35], v[100:115]
    v_exp_f32 v120, v120
    v_exp_f32 v121, v121
    v_exp_f32 v122, v122
    v_exp_f32 v123, v123
    v_cvt_pk_bf16_f32 v142, v120, v121
    v_cvt_pk_bf16_f32 v143, v122, v123
    v_mfma_f32_32x32x16_bf16 v[52:67], v[172:175], v[132:135], v[52:67]
    v_exp_f32 v124, v124
    v_exp_f32 v125, v125
    v_exp_f32 v126, v126
    v_exp_f32 v127, v127
    v_cvt_pk_bf16_f32 v144, v124, v125
    v_cvt_pk_bf16_f32 v145, v126, v127
    v_mfma_f32_32x32x16_bf16 v[52:67], v[176:179], v[136:139], v[52:67]
    v_exp_f32 v128, v128
    v_exp_f32 v129, v129
    v_exp_f32 v130, v130
    v_exp_f32 v131, v131
    v_cvt_pk_bf16_f32 v146, v128, v129
    v_cvt_pk_bf16_f32 v147, v130, v131
    v_mfma_f32_32x32x16_bf16 v[116:131], v[164:167], v[4:7], 0
    v_exp_f32 v100, v100
    v_exp_f32 v101, v101
    v_exp_f32 v102, v102
    v_exp_f32 v103, v103
    v_cvt_pk_bf16_f32 v132, v100, v101
    v_cvt_pk_bf16_f32 v133, v102, v103
    v_mfma_f32_32x32x16_bf16 v[116:131], v[168:171], v[8:11], v[116:131]
    v_exp_f32 v104, v104
    v_exp_f32 v105, v105
    v_exp_f32 v106, v106
    v_exp_f32 v107, v107
    v_cvt_pk_bf16_f32 v134, v104, v105
    v_cvt_pk_bf16_f32 v135, v106, v107
    v_mfma_f32_32x32x16_bf16 v[68:83], v[172:175], v[140:143], v[68:83]
    v_exp_f32 v108, v108
    v_exp_f32 v109, v109
    v_exp_f32 v110, v110
    v_exp_f32 v111, v111
    v_cvt_pk_bf16_f32 v136, v108, v109
    v_cvt_pk_bf16_f32 v137, v110, v111
    v_mfma_f32_32x32x16_bf16 v[68:83], v[176:179], v[144:147], v[68:83]
    v_exp_f32 v112, v112
    v_exp_f32 v113, v113
    v_exp_f32 v114, v114
    v_exp_f32 v115, v115
    v_cvt_pk_bf16_f32 v138, v112, v113
    v_cvt_pk_bf16_f32 v139, v114, v115
    s_waitcnt vmcnt(4)
    v_mfma_f32_32x32x16_bf16 v[100:115], v[180:183], v[12:15], 0
    v_exp_f32 v116, v116
    v_exp_f32 v117, v117
    v_exp_f32 v118, v118
    v_exp_f32 v119, v119
    v_cvt_pk_bf16_f32 v140, v116, v117
    v_cvt_pk_bf16_f32 v141, v118, v119
    v_mfma_f32_32x32x16_bf16 v[100:115], v[184:187], v[16:19], v[100:115]
    v_exp_f32 v120, v120
    v_exp_f32 v121, v121
    v_exp_f32 v122, v122
    v_exp_f32 v123, v123
    v_cvt_pk_bf16_f32 v142, v120, v121
    v_cvt_pk_bf16_f32 v143, v122, v123
    v_mfma_f32_32x32x16_bf16 v[84:99], v[172:175], v[132:135], v[84:99]
    v_exp_f32 v124, v124
    v_exp_f32 v125, v125
    v_exp_f32 v126, v126
    v_exp_f32 v127, v127
    v_cvt_pk_bf16_f32 v144, v124, v125
    v_cvt_pk_bf16_f32 v145, v126, v127
    v_mfma_f32_32x32x16_bf16 v[84:99], v[176:179], v[136:139], v[84:99]
    v_exp_f32 v128, v128
    v_exp_f32 v129, v129
    v_exp_f32 v130, v130
    v_exp_f32 v131, v131
    v_cvt_pk_bf16_f32 v146, v128, v129
    v_cvt_pk_bf16_f32 v147, v130, v131
    v_mfma_f32_32x32x16_bf16 v[116:131], v[180:183], v[20:23], 0
    v_exp_f32 v100, v100
    v_exp_f32 v101, v101
    v_exp_f32 v102, v102
    v_exp_f32 v103, v103
    v_cvt_pk_bf16_f32 v132, v100, v101
    v_cvt_pk_bf16_f32 v133, v102, v103
    v_mfma_f32_32x32x16_bf16 v[116:131], v[184:187], v[24:27], v[116:131]
    v_exp_f32 v104, v104
    v_exp_f32 v105, v105
    v_exp_f32 v106, v106
    v_exp_f32 v107, v107
    v_cvt_pk_bf16_f32 v134, v104, v105
    v_cvt_pk_bf16_f32 v135, v106, v107
    v_mfma_f32_32x32x16_bf16 v[36:51], v[172:175], v[140:143], v[36:51]
    v_exp_f32 v108, v108
    v_exp_f32 v109, v109
    v_exp_f32 v110, v110
    v_exp_f32 v111, v111
    v_cvt_pk_bf16_f32 v136, v108, v109
    v_cvt_pk_bf16_f32 v137, v110, v111
    v_mfma_f32_32x32x16_bf16 v[36:51], v[176:179], v[144:147], v[36:51]
    v_exp_f32 v112, v112
    v_exp_f32 v113, v113
    v_exp_f32 v114, v114
    v_exp_f32 v115, v115
    v_cvt_pk_bf16_f32 v138, v112, v113
    v_cvt_pk_bf16_f32 v139, v114, v115
    v_mfma_f32_32x32x16_bf16 v[100:115], v[180:183], v[28:31], 0
    v_exp_f32 v116, v116
    v_exp_f32 v117, v117
    v_exp_f32 v118, v118
    v_exp_f32 v119, v119
    v_cvt_pk_bf16_f32 v140, v116, v117
    v_cvt_pk_bf16_f32 v141, v118, v119
    v_mfma_f32_32x32x16_bf16 v[100:115], v[184:187], v[32:35], v[100:115]
    v_exp_f32 v120, v120
    v_exp_f32 v121, v121
    v_exp_f32 v122, v122
    v_exp_f32 v123, v123
    v_cvt_pk_bf16_f32 v142, v120, v121
    v_cvt_pk_bf16_f32 v143, v122, v123
    v_mfma_f32_32x32x16_bf16 v[52:67], v[188:191], v[132:135], v[52:67]
    v_exp_f32 v124, v124
    v_exp_f32 v125, v125
    v_exp_f32 v126, v126
    v_exp_f32 v127, v127
    v_cvt_pk_bf16_f32 v144, v124, v125
    v_cvt_pk_bf16_f32 v145, v126, v127
    v_mfma_f32_32x32x16_bf16 v[52:67], v[192:195], v[136:139], v[52:67]
    v_exp_f32 v128, v128
    v_exp_f32 v129, v129
    v_exp_f32 v130, v130
    v_exp_f32 v131, v131
    v_cvt_pk_bf16_f32 v146, v128, v129
    v_cvt_pk_bf16_f32 v147, v130, v131
    v_mfma_f32_32x32x16_bf16 v[116:131], v[180:183], v[4:7], 0
    v_exp_f32 v100, v100
    v_exp_f32 v101, v101
    v_exp_f32 v102, v102
    v_exp_f32 v103, v103
    v_cvt_pk_bf16_f32 v132, v100, v101
    v_cvt_pk_bf16_f32 v133, v102, v103
    v_mfma_f32_32x32x16_bf16 v[116:131], v[184:187], v[8:11], v[116:131]
    v_exp_f32 v104, v104
    v_exp_f32 v105, v105
    v_exp_f32 v106, v106
    v_exp_f32 v107, v107
    v_cvt_pk_bf16_f32 v134, v104, v105
    v_cvt_pk_bf16_f32 v135, v106, v107
    v_mfma_f32_32x32x16_bf16 v[68:83], v[188:191], v[140:143], v[68:83]
    v_exp_f32 v108, v108
    v_exp_f32 v109, v109
    v_exp_f32 v110, v110
    v_exp_f32 v111, v111
    v_cvt_pk_bf16_f32 v136, v108, v109
    v_cvt_pk_bf16_f32 v137, v110, v111
    v_mfma_f32_32x32x16_bf16 v[68:83], v[192:195], v[144:147], v[68:83]
    s_waitcnt lgkmcnt(0)
    v_readfirstlane_b32 s48, v217
    s_cmp_ge_u32 s48, 4
    s_cbranch_scc1 L_brok_16
    v_mov_b32 v216, 163592
    s_mov_b32 s80, 0
L_ev_17:
    ds_read_b32 v217, v216
    s_add_u32 s80, s80, 1
    s_waitcnt lgkmcnt(0)
    v_readfirstlane_b32 s48, v217
    s_cmp_ge_u32 s80, 0x400000
    s_cbranch_scc1 L_eve_18
    s_cmp_lt_u32 s48, 4
    s_cbranch_scc1 L_ev_17
L_eve_18:
L_brok_16:
    v_exp_f32 v112, v112
    v_exp_f32 v113, v113
    v_exp_f32 v114, v114
    v_exp_f32 v115, v115
    v_cvt_pk_bf16_f32 v138, v112, v113
    v_cvt_pk_bf16_f32 v139, v114, v115
    s_waitcnt vmcnt(0)
    v_mfma_f32_32x32x16_bf16 v[100:115], v[196:199], v[12:15], 0
    v_exp_f32 v116, v116
    v_exp_f32 v117, v117
    v_exp_f32 v118, v118
    v_exp_f32 v119, v119
    v_cvt_pk_bf16_f32 v140, v116, v117
    v_cvt_pk_bf16_f32 v141, v118, v119
    v_mfma_f32_32x32x16_bf16 v[100:115], v[200:203], v[16:19], v[100:115]
    v_exp_f32 v120, v120
    v_exp_f32 v121, v121
    v_exp_f32 v122, v122
    v_exp_f32 v123, v123
    v_cvt_pk_bf16_f32 v142, v120, v121
    v_cvt_pk_bf16_f32 v143, v122, v123
    v_mfma_f32_32x32x16_bf16 v[84:99], v[188:191], v[132:135], v[84:99]
    v_exp_f32 v124, v124
    v_exp_f32 v125, v125
    v_exp_f32 v126, v126
    v_exp_f32 v127, v127
    v_cvt_pk_bf16_f32 v144, v124, v125
    v_cvt_pk_bf16_f32 v145, v126, v127
    v_mfma_f32_32x32x16_bf16 v[84:99], v[192:195], v[136:139], v[84:99]
    v_exp_f32 v128, v128
    v_exp_f32 v129, v129
    v_exp_f32 v130, v130
    v_exp_f32 v131, v131
    v_cvt_pk_bf16_f32 v146, v128, v129
    v_cvt_pk_bf16_f32 v147, v130, v131
    v_mfma_f32_32x32x16_bf16 v[116:131], v[196:199], v[20:23], 0
    v_exp_f32 v100, v100
    v_exp_f32 v101, v101
    v_exp_f32 v102, v102
    v_exp_f32 v103, v103
    v_cvt_pk_bf16_f32 v132, v100, v101
    v_cvt_pk_bf16_f32 v133, v102, v103
    v_mfma_f32_32x32x16_bf16 v[116:131], v[200:203], v[24:27], v[116:131]
    v_exp_f32 v104, v104
    v_exp_f32 v105, v105
    v_exp_f32 v106, v106
    v_exp_f32 v107, v107
    v_cvt_pk_bf16_f32 v134, v104, v105
    v_cvt_pk_bf16_f32 v135, v106, v107
    v_mfma_f32_32x32x16_bf16 v[36:51], v[188:191], v[140:143], v[36:51]
    v_exp_f32 v108, v108
    v_exp_f32 v109, v109
    v_exp_f32 v110, v110
    v_exp_f32 v111, v111
    v_cvt_pk_bf16_f32 v136, v108, v109
    v_cvt_pk_bf16_f32 v137, v110, v111
    v_mfma_f32_32x32x16_bf16 v[36:51], v[192:195], v[144:147], v[36:51]
    v_exp_f32 v112, v112
    v_exp_f32 v113, v113
    v_exp_f32 v114, v114
    v_exp_f32 v115, v115
    v_cvt_pk_bf16_f32 v138, v112, v113
    v_cvt_pk_bf16_f32 v139, v114, v115
    v_mfma_f32_32x32x16_bf16 v[100:115], v[196:199], v[28:31], 0
    v_exp_f32 v116, v116
    v_exp_f32 v117, v117
    v_exp_f32 v118, v118
    v_exp_f32 v119, v119
    v_cvt_pk_bf16_f32 v140, v116, v117
    v_cvt_pk_bf16_f32 v141, v118, v119
    v_mfma_f32_32x32x16_bf16 v[100:115], v[200:203], v[32:35], v[100:115]
    v_exp_f32 v120, v120
    v_exp_f32 v121, v121
    v_exp_f32 v122, v122
    v_exp_f32 v123, v123
    v_cvt_pk_bf16_f32 v142, v120, v121
    v_cvt_pk_bf16_f32 v143, v122, v123
    v_mfma_f32_32x32x16_bf16 v[52:67], v[204:207], v[132:135], v[52:67]
    v_exp_f32 v124, v124
    v_exp_f32 v125, v125
    v_exp_f32 v126, v126
    v_exp_f32 v127, v127
    v_cvt_pk_bf16_f32 v144, v124, v125
    v_cvt_pk_bf16_f32 v145, v126, v127
    v_mfma_f32_32x32x16_bf16 v[52:67], v[208:211], v[136:139], v[52:67]
    v_exp_f32 v128, v128
    v_exp_f32 v129, v129
    v_exp_f32 v130, v130
    v_exp_f32 v131, v131
    v_cvt_pk_bf16_f32 v146, v128, v129
    v_cvt_pk_bf16_f32 v147, v130, v131
    v_mfma_f32_32x32x16_bf16 v[116:131], v[196:199], v[4:7], 0
    v_exp_f32 v100, v100
    v_exp_f32 v101, v101
    v_exp_f32 v102, v102
    v_exp_f32 v103, v103
    v_cvt_pk_bf16_f32 v132, v100, v101
    v_cvt_pk_bf16_f32 v133, v102, v103
    v_mfma_f32_32x32x16_bf16 v[116:131], v[200:203], v[8:11], v[116:131]
    v_exp_f32 v104, v104
    v_exp_f32 v105, v105
    v_exp_f32 v106, v106
    v_exp_f32 v107, v107
    v_cvt_pk_bf16_f32 v134, v104, v105
    v_cvt_pk_bf16_f32 v135, v106, v107
    v_mfma_f32_32x32x16_bf16 v[68:83], v[204:207], v[140:143], v[68:83]
    ds_write_b128 v213, v[52:55] offset:0
    ds_write_b128 v213, v[56:59] offset:1024
    v_exp_f32 v108, v108
    v_exp_f32 v109, v109
    v_exp_f32 v110, v110
    v_exp_f32 v111, v111
    v_cvt_pk_bf16_f32 v136, v108, v109
    v_cvt_pk_bf16_f32 v137, v110, v111
    v_mfma_f32_32x32x16_bf16 v[68:83], v[208:211], v[144:147], v[68:83]
    ds_write_b128 v213, v[60:63] offset:2048
    ds_write_b128 v213, v[64:67] offset:3072
    v_exp_f32 v112, v112
    v_exp_f32 v113, v113
    v_exp_f32 v114, v114
    v_exp_f32 v115, v115
    v_cvt_pk_bf16_f32 v138, v112, v113
    v_cvt_pk_bf16_f32 v139, v114, v115
    v_exp_f32 v116, v116
    v_exp_f32 v117, v117
    v_exp_f32 v118, v118
    v_exp_f32 v119, v119
    v_cvt_pk_bf16_f32 v140, v116, v117
    v_cvt_pk_bf16_f32 v141, v118, v119
    v_exp_f32 v120, v120
    v_exp_f32 v121, v121
    v_exp_f32 v122, v122
    v_exp_f32 v123, v123
    v_cvt_pk_bf16_f32 v142, v120, v121
    v_cvt_pk_bf16_f32 v143, v122, v123
    v_mfma_f32_32x32x16_bf16 v[84:99], v[204:207], v[132:135], v[84:99]
    ds_write_b128 v214, v[68:71] offset:0
    ds_write_b128 v214, v[72:75] offset:1024
    v_exp_f32 v124, v124
    v_exp_f32 v125, v125
    v_exp_f32 v126, v126
    v_exp_f32 v127, v127
    v_cvt_pk_bf16_f32 v144, v124, v125
    v_cvt_pk_bf16_f32 v145, v126, v127
    v_mfma_f32_32x32x16_bf16 v[84:99], v[208:211], v[136:139], v[84:99]
    ds_write_b128 v214, v[76:79] offset:2048
    ds_write_b128 v214, v[80:83] offset:3072
    v_exp_f32 v128, v128
    v_exp_f32 v129, v129
    v_exp_f32 v130, v130
    v_exp_f32 v131, v131
    v_cvt_pk_bf16_f32 v146, v128, v129
    v_cvt_pk_bf16_f32 v147, v130, v131
    s_nop 1
    v_mfma_f32_32x32x16_bf16 v[36:51], v[204:207], v[140:143], v[36:51]
    v_mfma_f32_32x32x16_bf16 v[36:51], v[208:211], v[144:147], v[36:51]
    s_nop 1
    ds_write_b128 v215, v[84:87] offset:0
    ds_write_b128 v215, v[88:91] offset:1024
    ds_write_b128 v215, v[92:95] offset:2048
    ds_write_b128 v215, v[96:99] offset:3072
    v_mov_b32 v216, 163596
    v_mov_b32 v217, 1
    s_mov_b64 exec, 1
    ds_add_u32 v216, v217
    s_mov_b64 exec, -1
    s_mul_i32 s49, s44, 12288
    s_add_u32 s49, s49, 98304
    v_add_u32 v213, s49, v212
    s_lshl_b32 s49, s71, 2
    s_add_u32 s49, s49, s44
    s_lshl_b32 s50, s49, 4
    s_add_u32 s50, s50, s70
    s_lshl_b32 s81, s50, 11
    s_add_u32 s81, s81, 0x990000
    s_add_u32 s50, s50, 512
    s_mov_b32 s54, 0x5f800000
    v_mov_b32 v216, 163596
    s_mov_b32 s80, 0
L_ev_19:
    ds_read_b32 v217, v216
    s_add_u32 s80, s80, 1
    s_waitcnt lgkmcnt(0)
    v_readfirstlane_b32 s48, v217
    s_cmp_ge_u32 s80, 0x400000
    s_cbranch_scc1 L_eve_20
    s_cmp_lt_u32 s48, 4
    s_cbranch_scc1 L_ev_19
L_eve_20:
    ds_read_b128 v[148:151], v213 offset:0
    ds_read_b128 v[152:155], v213 offset:1024
    ds_read_b128 v[156:159], v213 offset:2048
    ds_read_b128 v[160:163], v213 offset:3072
    ds_read_b128 v[164:167], v213 offset:4096
    ds_read_b128 v[168:171], v213 offset:5120
    ds_read_b128 v[172:175], v213 offset:6144
    ds_read_b128 v[176:179], v213 offset:7168
    ds_read_b128 v[180:183], v213 offset:8192
    ds_read_b128 v[184:187], v213 offset:9216
    ds_read_b128 v[188:191], v213 offset:10240
    ds_read_b128 v[192:195], v213 offset:11264
    s_waitcnt lgkmcnt(11)
    v_pk_add_f32 v[36:37], v[36:37], v[148:149]
    v_pk_add_f32 v[38:39], v[38:39], v[150:151]
    s_waitcnt lgkmcnt(10)
    v_pk_add_f32 v[40:41], v[40:41], v[152:153]
    v_pk_add_f32 v[42:43], v[42:43], v[154:155]
    s_waitcnt lgkmcnt(9)
    v_pk_add_f32 v[44:45], v[44:45], v[156:157]
    v_pk_add_f32 v[46:47], v[46:47], v[158:159]
    s_waitcnt lgkmcnt(8)
    v_pk_add_f32 v[48:49], v[48:49], v[160:161]
    v_pk_add_f32 v[50:51], v[50:51], v[162:163]
    s_waitcnt lgkmcnt(7)
    v_pk_add_f32 v[36:37], v[36:37], v[164:165]
    v_pk_add_f32 v[38:39], v[38:39], v[166:167]
    s_waitcnt lgkmcnt(6)
    v_pk_add_f32 v[40:41], v[40:41], v[168:169]
    v_pk_add_f32 v[42:43], v[42:43], v[170:171]
    s_waitcnt lgkmcnt(5)
    v_pk_add_f32 v[44:45], v[44:45], v[172:173]
    v_pk_add_f32 v[46:47], v[46:47], v[174:175]
    s_waitcnt lgkmcnt(4)
    v_pk_add_f32 v[48:49], v[48:49], v[176:177]
    v_pk_add_f32 v[50:51], v[50:51], v[178:179]
    s_waitcnt lgkmcnt(3)
    v_pk_add_f32 v[36:37], v[36:37], v[180:181]
    v_pk_add_f32 v[38:39], v[38:39], v[182:183]
    s_waitcnt lgkmcnt(2)
    v_pk_add_f32 v[40:41], v[40:41], v[184:185]
    v_pk_add_f32 v[42:43], v[42:43], v[186:187]
    s_waitcnt lgkmcnt(1)
    v_pk_add_f32 v[44:45], v[44:45], v[188:189]
    v_pk_add_f32 v[46:47], v[46:47], v[190:191]
    s_waitcnt lgkmcnt(0)
    v_pk_add_f32 v[48:49], v[48:49], v[192:193]
    v_pk_add_f32 v[50:51], v[50:51], v[194:195]
    v_mov_b32 v213, v48
    v_mov_b32 v214, v48
    v_mov_b32 v220, 0
    v_mov_b32 v221, 0
    v_pk_mul_f32 v[218:219], v[36:37], v[220:221]
    v_pk_fma_f32 v[218:219], v[38:39], v[220:221], v[218:219]
    v_pk_fma_f32 v[218:219], v[40:41], v[220:221], v[218:219]
    v_pk_fma_f32 v[218:219], v[42:43], v[220:221], v[218:219]
    v_pk_fma_f32 v[218:219], v[44:45], v[220:221], v[218:219]
    v_pk_fma_f32 v[218:219], v[46:47], v[220:221], v[218:219]
    v_pk_fma_f32 v[218:219], v[48:49], v[220:221], v[218:219]
    v_pk_fma_f32 v[218:219], v[50:51], v[220:221], v[218:219]
    v_permlane32_swap_b32 v213, v214
    v_add_f32 v215, v218, v219
    v_add_f32 v215, v215, v214
    v_cmp_le_f32 vcc, 0x1f800000, v215
    v_cmp_ge_f32 s[52:53], s54, v215
    s_and_b64 vcc, vcc, s[52:53]
    s_cmp_eq_u64 vcc, -1
    s_cbranch_scc0 L_slow_22
L_norm_21:
    v_rcp_f32 v218, v214
    v_rcp_f32 v219, v214
    v_cmp_gt_u32 vcc, 32, v1
    v_pk_mul_f32 v[36:37], v[36:37], v[218:219]
    v_pk_mul_f32 v[38:39], v[38:39], v[218:219]
    v_pk_mul_f32 v[40:41], v[40:41], v[218:219]
    v_pk_mul_f32 v[42:43], v[42:43], v[218:219]
    v_pk_mul_f32 v[44:45], v[44:45], v[218:219]
    v_pk_mul_f32 v[46:47], v[46:47], v[218:219]
    v_pk_mul_f32 v[48:49], v[48:49], v[218:219]
    v_pk_mul_f32 v[50:51], v[50:51], v[218:219]
    v_cvt_pk_bf16_f32 v132, v36, v37
    v_cvt_pk_bf16_f32 v133, v38, v39
    v_cvt_pk_bf16_f32 v134, v40, v41
    v_cvt_pk_bf16_f32 v135, v42, v43
    v_cvt_pk_bf16_f32 v136, v44, v45
    v_cvt_pk_bf16_f32 v137, v46, v47
    v_cvt_pk_bf16_f32 v138, v48, v49
    v_cvt_pk_bf16_f32 v139, v50, v51
    v_cndmask_b32 v138, 0, v138, vcc
    v_cndmask_b32 v139, 0, v139, vcc
    buffer_store_dwordx4 v[132:135], v212, s[40:43], s81 offen offset:0 sc1
    buffer_store_dwordx4 v[136:139], v212, s[40:43], s81 offen offset:1024 sc1
    v_mov_b32 v216, 163600
    v_mov_b32 v217, 1
    s_mov_b64 exec, 1
    ds_add_u32 v216, v217
    s_mov_b64 exec, -1
    s_waitcnt vmcnt(0)
    s_lshl_b32 s50, s50, 7
    v_lshl_add_u32 v220, v1, 4, s50
    v_mov_b32 v216, s64
    v_mov_b32 v217, s65
    v_mov_b32 v218, s64
    v_mov_b32 v219, s65
    s_mov_b64 exec, 0xff
    buffer_store_dwordx4 v[216:219], v220, s[40:43], 0 offen sc1
    s_mov_b64 exec, -1
    s_setprio 0
    s_cmp_lt_u32 s46, 28
    s_cbranch_scc1 L_fin
    s_endpgm
L_slow_22:
    s_lshl_b32 s77, s70, 18
    s_add_u32 s77, s77, 0x240000
    s_mov_b32 s80, 0
    v_mov_b32 v217, 0xff800000
L_s1_23:
    buffer_load_dwordx4 v[148:151], v212, s[40:43], s77 offen offset:0 sc1
    buffer_load_dwordx4 v[152:155], v212, s[40:43], s77 offen offset:1024 sc1
    s_waitcnt vmcnt(0)
    v_mfma_f32_32x32x16_bf16 v[100:115], v[148:151], v[4:7], 0
    v_mfma_f32_32x32x16_bf16 v[100:115], v[152:155], v[8:11], v[100:115]
    s_add_u32 s77, s77, 4096
    s_add_u32 s80, s80, 1
    s_nop 11
    v_max3_f32 v217, v217, v100, v101
    v_max3_f32 v217, v217, v102, v103
    v_max3_f32 v217, v217, v104, v105
    v_max3_f32 v217, v217, v106, v107
    v_max3_f32 v217, v217, v108, v109
    v_max3_f32 v217, v217, v110, v111
    v_max3_f32 v217, v217, v112, v113
    v_max3_f32 v217, v217, v114, v115
    s_cmp_lt_u32 s80, 64
    s_cbranch_scc1 L_s1_23
    v_mov_b32 v218, v217
    s_nop 1
    v_permlane32_swap_b32 v217, v218
    s_nop 1
    v_max_f32 v217, v217, v218
    s_lshl_b32 s77, s70, 18
    s_add_u32 s77, s77, 0x240000
    s_mov_b32 s80, 0
    v_mov_b32 v36, 0
    v_mov_b32 v37, 0
    v_mov_b32 v38, 0
    v_mov_b32 v39, 0
    v_mov_b32 v40, 0
    v_mov_b32 v41, 0
    v_mov_b32 v42, 0
    v_mov_b32 v43, 0
    v_mov_b32 v44, 0
    v_mov_b32 v45, 0
    v_mov_b32 v46, 0
    v_mov_b32 v47, 0
    v_mov_b32 v48, 0
    v_mov_b32 v49, 0
    v_mov_b32 v50, 0
    v_mov_b32 v51, 0
L_s2_24:
    buffer_load_dwordx4 v[148:151], v212, s[40:43], s77 offen offset:0 sc1
    buffer_load_dwordx4 v[152:155], v212, s[40:43], s77 offen offset:1024 sc1
    buffer_load_dwordx4 v[156:159], v212, s[40:43], s77 offen offset:2048 sc1
    buffer_load_dwordx4 v[160:163], v212, s[40:43], s77 offen offset:3072 sc1
    s_waitcnt vmcnt(0)
    v_mfma_f32_32x32x16_bf16 v[100:115], v[148:151], v[4:7], 0
    v_mfma_f32_32x32x16_bf16 v[100:115], v[152:155], v[8:11], v[100:115]
    s_add_u32 s77, s77, 4096
    s_add_u32 s80, s80, 1
    s_nop 11
    v_sub_f32 v100, v100, v217
    v_sub_f32 v101, v101, v217
    v_sub_f32 v102, v102, v217
    v_sub_f32 v103, v103, v217
    v_sub_f32 v104, v104, v217
    v_sub_f32 v105, v105, v217
    v_sub_f32 v106, v106, v217
    v_sub_f32 v107, v107, v217
    v_sub_f32 v108, v108, v217
    v_sub_f32 v109, v109, v217
    v_sub_f32 v110, v110, v217
    v_sub_f32 v111, v111, v217
    v_sub_f32 v112, v112, v217
    v_sub_f32 v113, v113, v217
    v_sub_f32 v114, v114, v217
    v_sub_f32 v115, v115, v217
    v_exp_f32 v100, v100
    v_exp_f32 v101, v101
    v_exp_f32 v102, v102
    v_exp_f32 v103, v103
    v_exp_f32 v104, v104
    v_exp_f32 v105, v105
    v_exp_f32 v106, v106
    v_exp_f32 v107, v107
    v_exp_f32 v108, v108
    v_exp_f32 v109, v109
    v_exp_f32 v110, v110
    v_exp_f32 v111, v111
    v_exp_f32 v112, v112
    v_exp_f32 v113, v113
    v_exp_f32 v114, v114
    v_exp_f32 v115, v115
    s_nop 0
    v_cvt_pk_bf16_f32 v132, v100, v101
    v_cvt_pk_bf16_f32 v133, v102, v103
    v_cvt_pk_bf16_f32 v134, v104, v105
    v_cvt_pk_bf16_f32 v135, v106, v107
    v_cvt_pk_bf16_f32 v136, v108, v109
    v_cvt_pk_bf16_f32 v137, v110, v111
    v_cvt_pk_bf16_f32 v138, v112, v113
    v_cvt_pk_bf16_f32 v139, v114, v115
    s_nop 1
    v_mfma_f32_32x32x16_bf16 v[36:51], v[156:159], v[132:135], v[36:51]
    v_mfma_f32_32x32x16_bf16 v[36:51], v[160:163], v[136:139], v[36:51]
    s_nop 7
    s_cmp_lt_u32 s80, 64
    s_cbranch_scc1 L_s2_24
    s_nop 11
    v_mov_b32 v213, v48
    v_mov_b32 v214, v48
    s_nop 1
    v_permlane32_swap_b32 v213, v214
    s_nop 1
    s_branch L_norm_21
L_hwg:
    s_cmp_ge_u32 s44, 4
    s_cbranch_scc1 L_hb
    buffer_load_dwordx4 v[4:7], v132, s[4:7], 0 offen offset:0
    buffer_load_dwordx4 v[8:11], v132, s[4:7], 0 offen offset:128
    buffer_load_dwordx4 v[12:15], v132, s[4:7], 0 offen offset:256
    buffer_load_dwordx4 v[16:19], v132, s[4:7], 0 offen offset:384
    buffer_load_dwordx4 v[20:23], v132, s[4:7], 0 offen offset:512
    buffer_load_dwordx4 v[24:27], v132, s[4:7], 0 offen offset:640
    buffer_load_dwordx4 v[28:31], v132, s[4:7], 0 offen offset:768
    v_lshrrev_b32 v244, 3, v0
    v_and_b32 v245, 7, v0
    v_mul_u32_u24 v246, 272, v244
    v_lshl_add_u32 v246, v245, 5, v246
    v_add_u32 v246, 90112, v246
    s_lshl_b32 s48, s74, 6
    v_add_u32 v244, s48, v244
    v_mul_u32_u24 v247, 896, v244
    v_lshl_add_u32 v247, v245, 4, v247
    s_lshl_b32 s48, s75, 7
    v_add_u32 v247, s48, v247
    v_lshlrev_b32 v244, 1, v244
    buffer_load_dwordx4 v[248:251], v247, s[4:7], 0 offen
    buffer_load_ushort v252, v244, s[28:31], 0 offen
    s_mul_i32 s48, s44, 7680
    s_add_u32 s48, s48, 98304
    v_lshrrev_b32 v100, 3, v1
    v_mul_u32_u24 v100, 960, v100
    v_and_b32 v101, 7, v1
    v_lshl_add_u32 v100, v101, 4, v100
    v_add_u32 v102, s48, v100
    v_bfe_u32 v100, v1, 2, 2
    v_mul_u32_u24 v100, 960, v100
    v_lshrrev_b32 v101, 4, v1
    v_lshl_add_u32 v100, v101, 5, v100
    v_and_b32 v101, 3, v1
    v_lshl_add_u32 v100, v101, 3, v100
    v_add_u32 v103, s48, v100
    v_lshlrev_b32 v104, 4, v1
    v_add_u32 v105, 4096, v104
    s_lshl_b32 s48, s57, 2
    s_add_u32 s48, s48, s44
    s_mul_i32 s48, s48, 7168
    s_add_u32 s81, s48, 0x640000
    s_waitcnt vmcnt(2)
    v_mov_b32 v106, 0
    v_dot2c_f32_bf16 v106, 0x3f803f80, v4
    v_dot2c_f32_bf16 v106, 0x3f803f80, v5
    v_dot2c_f32_bf16 v106, 0x3f803f80, v6
    v_dot2c_f32_bf16 v106, 0x3f803f80, v7
    v_dot2c_f32_bf16 v106, 0x3f803f80, v8
    v_dot2c_f32_bf16 v106, 0x3f803f80, v9
    v_dot2c_f32_bf16 v106, 0x3f803f80, v10
    v_dot2c_f32_bf16 v106, 0x3f803f80, v11
    v_dot2c_f32_bf16 v106, 0x3f803f80, v12
    v_dot2c_f32_bf16 v106, 0x3f803f80, v13
    v_dot2c_f32_bf16 v106, 0x3f803f80, v14
    v_dot2c_f32_bf16 v106, 0x3f803f80, v15
    v_dot2c_f32_bf16 v106, 0x3f803f80, v16
    v_dot2c_f32_bf16 v106, 0x3f803f80, v17
    v_dot2c_f32_bf16 v106, 0x3f803f80, v18
    v_dot2c_f32_bf16 v106, 0x3f803f80, v19
    v_dot2c_f32_bf16 v106, 0x3f803f80, v20
    v_dot2c_f32_bf16 v106, 0x3f803f80, v21
    v_dot2c_f32_bf16 v106, 0x3f803f80, v22
    v_dot2c_f32_bf16 v106, 0x3f803f80, v23
    v_dot2c_f32_bf16 v106, 0x3f803f80, v24
    v_dot2c_f32_bf16 v106, 0x3f803f80, v25
    v_dot2c_f32_bf16 v106, 0x3f803f80, v26
    v_dot2c_f32_bf16 v106, 0x3f803f80, v27
    v_dot2c_f32_bf16 v106, 0x3f803f80, v28
    v_dot2c_f32_bf16 v106, 0x3f803f80, v29
    v_dot2c_f32_bf16 v106, 0x3f803f80, v30
    v_dot2c_f32_bf16 v106, 0x3f803f80, v31
    s_nop 0
    s_nop 1
    v_add_f32_dpp v106, v106, v106 quad_perm:[1,0,3,2] row_mask:0xf bank_mask:0xf
    s_nop 1
    v_add_f32_dpp v106, v106, v106 quad_perm:[2,3,0,1] row_mask:0xf bank_mask:0xf
    s_nop 1
    v_add_f32_dpp v106, v106, v106 row_half_mirror row_mask:0xf bank_mask:0xf
    v_mul_f32 v106, 0xbb124925, v106
    v_dot2_f32_bf16 v32, v4, s66, v106
    v_dot2_f32_bf16 v33, v4, s67, v106
    v_dot2_f32_bf16 v34, v5, s66, v106
    v_dot2_f32_bf16 v35, v5, s67, v106
    v_dot2_f32_bf16 v36, v6, s66, v106
    v_dot2_f32_bf16 v37, v6, s67, v106
    v_dot2_f32_bf16 v38, v7, s66, v106
    v_dot2_f32_bf16 v39, v7, s67, v106
    v_dot2_f32_bf16 v40, v8, s66, v106
    v_dot2_f32_bf16 v41, v8, s67, v106
    v_dot2_f32_bf16 v42, v9, s66, v106
    v_dot2_f32_bf16 v43, v9, s67, v106
    v_dot2_f32_bf16 v44, v10, s66, v106
    v_dot2_f32_bf16 v45, v10, s67, v106
    v_dot2_f32_bf16 v46, v11, s66, v106
    v_dot2_f32_bf16 v47, v11, s67, v106
    v_dot2_f32_bf16 v48, v12, s66, v106
    v_dot2_f32_bf16 v49, v12, s67, v106
    v_dot2_f32_bf16 v50, v13, s66, v106
    v_dot2_f32_bf16 v51, v13, s67, v106
    v_dot2_f32_bf16 v52, v14, s66, v106
    v_dot2_f32_bf16 v53, v14, s67, v106
    v_dot2_f32_bf16 v54, v15, s66, v106
    v_dot2_f32_bf16 v55, v15, s67, v106
    v_dot2_f32_bf16 v56, v16, s66, v106
    v_dot2_f32_bf16 v57, v16, s67, v106
    v_dot2_f32_bf16 v58, v17, s66, v106
    v_dot2_f32_bf16 v59, v17, s67, v106
    v_dot2_f32_bf16 v60, v18, s66, v106
    v_dot2_f32_bf16 v61, v18, s67, v106
    v_dot2_f32_bf16 v62, v19, s66, v106
    v_dot2_f32_bf16 v63, v19, s67, v106
    v_dot2_f32_bf16 v64, v20, s66, v106
    v_dot2_f32_bf16 v65, v20, s67, v106
    v_dot2_f32_bf16 v66, v21, s66, v106
    v_dot2_f32_bf16 v67, v21, s67, v106
    v_dot2_f32_bf16 v68, v22, s66, v106
    v_dot2_f32_bf16 v69, v22, s67, v106
    v_dot2_f32_bf16 v70, v23, s66, v106
    v_dot2_f32_bf16 v71, v23, s67, v106
    v_dot2_f32_bf16 v72, v24, s66, v106
    v_dot2_f32_bf16 v73, v24, s67, v106
    v_dot2_f32_bf16 v74, v25, s66, v106
    v_dot2_f32_bf16 v75, v25, s67, v106
    v_dot2_f32_bf16 v76, v26, s66, v106
    v_dot2_f32_bf16 v77, v26, s67, v106
    v_dot2_f32_bf16 v78, v27, s66, v106
    v_dot2_f32_bf16 v79, v27, s67, v106
    v_dot2_f32_bf16 v80, v28, s66, v106
    v_dot2_f32_bf16 v81, v28, s67, v106
    v_dot2_f32_bf16 v82, v29, s66, v106
    v_dot2_f32_bf16 v83, v29, s67, v106
    v_dot2_f32_bf16 v84, v30, s66, v106
    v_dot2_f32_bf16 v85, v30, s67, v106
    v_dot2_f32_bf16 v86, v31, s66, v106
    v_dot2_f32_bf16 v87, v31, s67, v106
    v_mul_f32 v107, v32, v32
    v_mul_f32 v108, v33, v33
    v_fmac_f32 v107, v34, v34
    v_fmac_f32 v108, v35, v35
    v_fmac_f32 v107, v36, v36
    v_fmac_f32 v108, v37, v37
    v_fmac_f32 v107, v38, v38
    v_fmac_f32 v108, v39, v39
    v_fmac_f32 v107, v40, v40
    v_fmac_f32 v108, v41, v41
    v_fmac_f32 v107, v42, v42
    v_fmac_f32 v108, v43, v43
    v_fmac_f32 v107, v44, v44
    v_fmac_f32 v108, v45, v45
    v_fmac_f32 v107, v46, v46
    v_fmac_f32 v108, v47, v47
    v_fmac_f32 v107, v48, v48
    v_fmac_f32 v108, v49, v49
    v_fmac_f32 v107, v50, v50
    v_fmac_f32 v108, v51, v51
    v_fmac_f32 v107, v52, v52
    v_fmac_f32 v108, v53, v53
    v_fmac_f32 v107, v54, v54
    v_fmac_f32 v108, v55, v55
    v_fmac_f32 v107, v56, v56
    v_fmac_f32 v108, v57, v57
    v_fmac_f32 v107, v58, v58
    v_fmac_f32 v108, v59, v59
    v_fmac_f32 v107, v60, v60
    v_fmac_f32 v108, v61, v61
    v_fmac_f32 v107, v62, v62
    v_fmac_f32 v108, v63, v63
    v_fmac_f32 v107, v64, v64
    v_fmac_f32 v108, v65, v65
    v_fmac_f32 v107, v66, v66
    v_fmac_f32 v108, v67, v67
    v_fmac_f32 v107, v68, v68
    v_fmac_f32 v108, v69, v69
    v_fmac_f32 v107, v70, v70
    v_fmac_f32 v108, v71, v71
    v_fmac_f32 v107, v72, v72
    v_fmac_f32 v108, v73, v73
    v_fmac_f32 v107, v74, v74
    v_fmac_f32 v108, v75, v75
    v_fmac_f32 v107, v76, v76
    v_fmac_f32 v108, v77, v77
    v_fmac_f32 v107, v78, v78
    v_fmac_f32 v108, v79, v79
    v_fmac_f32 v107, v80, v80
    v_fmac_f32 v108, v81, v81
    v_fmac_f32 v107, v82, v82
    v_fmac_f32 v108, v83, v83
    v_fmac_f32 v107, v84, v84
    v_fmac_f32 v108, v85, v85
    v_fmac_f32 v107, v86, v86
    v_fmac_f32 v108, v87, v87
    v_add_f32 v107, v107, v108
    s_nop 1
    v_add_f32_dpp v107, v107, v107 quad_perm:[1,0,3,2] row_mask:0xf bank_mask:0xf
    s_nop 1
    v_add_f32_dpp v107, v107, v107 quad_perm:[2,3,0,1] row_mask:0xf bank_mask:0xf
    s_nop 1
    v_add_f32_dpp v107, v107, v107 row_half_mirror row_mask:0xf bank_mask:0xf
    v_mul_f32 v107, 0x3b124925, v107
    v_add_f32 v108, 0x3727c5ac, v107
    v_rsq_f32 v108, v108
    s_nop 0
    v_mul_f32 v107, v107, v108
    v_mov_b32 v109, 0x3727c5ac
    v_fmac_f32 v109, v107, v108
    v_rsq_f32 v109, v109
    s_nop 0
    v_mul_f32 v107, v108, v109
    v_mul_f32 v32, v107, v32
    v_mul_f32 v33, v107, v33
    v_mul_f32 v34, v107, v34
    v_mul_f32 v35, v107, v35
    v_mul_f32 v36, v107, v36
    v_mul_f32 v37, v107, v37
    v_mul_f32 v38, v107, v38
    v_mul_f32 v39, v107, v39
    v_mul_f32 v40, v107, v40
    v_mul_f32 v41, v107, v41
    v_mul_f32 v42, v107, v42
    v_mul_f32 v43, v107, v43
    v_mul_f32 v44, v107, v44
    v_mul_f32 v45, v107, v45
    v_mul_f32 v46, v107, v46
    v_mul_f32 v47, v107, v47
    v_mul_f32 v48, v107, v48
    v_mul_f32 v49, v107, v49
    v_mul_f32 v50, v107, v50
    v_mul_f32 v51, v107, v51
    v_mul_f32 v52, v107, v52
    v_mul_f32 v53, v107, v53
    v_mul_f32 v54, v107, v54
    v_mul_f32 v55, v107, v55
    v_mul_f32 v56, v107, v56
    v_mul_f32 v57, v107, v57
    v_mul_f32 v58, v107, v58
    v_mul_f32 v59, v107, v59
    v_mul_f32 v60, v107, v60
    v_mul_f32 v61, v107, v61
    v_mul_f32 v62, v107, v62
    v_mul_f32 v63, v107, v63
    v_mul_f32 v64, v107, v64
    v_mul_f32 v65, v107, v65
    v_mul_f32 v66, v107, v66
    v_mul_f32 v67, v107, v67
    v_mul_f32 v68, v107, v68
    v_mul_f32 v69, v107, v69
    v_mul_f32 v70, v107, v70
    v_mul_f32 v71, v107, v71
    v_mul_f32 v72, v107, v72
    v_mul_f32 v73, v107, v73
    v_mul_f32 v74, v107, v74
    v_mul_f32 v75, v107, v75
    v_mul_f32 v76, v107, v76
    v_mul_f32 v77, v107, v77
    v_mul_f32 v78, v107, v78
    v_mul_f32 v79, v107, v79
    v_mul_f32 v80, v107, v80
    v_mul_f32 v81, v107, v81
    v_mul_f32 v82, v107, v82
    v_mul_f32 v83, v107, v83
    v_mul_f32 v84, v107, v84
    v_mul_f32 v85, v107, v85
    v_mul_f32 v86, v107, v86
    v_mul_f32 v87, v107, v87
    v_cvt_pk_bf16_f32 v4, v32, v33
    v_cvt_pk_bf16_f32 v5, v34, v35
    v_cvt_pk_bf16_f32 v6, v36, v37
    v_cvt_pk_bf16_f32 v7, v38, v39
    ds_write_b128 v102, v[4:7] offset:0
    v_cvt_pk_bf16_f32 v8, v40, v41
    v_cvt_pk_bf16_f32 v9, v42, v43
    v_cvt_pk_bf16_f32 v10, v44, v45
    v_cvt_pk_bf16_f32 v11, v46, v47
    ds_write_b128 v102, v[8:11] offset:128
    v_cvt_pk_bf16_f32 v12, v48, v49
    v_cvt_pk_bf16_f32 v13, v50, v51
    v_cvt_pk_bf16_f32 v14, v52, v53
    v_cvt_pk_bf16_f32 v15, v54, v55
    ds_write_b128 v102, v[12:15] offset:256
    v_cvt_pk_bf16_f32 v16, v56, v57
    v_cvt_pk_bf16_f32 v17, v58, v59
    v_cvt_pk_bf16_f32 v18, v60, v61
    v_cvt_pk_bf16_f32 v19, v62, v63
    ds_write_b128 v102, v[16:19] offset:384
    v_cvt_pk_bf16_f32 v20, v64, v65
    v_cvt_pk_bf16_f32 v21, v66, v67
    v_cvt_pk_bf16_f32 v22, v68, v69
    v_cvt_pk_bf16_f32 v23, v70, v71
    ds_write_b128 v102, v[20:23] offset:512
    v_cvt_pk_bf16_f32 v24, v72, v73
    v_cvt_pk_bf16_f32 v25, v74, v75
    v_cvt_pk_bf16_f32 v26, v76, v77
    v_cvt_pk_bf16_f32 v27, v78, v79
    ds_write_b128 v102, v[24:27] offset:640
    v_cvt_pk_bf16_f32 v28, v80, v81
    v_cvt_pk_bf16_f32 v29, v82, v83
    v_cvt_pk_bf16_f32 v30, v84, v85
    v_cvt_pk_bf16_f32 v31, v86, v87
    ds_write_b128 v102, v[28:31] offset:768
    s_waitcnt lgkmcnt(0)
    ds_read_b64_tr_b16 v[32:33], v103 offset:0
    ds_read_b64_tr_b16 v[34:35], v103 offset:3840
    ds_read_b64_tr_b16 v[36:37], v103 offset:128
    ds_read_b64_tr_b16 v[38:39], v103 offset:3968
    ds_read_b64_tr_b16 v[40:41], v103 offset:256
    ds_read_b64_tr_b16 v[42:43], v103 offset:4096
    ds_read_b64_tr_b16 v[44:45], v103 offset:384
    ds_read_b64_tr_b16 v[46:47], v103 offset:4224
    ds_read_b64_tr_b16 v[48:49], v103 offset:512
    ds_read_b64_tr_b16 v[50:51], v103 offset:4352
    ds_read_b64_tr_b16 v[52:53], v103 offset:640
    ds_read_b64_tr_b16 v[54:55], v103 offset:4480
    ds_read_b64_tr_b16 v[56:57], v103 offset:768
    ds_read_b64_tr_b16 v[58:59], v103 offset:4608
    s_waitcnt lgkmcnt(12)
    buffer_store_dwordx4 v[32:35], v104, s[40:43], s81 offen offset:0 sc1
    s_waitcnt lgkmcnt(10)
    buffer_store_dwordx4 v[36:39], v104, s[40:43], s81 offen offset:1024 sc1
    s_waitcnt lgkmcnt(8)
    buffer_store_dwordx4 v[40:43], v104, s[40:43], s81 offen offset:2048 sc1
    s_waitcnt lgkmcnt(6)
    buffer_store_dwordx4 v[44:47], v104, s[40:43], s81 offen offset:3072 sc1
    s_waitcnt lgkmcnt(4)
    buffer_store_dwordx4 v[48:51], v105, s[40:43], s81 offen offset:0 sc1
    s_waitcnt lgkmcnt(2)
    buffer_store_dwordx4 v[52:55], v105, s[40:43], s81 offen offset:1024 sc1
    s_waitcnt lgkmcnt(0)
    buffer_store_dwordx4 v[56:59], v105, s[40:43], s81 offen offset:2048 sc1
    v_mov_b32 v120, 163584
    v_mov_b32 v121, 1
    s_mov_b64 exec, 1
    ds_add_u32 v120, v121
    s_mov_b64 exec, -1
    s_mov_b32 s80, 0
L_tag_25:
    v_mov_b32 v122, 0
    buffer_load_dwordx2 v[120:121], v122, s[36:39], 0 offen sc1
    s_add_u32 s80, s80, 1
    s_cmp_ge_u32 s80, 0x100000
    s_waitcnt vmcnt(0)
    s_cbranch_scc1 L_tage_26
L_tagf_27:
    v_readfirstlane_b32 s64, v120
    v_readfirstlane_b32 s65, v121
    s_cmp_eq_u32 s64, 0
    s_cbranch_scc1 L_tag_25
L_tage_26:
    s_add_u32 s50, s57, 192
    v_mov_b32 v120, 163608
    v_mov_b32 v121, 1
    s_mov_b64 exec, 1
    ds_add_rtn_u32 v121, v120, v121
    s_mov_b64 exec, -1
    s_waitcnt lgkmcnt(0)
    v_readfirstlane_b32 s48, v121
    s_cmp_lg_u32 s48, 3
    s_cbranch_scc1 L_nsig_28
    s_lshl_b32 s50, s50, 7
    v_lshl_add_u32 v124, v1, 4, s50
    v_mov_b32 v120, s64
    v_mov_b32 v121, s65
    v_mov_b32 v122, s64
    v_mov_b32 v123, s65
    s_mov_b64 exec, 0xff
    buffer_store_dwordx4 v[120:123], v124, s[40:43], 0 offen sc1
    s_mov_b64 exec, -1
L_nsig_28:
    s_branch L_a
L_hb:
    s_cmp_lg_u32 s2, 192
    s_cbranch_scc1 L_nz
    s_cmp_lg_u32 s44, 7
    s_cbranch_scc1 L_nz
    v_mov_b32 v8, 196608
    buffer_load_dword v9, v8, s[40:43], 0 offen sc1
    s_waitcnt vmcnt(0)
    v_readfirstlane_b32 s48, v9
    s_mul_i32 s49, s48, 0x0019660d
    s_add_u32 s49, s49, 0x3c6ef35f
    s_mul_i32 s50, s48, 0x9e3779b1
    s_add_u32 s50, s50, 0x7f4a7c15
    s_or_b32 s51, s49, 1
    v_mov_b32 v10, s51
    v_mov_b32 v11, s50
    v_mov_b32 v9, s49
    v_mov_b32 v12, 0
    s_mov_b64 exec, 1
    buffer_store_dwordx2 v[10:11], v12, s[36:39], 0 offen sc1
    buffer_store_dword v9, v8, s[40:43], 0 offen sc1
    s_mov_b64 exec, -1
L_nz:
    s_mov_b32 s10, 1204224
    s_mov_b32 s11, 0x20000
    s_sub_u32 s50, s46, 24
    s_lshl_b32 s50, s50, 2
    s_add_u32 s50, s50, s44
    s_sub_u32 s50, s50, 4
    s_and_b32 s51, s45, 1
    s_mul_i32 s51, s51, 1280
    v_mul_u32_u24 v12, 5958, v1
    v_lshrrev_b32 v12, 16, v12
    v_mul_u32_u24 v13, 11, v12
    v_sub_u32 v13, v1, v13
    v_lshlrev_b32 v12, 5, v12
    v_add_u32 v12, s50, v12
    v_mul_u32_u24 v12, 2688, v12
    v_lshl_add_u32 v12, v13, 7, v12
    v_add_u32 v12, s51, v12
    v_mov_b32 v14, 0x40000000
    v_cmp_gt_u32 vcc, 55, v1
    s_mov_b32 s77, 430080
    s_nop 0
    v_cndmask_b32 v12, v14, v12, vcc
    buffer_load_dword v13, v12, s[8:11], s77 offen
    s_add_u32 s77, s77, 430080
    buffer_load_dword v13, v12, s[8:11], s77 offen
    s_add_u32 s77, s77, 430080
    s_lshl_b32 s59, s76, 11
    v_lshrrev_b32 v232, 3, v1
    v_bfe_u32 v233, v1, 4, 1
    v_lshlrev_b32 v233, 2, v233
    v_and_b32 v234, 7, v1
    v_xor_b32 v233, v233, v234
    v_lshlrev_b32 v233, 4, v233
    s_and_b32 s60, s75, 3
    s_lshl_b32 s60, s60, 1
    s_mul_i32 s48, s73, 128
    s_mul_i32 s49, s76, 1835008
    s_add_u32 s48, s48, s49
    v_mul_u32_u24 v234, 3584, v232
    v_add3_u32 v204, v234, v233, s48
    v_add_u32 v205, 27648, v204
    s_mul_i32 s48, s74, 128
    s_mul_i32 s49, s76, 1835008
    s_add_u32 s48, s48, s49
    v_mul_u32_u24 v234, 4096, v232
    v_add3_u32 v206, v234, v233, s48
    v_add_u32 v207, 31744, v206
    s_mul_i32 s48, s75, 128
    s_mul_i32 s49, s76, 100352
    s_add_u32 s48, s48, s49
    v_mul_u32_u24 v234, 896, v232
    v_add3_u32 v208, v234, v233, s48
    v_add_u32 v209, 6144, v208
    v_lshrrev_b32 v232, 5, v1
    v_mul_u32_u24 v232, 7168, v232
    v_and_b32 v233, 31, v1
    v_lshl_add_u32 v232, v233, 4, v232
    v_mov_b32 v234, 0x40000000
    v_cmp_gt_u32 vcc, 24, v233
    s_lshl_b32 s48, s75, 10
    v_add_u32 v212, s48, v232
    v_add_u32 v213, 512, v212
    s_mul_i32 s48, s72, 896
    v_add_u32 v232, s48, v232
    v_add_u32 v233, 512, v232
    v_cndmask_b32 v233, v234, v233, vcc
    s_bitcmp1_b32 s76, 0
    s_cselect_b64 vcc, -1, 0
    v_lshlrev_b32 v214, 4, v1
    v_add_u32 v215, 0x8000, v214
    v_cndmask_b32 v210, v232, v233, vcc
    v_cndmask_b32 v211, v233, v232, vcc
    v_bfe_u32 v232, v1, 2, 2
    v_bfe_u32 v233, v1, 4, 1
    v_bfe_u32 v234, v1, 1, 1
    v_lshl_add_u32 v233, v233, 1, v234
    v_lshrrev_b32 v234, 1, v232
    v_lshlrev_b32 v234, 2, v234
    v_xor_b32 v233, v233, v234
    v_lshlrev_b32 v233, 4, v233
    v_and_b32 v234, 1, v1
    v_lshl_add_u32 v233, v234, 3, v233
    v_lshl_add_u32 v232, v232, 7, v233
    v_add_u32 v232, s59, v232
    v_lshrrev_b32 v233, 5, v1
    v_lshl_add_u32 v220, v233, 9, v232
    v_xor_b32 v221, 64, v220
    v_lshl_add_u32 v216, v233, 10, v232
    s_lshl_b32 s48, s76, 5
    s_and_b32 s48, s48, 64
    v_xor_b32 v216, s48, v216
    v_xor_b32 v217, 64, v216
    v_add_u32 v218, 0x10000, v216
    v_add_u32 v219, 0x10000, v217
    v_add_u32 v222, 0x10000, v220
    v_add_u32 v223, 0x10000, v221
    s_lshl_b32 s48, s73, 7
    s_lshl_b32 s49, s76, 5
    s_and_b32 s49, s49, 64
    s_add_u32 s48, s48, s49
    v_lshrrev_b32 v232, 5, v1
    v_lshl_add_u32 v232, v232, 3, s48
    buffer_load_dwordx2 v[224:225], v232, s[24:27], 0 offen offset:0
    buffer_load_dwordx2 v[226:227], v232, s[24:27], 0 offen offset:16
    buffer_load_dwordx2 v[228:229], v232, s[24:27], 0 offen offset:32
    buffer_load_dwordx2 v[230:231], v232, s[24:27], 0 offen offset:48
    v_lshrrev_b32 v244, 3, v0
    v_and_b32 v245, 7, v0
    v_mul_u32_u24 v246, 272, v244
    v_lshl_add_u32 v246, v245, 5, v246
    v_add_u32 v246, 90112, v246
    s_lshl_b32 s48, s74, 6
    v_add_u32 v244, s48, v244
    v_mul_u32_u24 v247, 896, v244
    v_lshl_add_u32 v247, v245, 4, v247
    s_lshl_b32 s48, s75, 7
    v_add_u32 v247, s48, v247
    v_lshlrev_b32 v244, 1, v244
    buffer_load_dwordx4 v[248:251], v247, s[4:7], 0 offen
    buffer_load_ushort v252, v244, s[28:31], 0 offen
    s_sub_u32 s48, s46, 24
    s_lshl_b32 s48, s48, 4
    s_lshl_b32 s49, s76, 9
    s_add_u32 s48, s48, s49
    s_add_u32 s48, s48, 0
    s_mul_i32 s48, s48, 3584
    s_mul_i32 s49, s45, 7
    s_lshr_b32 s49, s49, 1
    s_lshl_b32 s49, s49, 7
    s_add_u32 s48, s48, s49
    s_waitcnt vmcnt(0)
    v_lshrrev_b32 v6, 2, v1
    v_mul_u32_u24 v6, 3584, v6
    v_and_b32 v7, 3, v1
    v_lshl_add_u32 v6, v7, 7, v6
    buffer_load_dword v7, v6, s[16:19], s48 offen
    s_add_u32 s48, s48, 458752
    s_waitcnt vmcnt(1)
    buffer_load_dword v7, v6, s[16:19], s48 offen
    s_add_u32 s48, s48, 458752
    s_waitcnt vmcnt(1)
    buffer_load_dword v7, v6, s[16:19], s48 offen
    s_add_u32 s48, s48, 458752
    s_waitcnt vmcnt(1)
    buffer_load_dword v7, v6, s[16:19], s48 offen
    s_add_u32 s48, s48, 458752
    s_waitcnt vmcnt(1)
    s_waitcnt vmcnt(0)
    s_mov_b32 s80, 0
L_tag_29:
    v_mov_b32 v6, 0
    buffer_load_dwordx2 v[4:5], v6, s[36:39], 0 offen sc1
    s_add_u32 s80, s80, 1
    s_cmp_ge_u32 s80, 0x100000
    s_waitcnt vmcnt(0)
    s_cbranch_scc1 L_tage_30
L_tagf_31:
    v_readfirstlane_b32 s64, v4
    v_readfirstlane_b32 s65, v5
    s_cmp_eq_u32 s64, 0
    s_cbranch_scc1 L_tag_29
L_tage_30:
    s_cmp_ge_u32 s46, 28
    s_cbranch_scc1 L_spare
    s_add_u32 m0, s59, 0
    s_mov_b32 s58, 0
    buffer_load_dwordx4 v204, s[16:19], s58 offen offset:0 lds
    buffer_load_dwordx4 v205, s[16:19], s58 offen offset:1024 lds
    s_add_u32 m0, s59, 8192
    s_add_u32 s58, s58, 57344
    buffer_load_dwordx4 v204, s[16:19], s58 offen offset:0 lds
    buffer_load_dwordx4 v205, s[16:19], s58 offen offset:1024 lds
    s_add_u32 m0, s59, 16384
    s_add_u32 s58, s58, 57344
    buffer_load_dwordx4 v204, s[16:19], s58 offen offset:0 lds
    buffer_load_dwordx4 v205, s[16:19], s58 offen offset:1024 lds
    s_add_u32 m0, s59, 24576
    s_add_u32 s58, s58, 57344
    buffer_load_dwordx4 v204, s[16:19], s58 offen offset:0 lds
    buffer_load_dwordx4 v205, s[16:19], s58 offen offset:1024 lds
    s_add_u32 m0, s59, 32768
    s_add_u32 s58, s58, 57344
    buffer_load_dwordx4 v204, s[16:19], s58 offen offset:0 lds
    buffer_load_dwordx4 v205, s[16:19], s58 offen offset:1024 lds
    s_add_u32 m0, s59, 40960
    s_add_u32 s58, s58, 57344
    buffer_load_dwordx4 v204, s[16:19], s58 offen offset:0 lds
    buffer_load_dwordx4 v205, s[16:19], s58 offen offset:1024 lds
    s_add_u32 m0, s59, 49152
    s_add_u32 s58, s58, 57344
    buffer_load_dwordx4 v204, s[16:19], s58 offen offset:0 lds
    buffer_load_dwordx4 v205, s[16:19], s58 offen offset:1024 lds
    s_add_u32 m0, s59, 57344
    s_add_u32 s58, s58, 57344
    buffer_load_dwordx4 v204, s[16:19], s58 offen offset:0 lds
    buffer_load_dwordx4 v205, s[16:19], s58 offen offset:1024 lds
    s_add_u32 m0, s59, 65536
    s_add_u32 s58, s58, 57344
    buffer_load_dwordx4 v204, s[16:19], s58 offen offset:0 lds
    buffer_load_dwordx4 v205, s[16:19], s58 offen offset:1024 lds
    s_add_u32 m0, s59, 73728
    s_add_u32 s58, s58, 57344
    buffer_load_dwordx4 v204, s[16:19], s58 offen offset:0 lds
    buffer_load_dwordx4 v205, s[16:19], s58 offen offset:1024 lds
    s_add_u32 m0, s59, 81920
    s_add_u32 s58, s58, 57344
    buffer_load_dwordx4 v204, s[16:19], s58 offen offset:0 lds
    buffer_load_dwordx4 v205, s[16:19], s58 offen offset:1024 lds
    s_add_u32 m0, s59, 90112
    s_add_u32 s58, s58, 57344
    buffer_load_dwordx4 v204, s[16:19], s58 offen offset:0 lds
    buffer_load_dwordx4 v205, s[16:19], s58 offen offset:1024 lds
    s_branch L_m1p
L_p1b:
    s_lshl_b32 s48, s76, 7
    s_add_u32 s48, s48, 0
    v_add_u32 v8, s48, v1
    v_mul_u32_u24 v9, 2341, v8
    v_lshrrev_b32 v9, 16, v9
    v_mul_u32_u24 v10, 28, v9
    v_sub_u32 v8, v8, v10
    v_mul_u32_u24 v9, 2688, v9
    v_lshl_add_u32 v4, v8, 4, v9
    s_mul_i32 s48, s69, 448
    s_sub_u32 s48, s48, 0
    v_add_u32 v4, s48, v4
    s_lshl_b32 s48, s76, 7
    s_add_u32 s48, s48, 64
    v_add_u32 v8, s48, v1
    v_mul_u32_u24 v9, 2341, v8
    v_lshrrev_b32 v9, 16, v9
    v_mul_u32_u24 v10, 28, v9
    v_sub_u32 v8, v8, v10
    v_mul_u32_u24 v9, 2688, v9
    v_lshl_add_u32 v5, v8, 4, v9
    s_mul_i32 s48, s69, 448
    s_sub_u32 s48, s48, 1024
    v_add_u32 v5, s48, v5
    s_lshl_b32 s79, s76, 11
    s_mov_b32 s77, 0xffff5800
    s_cmp_eq_u32 s76, 3
    s_cbranch_scc1 L_b3_32
    s_add_u32 m0, s79, 0
    s_add_u32 s77, s77, 43008
    buffer_load_dwordx4 v4, s[8:11], s77 offen offset:0 lds
    buffer_load_dwordx4 v5, s[8:11], s77 offen offset:1024 lds
    s_add_u32 m0, s79, 7168
    s_add_u32 s77, s77, 43008
    buffer_load_dwordx4 v4, s[8:11], s77 offen offset:0 lds
    buffer_load_dwordx4 v5, s[8:11], s77 offen offset:1024 lds
    s_add_u32 m0, s79, 14336
    s_add_u32 s77, s77, 43008
    buffer_load_dwordx4 v4, s[8:11], s77 offen offset:0 lds
    buffer_load_dwordx4 v5, s[8:11], s77 offen offset:1024 lds
    s_add_u32 m0, s79, 21504
    s_add_u32 s77, s77, 43008
    buffer_load_dwordx4 v4, s[8:11], s77 offen offset:0 lds
    buffer_load_dwordx4 v5, s[8:11], s77 offen offset:1024 lds
    s_add_u32 m0, s79, 28672
    s_add_u32 s77, s77, 43008
    buffer_load_dwordx4 v4, s[8:11], s77 offen offset:0 lds
    buffer_load_dwordx4 v5, s[8:11], s77 offen offset:1024 lds
    s_add_u32 m0, s79, 35840
    s_add_u32 s77, s77, 43008
    buffer_load_dwordx4 v4, s[8:11], s77 offen offset:0 lds
    buffer_load_dwordx4 v5, s[8:11], s77 offen offset:1024 lds
    s_add_u32 m0, s79, 43008
    s_add_u32 s77, s77, 43008
    buffer_load_dwordx4 v4, s[8:11], s77 offen offset:0 lds
    buffer_load_dwordx4 v5, s[8:11], s77 offen offset:1024 lds
    s_add_u32 m0, s79, 50176
    s_add_u32 s77, s77, 43008
    buffer_load_dwordx4 v4, s[8:11], s77 offen offset:0 lds
    buffer_load_dwordx4 v5, s[8:11], s77 offen offset:1024 lds
    s_add_u32 m0, s79, 57344
    s_add_u32 s77, s77, 43008
    buffer_load_dwordx4 v4, s[8:11], s77 offen offset:0 lds
    buffer_load_dwordx4 v5, s[8:11], s77 offen offset:1024 lds
    s_add_u32 m0, s79, 64512
    s_add_u32 s77, s77, 43008
    buffer_load_dwordx4 v4, s[8:11], s77 offen offset:0 lds
    buffer_load_dwordx4 v5, s[8:11], s77 offen offset:1024 lds
    s_add_u32 m0, s79, 71680
    s_add_u32 s77, s77, 43008
    buffer_load_dwordx4 v4, s[8:11], s77 offen offset:0 lds
    buffer_load_dwordx4 v5, s[8:11], s77 offen offset:1024 lds
    s_add_u32 m0, s79, 78848
    s_add_u32 s77, s77, 43008
    buffer_load_dwordx4 v4, s[8:11], s77 offen offset:0 lds
    buffer_load_dwordx4 v5, s[8:11], s77 offen offset:1024 lds
    s_lshl_b32 s59, s76, 11
    v_lshrrev_b32 v232, 3, v1
    v_bfe_u32 v233, v1, 4, 1
    v_lshlrev_b32 v233, 2, v233
    v_and_b32 v234, 7, v1
    v_xor_b32 v233, v233, v234
    v_lshlrev_b32 v233, 4, v233
    s_and_b32 s60, s75, 3
    s_lshl_b32 s60, s60, 1
    s_mul_i32 s48, s73, 128
    s_mul_i32 s49, s76, 1835008
    s_add_u32 s48, s48, s49
    v_mul_u32_u24 v234, 3584, v232
    v_add3_u32 v204, v234, v233, s48
    v_add_u32 v205, 27648, v204
    s_mul_i32 s48, s74, 128
    s_mul_i32 s49, s76, 1835008
    s_add_u32 s48, s48, s49
    v_mul_u32_u24 v234, 4096, v232
    v_add3_u32 v206, v234, v233, s48
    v_add_u32 v207, 31744, v206
    s_mul_i32 s48, s75, 128
    s_mul_i32 s49, s76, 100352
    s_add_u32 s48, s48, s49
    v_mul_u32_u24 v234, 896, v232
    v_add3_u32 v208, v234, v233, s48
    v_add_u32 v209, 6144, v208
    v_lshrrev_b32 v232, 5, v1
    v_mul_u32_u24 v232, 7168, v232
    v_and_b32 v233, 31, v1
    v_lshl_add_u32 v232, v233, 4, v232
    v_mov_b32 v234, 0x40000000
    v_cmp_gt_u32 vcc, 24, v233
    s_lshl_b32 s48, s75, 10
    v_add_u32 v212, s48, v232
    v_add_u32 v213, 512, v212
    s_mul_i32 s48, s72, 896
    v_add_u32 v232, s48, v232
    v_add_u32 v233, 512, v232
    v_cndmask_b32 v233, v234, v233, vcc
    s_bitcmp1_b32 s76, 0
    s_cselect_b64 vcc, -1, 0
    v_lshlrev_b32 v214, 4, v1
    v_add_u32 v215, 0x8000, v214
    v_cndmask_b32 v210, v232, v233, vcc
    v_cndmask_b32 v211, v233, v232, vcc
    v_bfe_u32 v232, v1, 2, 2
    v_bfe_u32 v233, v1, 4, 1
    v_bfe_u32 v234, v1, 1, 1
    v_lshl_add_u32 v233, v233, 1, v234
    v_lshrrev_b32 v234, 1, v232
    v_lshlrev_b32 v234, 2, v234
    v_xor_b32 v233, v233, v234
    v_lshlrev_b32 v233, 4, v233
    v_and_b32 v234, 1, v1
    v_lshl_add_u32 v233, v234, 3, v233
    v_lshl_add_u32 v232, v232, 7, v233
    v_add_u32 v232, s59, v232
    v_lshrrev_b32 v233, 5, v1
    v_lshl_add_u32 v220, v233, 9, v232
    v_xor_b32 v221, 64, v220
    v_lshl_add_u32 v216, v233, 10, v232
    s_lshl_b32 s48, s76, 5
    s_and_b32 s48, s48, 64
    v_xor_b32 v216, s48, v216
    v_xor_b32 v217, 64, v216
    v_add_u32 v218, 0x10000, v216
    v_add_u32 v219, 0x10000, v217
    v_add_u32 v222, 0x10000, v220
    v_add_u32 v223, 0x10000, v221
    s_waitcnt vmcnt(20)
    s_barrier
    s_waitcnt vmcnt(16)
    s_barrier
    s_add_u32 m0, s79, 86016
    s_add_u32 s77, s77, 43008
    buffer_load_dwordx4 v4, s[8:11], s77 offen offset:0 lds
    buffer_load_dwordx4 v5, s[8:11], s77 offen offset:1024 lds
    s_add_u32 m0, s79, 93184
    s_add_u32 s77, s77, 43008
    buffer_load_dwordx4 v4, s[8:11], s77 offen offset:0 lds
    buffer_load_dwordx4 v5, s[8:11], s77 offen offset:1024 lds
    s_add_u32 m0, s79, 0
    s_add_u32 s77, s77, 43008
    buffer_load_dwordx4 v4, s[8:11], s77 offen offset:0 lds
    buffer_load_dwordx4 v5, s[8:11], s77 offen offset:1024 lds
    s_waitcnt vmcnt(18)
    s_barrier
    s_add_u32 m0, s79, 7168
    s_add_u32 s77, s77, 43008
    buffer_load_dwordx4 v4, s[8:11], s77 offen offset:0 lds
    buffer_load_dwordx4 v5, s[8:11], s77 offen offset:1024 lds
    s_add_u32 m0, s79, 14336
    s_add_u32 s77, s77, 43008
    buffer_load_dwordx4 v4, s[8:11], s77 offen offset:0 lds
    buffer_load_dwordx4 v5, s[8:11], s77 offen offset:1024 lds
    s_add_u32 m0, s79, 21504
    s_add_u32 s77, s77, 43008
    buffer_load_dwordx4 v4, s[8:11], s77 offen offset:0 lds
    buffer_load_dwordx4 v5, s[8:11], s77 offen offset:1024 lds
    s_waitcnt vmcnt(20)
    s_barrier
    s_add_u32 m0, s79, 28672
    s_add_u32 s77, s77, 43008
    buffer_load_dwordx4 v4, s[8:11], s77 offen offset:0 lds
    buffer_load_dwordx4 v5, s[8:11], s77 offen offset:1024 lds
    s_add_u32 m0, s79, 35840
    s_add_u32 s77, s77, 43008
    buffer_load_dwordx4 v4, s[8:11], s77 offen offset:0 lds
    buffer_load_dwordx4 v5, s[8:11], s77 offen offset:1024 lds
    s_waitcnt vmcnt(20)
    s_barrier
    s_add_u32 m0, s79, 43008
    s_add_u32 s77, s77, 43008
    buffer_load_dwordx4 v4, s[8:11], s77 offen offset:0 lds
    buffer_load_dwordx4 v5, s[8:11], s77 offen offset:1024 lds
    s_add_u32 m0, s79, 50176
    s_add_u32 s77, s77, 43008
    buffer_load_dwordx4 v4, s[8:11], s77 offen offset:0 lds
    buffer_load_dwordx4 v5, s[8:11], s77 offen offset:1024 lds
    s_waitcnt vmcnt(20)
    s_barrier
    s_add_u32 m0, s79, 57344
    s_add_u32 s77, s77, 43008
    buffer_load_dwordx4 v4, s[8:11], s77 offen offset:0 lds
    buffer_load_dwordx4 v5, s[8:11], s77 offen offset:1024 lds
    s_add_u32 m0, s79, 64512
    s_add_u32 s77, s77, 43008
    buffer_load_dwordx4 v4, s[8:11], s77 offen offset:0 lds
    buffer_load_dwordx4 v5, s[8:11], s77 offen offset:1024 lds
    s_waitcnt vmcnt(20)
    s_barrier
    s_add_u32 m0, s79, 71680
    s_add_u32 s77, s77, 43008
    buffer_load_dwordx4 v4, s[8:11], s77 offen offset:0 lds
    buffer_load_dwordx4 v5, s[8:11], s77 offen offset:1024 lds
    s_add_u32 m0, s79, 78848
    s_add_u32 s77, s77, 43008
    buffer_load_dwordx4 v4, s[8:11], s77 offen offset:0 lds
    buffer_load_dwordx4 v5, s[8:11], s77 offen offset:1024 lds
    s_waitcnt vmcnt(20)
    s_barrier
    s_add_u32 m0, s79, 86016
    s_add_u32 s77, s77, 43008
    buffer_load_dwordx4 v4, s[8:11], s77 offen offset:0 lds
    buffer_load_dwordx4 v5, s[8:11], s77 offen offset:1024 lds
    s_add_u32 m0, s79, 93184
    s_add_u32 s77, s77, 43008
    buffer_load_dwordx4 v4, s[8:11], s77 offen offset:0 lds
    buffer_load_dwordx4 v5, s[8:11], s77 offen offset:1024 lds
    s_waitcnt vmcnt(20)
    s_barrier
    s_waitcnt vmcnt(0)
    s_barrier
    s_branch L_bj_33
L_b3_32:
    s_add_u32 m0, s79, 0
    s_add_u32 s77, s77, 43008
    buffer_load_dwordx4 v4, s[8:11], s77 offen offset:0 lds
    s_add_u32 m0, s79, 7168
    s_add_u32 s77, s77, 43008
    buffer_load_dwordx4 v4, s[8:11], s77 offen offset:0 lds
    s_add_u32 m0, s79, 14336
    s_add_u32 s77, s77, 43008
    buffer_load_dwordx4 v4, s[8:11], s77 offen offset:0 lds
    s_add_u32 m0, s79, 21504
    s_add_u32 s77, s77, 43008
    buffer_load_dwordx4 v4, s[8:11], s77 offen offset:0 lds
    s_add_u32 m0, s79, 28672
    s_add_u32 s77, s77, 43008
    buffer_load_dwordx4 v4, s[8:11], s77 offen offset:0 lds
    s_add_u32 m0, s79, 35840
    s_add_u32 s77, s77, 43008
    buffer_load_dwordx4 v4, s[8:11], s77 offen offset:0 lds
    s_add_u32 m0, s79, 43008
    s_add_u32 s77, s77, 43008
    buffer_load_dwordx4 v4, s[8:11], s77 offen offset:0 lds
    s_add_u32 m0, s79, 50176
    s_add_u32 s77, s77, 43008
    buffer_load_dwordx4 v4, s[8:11], s77 offen offset:0 lds
    s_add_u32 m0, s79, 57344
    s_add_u32 s77, s77, 43008
    buffer_load_dwordx4 v4, s[8:11], s77 offen offset:0 lds
    s_add_u32 m0, s79, 64512
    s_add_u32 s77, s77, 43008
    buffer_load_dwordx4 v4, s[8:11], s77 offen offset:0 lds
    s_add_u32 m0, s79, 71680
    s_add_u32 s77, s77, 43008
    buffer_load_dwordx4 v4, s[8:11], s77 offen offset:0 lds
    s_add_u32 m0, s79, 78848
    s_add_u32 s77, s77, 43008
    buffer_load_dwordx4 v4, s[8:11], s77 offen offset:0 lds
    s_lshl_b32 s59, s76, 11
    v_lshrrev_b32 v232, 3, v1
    v_bfe_u32 v233, v1, 4, 1
    v_lshlrev_b32 v233, 2, v233
    v_and_b32 v234, 7, v1
    v_xor_b32 v233, v233, v234
    v_lshlrev_b32 v233, 4, v233
    s_and_b32 s60, s75, 3
    s_lshl_b32 s60, s60, 1
    s_mul_i32 s48, s73, 128
    s_mul_i32 s49, s76, 1835008
    s_add_u32 s48, s48, s49
    v_mul_u32_u24 v234, 3584, v232
    v_add3_u32 v204, v234, v233, s48
    v_add_u32 v205, 27648, v204
    s_mul_i32 s48, s74, 128
    s_mul_i32 s49, s76, 1835008
    s_add_u32 s48, s48, s49
    v_mul_u32_u24 v234, 4096, v232
    v_add3_u32 v206, v234, v233, s48
    v_add_u32 v207, 31744, v206
    s_mul_i32 s48, s75, 128
    s_mul_i32 s49, s76, 100352
    s_add_u32 s48, s48, s49
    v_mul_u32_u24 v234, 896, v232
    v_add3_u32 v208, v234, v233, s48
    v_add_u32 v209, 6144, v208
    v_lshrrev_b32 v232, 5, v1
    v_mul_u32_u24 v232, 7168, v232
    v_and_b32 v233, 31, v1
    v_lshl_add_u32 v232, v233, 4, v232
    v_mov_b32 v234, 0x40000000
    v_cmp_gt_u32 vcc, 24, v233
    s_lshl_b32 s48, s75, 10
    v_add_u32 v212, s48, v232
    v_add_u32 v213, 512, v212
    s_mul_i32 s48, s72, 896
    v_add_u32 v232, s48, v232
    v_add_u32 v233, 512, v232
    v_cndmask_b32 v233, v234, v233, vcc
    s_bitcmp1_b32 s76, 0
    s_cselect_b64 vcc, -1, 0
    v_lshlrev_b32 v214, 4, v1
    v_add_u32 v215, 0x8000, v214
    v_cndmask_b32 v210, v232, v233, vcc
    v_cndmask_b32 v211, v233, v232, vcc
    v_bfe_u32 v232, v1, 2, 2
    v_bfe_u32 v233, v1, 4, 1
    v_bfe_u32 v234, v1, 1, 1
    v_lshl_add_u32 v233, v233, 1, v234
    v_lshrrev_b32 v234, 1, v232
    v_lshlrev_b32 v234, 2, v234
    v_xor_b32 v233, v233, v234
    v_lshlrev_b32 v233, 4, v233
    v_and_b32 v234, 1, v1
    v_lshl_add_u32 v233, v234, 3, v233
    v_lshl_add_u32 v232, v232, 7, v233
    v_add_u32 v232, s59, v232
    v_lshrrev_b32 v233, 5, v1
    v_lshl_add_u32 v220, v233, 9, v232
    v_xor_b32 v221, 64, v220
    v_lshl_add_u32 v216, v233, 10, v232
    s_lshl_b32 s48, s76, 5
    s_and_b32 s48, s48, 64
    v_xor_b32 v216, s48, v216
    v_xor_b32 v217, 64, v216
    v_add_u32 v218, 0x10000, v216
    v_add_u32 v219, 0x10000, v217
    v_add_u32 v222, 0x10000, v220
    v_add_u32 v223, 0x10000, v221
    s_waitcnt vmcnt(10)
    s_barrier
    s_waitcnt vmcnt(8)
    s_barrier
    s_add_u32 m0, s79, 86016
    s_add_u32 s77, s77, 43008
    buffer_load_dwordx4 v4, s[8:11], s77 offen offset:0 lds
    s_add_u32 m0, s79, 93184
    s_add_u32 s77, s77, 43008
    buffer_load_dwordx4 v4, s[8:11], s77 offen offset:0 lds
    s_add_u32 m0, s79, 0
    s_add_u32 s77, s77, 43008
    buffer_load_dwordx4 v4, s[8:11], s77 offen offset:0 lds
    s_waitcnt vmcnt(9)
    s_barrier
    s_add_u32 m0, s79, 7168
    s_add_u32 s77, s77, 43008
    buffer_load_dwordx4 v4, s[8:11], s77 offen offset:0 lds
    s_add_u32 m0, s79, 14336
    s_add_u32 s77, s77, 43008
    buffer_load_dwordx4 v4, s[8:11], s77 offen offset:0 lds
    s_add_u32 m0, s79, 21504
    s_add_u32 s77, s77, 43008
    buffer_load_dwordx4 v4, s[8:11], s77 offen offset:0 lds
    s_waitcnt vmcnt(10)
    s_barrier
    s_add_u32 m0, s79, 28672
    s_add_u32 s77, s77, 43008
    buffer_load_dwordx4 v4, s[8:11], s77 offen offset:0 lds
    s_add_u32 m0, s79, 35840
    s_add_u32 s77, s77, 43008
    buffer_load_dwordx4 v4, s[8:11], s77 offen offset:0 lds
    s_waitcnt vmcnt(10)
    s_barrier
    s_add_u32 m0, s79, 43008
    s_add_u32 s77, s77, 43008
    buffer_load_dwordx4 v4, s[8:11], s77 offen offset:0 lds
    s_add_u32 m0, s79, 50176
    s_add_u32 s77, s77, 43008
    buffer_load_dwordx4 v4, s[8:11], s77 offen offset:0 lds
    s_waitcnt vmcnt(10)
    s_barrier
    s_add_u32 m0, s79, 57344
    s_add_u32 s77, s77, 43008
    buffer_load_dwordx4 v4, s[8:11], s77 offen offset:0 lds
    s_add_u32 m0, s79, 64512
    s_add_u32 s77, s77, 43008
    buffer_load_dwordx4 v4, s[8:11], s77 offen offset:0 lds
    s_waitcnt vmcnt(10)
    s_barrier
    s_add_u32 m0, s79, 71680
    s_add_u32 s77, s77, 43008
    buffer_load_dwordx4 v4, s[8:11], s77 offen offset:0 lds
    s_add_u32 m0, s79, 78848
    s_add_u32 s77, s77, 43008
    buffer_load_dwordx4 v4, s[8:11], s77 offen offset:0 lds
    s_waitcnt vmcnt(10)
    s_barrier
    s_add_u32 m0, s79, 86016
    s_add_u32 s77, s77, 43008
    buffer_load_dwordx4 v4, s[8:11], s77 offen offset:0 lds
    s_add_u32 m0, s79, 93184
    s_add_u32 s77, s77, 43008
    buffer_load_dwordx4 v4, s[8:11], s77 offen offset:0 lds
    s_waitcnt vmcnt(10)
    s_barrier
    s_waitcnt vmcnt(0)
    s_barrier
L_bj_33:
    v_mov_b32 v186, 0
    buffer_load_dwordx2 v[184:185], v186, s[36:39], 0 offen sc1
    s_lshl_b32 s48, s73, 7
    s_lshl_b32 s49, s76, 5
    s_and_b32 s49, s49, 64
    s_add_u32 s48, s48, s49
    v_lshrrev_b32 v232, 5, v1
    v_lshl_add_u32 v232, v232, 3, s48
    buffer_load_dwordx2 v[224:225], v232, s[24:27], 0 offen offset:0
    buffer_load_dwordx2 v[226:227], v232, s[24:27], 0 offen offset:16
    buffer_load_dwordx2 v[228:229], v232, s[24:27], 0 offen offset:32
    buffer_load_dwordx2 v[230:231], v232, s[24:27], 0 offen offset:48
    v_lshrrev_b32 v244, 3, v0
    v_and_b32 v245, 7, v0
    v_mul_u32_u24 v246, 272, v244
    v_lshl_add_u32 v246, v245, 5, v246
    v_add_u32 v246, 90112, v246
    s_lshl_b32 s48, s74, 6
    v_add_u32 v244, s48, v244
    v_mul_u32_u24 v247, 896, v244
    v_lshl_add_u32 v247, v245, 4, v247
    s_lshl_b32 s48, s75, 7
    v_add_u32 v247, s48, v247
    v_lshlrev_b32 v244, 1, v244
    buffer_load_dwordx4 v[248:251], v247, s[4:7], 0 offen
    buffer_load_ushort v252, v244, s[28:31], 0 offen
    s_add_u32 m0, s59, 0
    s_mov_b32 s58, 0
    buffer_load_dwordx4 v204, s[16:19], s58 offen offset:0 lds
    buffer_load_dwordx4 v205, s[16:19], s58 offen offset:1024 lds
    s_add_u32 m0, s59, 8192
    s_add_u32 s58, s58, 57344
    buffer_load_dwordx4 v204, s[16:19], s58 offen offset:0 lds
    buffer_load_dwordx4 v205, s[16:19], s58 offen offset:1024 lds
    s_add_u32 m0, s59, 16384
    s_add_u32 s58, s58, 57344
    buffer_load_dwordx4 v204, s[16:19], s58 offen offset:0 lds
    buffer_load_dwordx4 v205, s[16:19], s58 offen offset:1024 lds
    v_mov_b32 v8, 163648
    s_mov_b32 s80, 0
L_pw_34:
    s_sleep 1
    ds_read_b128 v[12:15], v8
    s_add_u32 s80, s80, 1
    s_waitcnt lgkmcnt(0)
    v_min3_u32 v12, v12, v13, v14
    v_min_u32 v12, v12, v15
    s_cmp_ge_u32 s80, 0x400000
    v_readfirstlane_b32 s48, v12
    s_cbranch_scc1 L_pwe_35
    s_cmp_lt_u32 s48, 1
    s_cbranch_scc1 L_pw_34
L_pwe_35:
    s_add_u32 m0, s59, 24576
    s_add_u32 s58, s58, 57344
    buffer_load_dwordx4 v204, s[16:19], s58 offen offset:0 lds
    buffer_load_dwordx4 v205, s[16:19], s58 offen offset:1024 lds
    s_add_u32 m0, s59, 32768
    s_add_u32 s58, s58, 57344
    buffer_load_dwordx4 v204, s[16:19], s58 offen offset:0 lds
    buffer_load_dwordx4 v205, s[16:19], s58 offen offset:1024 lds
    v_mov_b32 v8, 163648
    s_mov_b32 s80, 0
L_pw_36:
    s_sleep 1
    ds_read_b128 v[12:15], v8
    s_add_u32 s80, s80, 1
    s_waitcnt lgkmcnt(0)
    v_min3_u32 v12, v12, v13, v14
    v_min_u32 v12, v12, v15
    s_cmp_ge_u32 s80, 0x400000
    v_readfirstlane_b32 s48, v12
    s_cbranch_scc1 L_pwe_37
    s_cmp_lt_u32 s48, 2
    s_cbranch_scc1 L_pw_36
L_pwe_37:
    s_add_u32 m0, s59, 40960
    s_add_u32 s58, s58, 57344
    buffer_load_dwordx4 v204, s[16:19], s58 offen offset:0 lds
    buffer_load_dwordx4 v205, s[16:19], s58 offen offset:1024 lds
    s_add_u32 m0, s59, 49152
    s_add_u32 s58, s58, 57344
    buffer_load_dwordx4 v204, s[16:19], s58 offen offset:0 lds
    buffer_load_dwordx4 v205, s[16:19], s58 offen offset:1024 lds
    v_mov_b32 v8, 163648
    s_mov_b32 s80, 0
L_pw_38:
    s_sleep 1
    ds_read_b128 v[12:15], v8
    s_add_u32 s80, s80, 1
    s_waitcnt lgkmcnt(0)
    v_min3_u32 v12, v12, v13, v14
    v_min_u32 v12, v12, v15
    s_cmp_ge_u32 s80, 0x400000
    v_readfirstlane_b32 s48, v12
    s_cbranch_scc1 L_pwe_39
    s_cmp_lt_u32 s48, 3
    s_cbranch_scc1 L_pw_38
L_pwe_39:
    s_add_u32 m0, s59, 57344
    s_add_u32 s58, s58, 57344
    buffer_load_dwordx4 v204, s[16:19], s58 offen offset:0 lds
    buffer_load_dwordx4 v205, s[16:19], s58 offen offset:1024 lds
    v_mov_b32 v8, 163648
    s_mov_b32 s80, 0
L_pw_40:
    s_sleep 1
    ds_read_b128 v[12:15], v8
    s_add_u32 s80, s80, 1
    s_waitcnt lgkmcnt(0)
    v_min3_u32 v12, v12, v13, v14
    v_min_u32 v12, v12, v15
    s_cmp_ge_u32 s80, 0x400000
    v_readfirstlane_b32 s48, v12
    s_cbranch_scc1 L_pwe_41
    s_cmp_lt_u32 s48, 4
    s_cbranch_scc1 L_pw_40
L_pwe_41:
    s_lshl_b32 s49, s76, 4
    s_add_u32 s49, s49, 192
    v_add_lshl_u32 v232, s49, v1, 7
    v_min_u32 v232, v232, v232
    v_cmp_gt_u32 vcc, 16, v1
    v_readfirstlane_b32 s49, v232
    s_nop 1
    v_mov_b32 v233, s49
    v_cndmask_b32 v232, v233, v232, vcc
    buffer_load_dwordx2 v[234:235], v232, s[40:43], 0 offen sc1
    s_add_u32 m0, s59, 65536
    s_add_u32 s58, s58, 57344
    buffer_load_dwordx4 v204, s[16:19], s58 offen offset:0 lds
    buffer_load_dwordx4 v205, s[16:19], s58 offen offset:1024 lds
    s_add_u32 m0, s59, 73728
    s_add_u32 s58, s58, 57344
    buffer_load_dwordx4 v204, s[16:19], s58 offen offset:0 lds
    buffer_load_dwordx4 v205, s[16:19], s58 offen offset:1024 lds
    v_mov_b32 v8, 163648
    s_mov_b32 s80, 0
L_pw_42:
    s_sleep 1
    ds_read_b128 v[12:15], v8
    s_add_u32 s80, s80, 1
    s_waitcnt lgkmcnt(0)
    v_min3_u32 v12, v12, v13, v14
    v_min_u32 v12, v12, v15
    s_cmp_ge_u32 s80, 0x400000
    v_readfirstlane_b32 s48, v12
    s_cbranch_scc1 L_pwe_43
    s_cmp_lt_u32 s48, 5
    s_cbranch_scc1 L_pw_42
L_pwe_43:
    s_add_u32 m0, s59, 81920
    s_add_u32 s58, s58, 57344
    buffer_load_dwordx4 v204, s[16:19], s58 offen offset:0 lds
    buffer_load_dwordx4 v205, s[16:19], s58 offen offset:1024 lds
    s_add_u32 m0, s59, 90112
    s_add_u32 s58, s58, 57344
    buffer_load_dwordx4 v204, s[16:19], s58 offen offset:0 lds
    buffer_load_dwordx4 v205, s[16:19], s58 offen offset:1024 lds
    s_waitcnt vmcnt(8)
    v_readfirstlane_b32 s64, v184
    v_readfirstlane_b32 s65, v185
    s_cmp_eq_u32 s64, 0
    s_cbranch_scc1 L_m1t
    v_cmp_ne_u64 vcc, s[64:65], v[234:235]
    s_cbranch_vccnz L_m1p
    s_branch L_m1e
L_m1t:
    s_mov_b32 s80, 0
L_tag_44:
    v_mov_b32 v6, 0
    buffer_load_dwordx2 v[4:5], v6, s[36:39], 0 offen sc1
    s_add_u32 s80, s80, 1
    s_cmp_ge_u32 s80, 0x100000
    s_waitcnt vmcnt(0)
    s_cbranch_scc1 L_tage_45
L_tagf_46:
    v_readfirstlane_b32 s64, v4
    v_readfirstlane_b32 s65, v5
    s_cmp_eq_u32 s64, 0
    s_cbranch_scc1 L_tag_44
L_tage_45:
L_m1p:
    s_lshl_b32 s49, s76, 4
    s_add_u32 s49, s49, 192
    v_add_lshl_u32 v232, s49, v1, 7
    s_mov_b64 exec, 0xffff
    s_mov_b32 s80, 0
    s_branch L_pollf_49
L_poll_47:
    s_sleep 2
L_pollf_49:
    buffer_load_dwordx2 v[234:235], v232, s[40:43], 0 offen sc1
    s_add_u32 s80, s80, 1
    s_cmp_ge_u32 s80, 0x100000
    s_waitcnt vmcnt(0)
    s_cbranch_scc1 L_polle_48
    v_cmp_ne_u64 vcc, s[64:65], v[234:235]
    s_cbranch_vccnz L_poll_47
L_polle_48:
    s_mov_b64 exec, -1
L_m1e:
    s_mul_i32 s81, s76, 458752
    s_add_u32 s81, s81, 0x640000
    s_mov_b32 s78, s81
    buffer_load_dwordx4 v[84:87], v210, s[40:43], s78 offen sc1
    buffer_load_dwordx4 v[88:91], v211, s[40:43], s78 offen sc1
    s_add_u32 s78, s78, 14336
    buffer_load_dwordx4 v[92:95], v210, s[40:43], s78 offen sc1
    buffer_load_dwordx4 v[96:99], v211, s[40:43], s78 offen sc1
    s_add_u32 s78, s78, 14336
    buffer_load_dwordx4 v[100:103], v210, s[40:43], s78 offen sc1
    buffer_load_dwordx4 v[104:107], v211, s[40:43], s78 offen sc1
    s_add_u32 s78, s78, 14336
    buffer_load_dwordx4 v[108:111], v210, s[40:43], s78 offen sc1
    buffer_load_dwordx4 v[112:115], v211, s[40:43], s78 offen sc1
    s_add_u32 s78, s78, 14336
    buffer_load_dwordx4 v[116:119], v210, s[40:43], s78 offen sc1
    buffer_load_dwordx4 v[120:123], v211, s[40:43], s78 offen sc1
    s_add_u32 s78, s78, 14336
    buffer_load_dwordx4 v[124:127], v210, s[40:43], s78 offen sc1
    buffer_load_dwordx4 v[128:131], v211, s[40:43], s78 offen sc1
    s_waitcnt vmcnt(10)
    ds_read_b64_tr_b16 v[68:69], v216 offset:0
    ds_read_b64_tr_b16 v[70:71], v216 offset:512
    ds_read_b64_tr_b16 v[72:73], v217 offset:0
    ds_read_b64_tr_b16 v[74:75], v217 offset:512
    ds_read_b64_tr_b16 v[76:77], v216 offset:8192
    ds_read_b64_tr_b16 v[78:79], v216 offset:8704
    ds_read_b64_tr_b16 v[80:81], v217 offset:8192
    ds_read_b64_tr_b16 v[82:83], v217 offset:8704
    s_waitcnt lgkmcnt(4)
    v_mfma_f32_32x32x16_bf16 v[4:19], v[68:71], v[84:87], 0
    v_mfma_f32_32x32x16_bf16 v[20:35], v[68:71], v[88:91], 0
    s_add_u32 m0, s59, 0
    s_add_u32 s58, s58, 57344
    buffer_load_dwordx4 v204, s[16:19], s58 offen offset:0 lds
    buffer_load_dwordx4 v205, s[16:19], s58 offen offset:1024 lds
    v_mfma_f32_32x32x16_bf16 v[36:51], v[72:75], v[84:87], 0
    v_mfma_f32_32x32x16_bf16 v[52:67], v[72:75], v[88:91], 0
    s_add_u32 s78, s78, 14336
    buffer_load_dwordx4 v[84:87], v210, s[40:43], s78 offen sc1
    buffer_load_dwordx4 v[88:91], v211, s[40:43], s78 offen sc1
    s_waitcnt vmcnt(12)
    ds_read_b64_tr_b16 v[68:69], v216 offset:16384
    ds_read_b64_tr_b16 v[70:71], v216 offset:16896
    ds_read_b64_tr_b16 v[72:73], v217 offset:16384
    ds_read_b64_tr_b16 v[74:75], v217 offset:16896
    s_waitcnt lgkmcnt(4)
    v_mfma_f32_32x32x16_bf16 v[4:19], v[76:79], v[92:95], v[4:19]
    v_mfma_f32_32x32x16_bf16 v[20:35], v[76:79], v[96:99], v[20:35]
    s_add_u32 m0, s59, 8192
    s_add_u32 s58, s58, 57344
    buffer_load_dwordx4 v204, s[16:19], s58 offen offset:0 lds
    buffer_load_dwordx4 v205, s[16:19], s58 offen offset:1024 lds
    v_mfma_f32_32x32x16_bf16 v[36:51], v[80:83], v[92:95], v[36:51]
    v_mfma_f32_32x32x16_bf16 v[52:67], v[80:83], v[96:99], v[52:67]
    s_add_u32 s78, s78, 14336
    buffer_load_dwordx4 v[92:95], v210, s[40:43], s78 offen sc1
    buffer_load_dwordx4 v[96:99], v211, s[40:43], s78 offen sc1
    s_waitcnt vmcnt(14)
    ds_read_b64_tr_b16 v[76:77], v216 offset:24576
    ds_read_b64_tr_b16 v[78:79], v216 offset:25088
    ds_read_b64_tr_b16 v[80:81], v217 offset:24576
    ds_read_b64_tr_b16 v[82:83], v217 offset:25088
    s_waitcnt lgkmcnt(4)
    v_mfma_f32_32x32x16_bf16 v[4:19], v[68:71], v[100:103], v[4:19]
    v_mfma_f32_32x32x16_bf16 v[20:35], v[68:71], v[104:107], v[20:35]
    s_add_u32 m0, s59, 16384
    s_add_u32 s58, s58, 57344
    buffer_load_dwordx4 v204, s[16:19], s58 offen offset:0 lds
    buffer_load_dwordx4 v205, s[16:19], s58 offen offset:1024 lds
    v_mfma_f32_32x32x16_bf16 v[36:51], v[72:75], v[100:103], v[36:51]
    v_mfma_f32_32x32x16_bf16 v[52:67], v[72:75], v[104:107], v[52:67]
    s_add_u32 s78, s78, 14336
    buffer_load_dwordx4 v[100:103], v210, s[40:43], s78 offen sc1
    buffer_load_dwordx4 v[104:107], v211, s[40:43], s78 offen sc1
    s_waitcnt vmcnt(16)
    ds_read_b64_tr_b16 v[68:69], v216 offset:32768
    ds_read_b64_tr_b16 v[70:71], v216 offset:33280
    ds_read_b64_tr_b16 v[72:73], v217 offset:32768
    ds_read_b64_tr_b16 v[74:75], v217 offset:33280
    s_waitcnt lgkmcnt(4)
    v_mfma_f32_32x32x16_bf16 v[4:19], v[76:79], v[108:111], v[4:19]
    v_mfma_f32_32x32x16_bf16 v[20:35], v[76:79], v[112:115], v[20:35]
    s_add_u32 m0, s59, 24576
    s_add_u32 s58, s58, 57344
    buffer_load_dwordx4 v204, s[16:19], s58 offen offset:0 lds
    buffer_load_dwordx4 v205, s[16:19], s58 offen offset:1024 lds
    v_mfma_f32_32x32x16_bf16 v[36:51], v[80:83], v[108:111], v[36:51]
    v_mfma_f32_32x32x16_bf16 v[52:67], v[80:83], v[112:115], v[52:67]
    s_add_u32 s78, s78, 14336
    buffer_load_dwordx4 v[108:111], v210, s[40:43], s78 offen sc1
    buffer_load_dwordx4 v[112:115], v211, s[40:43], s78 offen sc1
    s_waitcnt vmcnt(18)
    ds_read_b64_tr_b16 v[76:77], v216 offset:40960
    ds_read_b64_tr_b16 v[78:79], v216 offset:41472
    ds_read_b64_tr_b16 v[80:81], v217 offset:40960
    ds_read_b64_tr_b16 v[82:83], v217 offset:41472
    s_waitcnt lgkmcnt(4)
    v_mfma_f32_32x32x16_bf16 v[4:19], v[68:71], v[116:119], v[4:19]
    v_mfma_f32_32x32x16_bf16 v[20:35], v[68:71], v[120:123], v[20:35]
    v_mfma_f32_32x32x16_bf16 v[36:51], v[72:75], v[116:119], v[36:51]
    v_mfma_f32_32x32x16_bf16 v[52:67], v[72:75], v[120:123], v[52:67]
    s_add_u32 s78, s78, 14336
    buffer_load_dwordx4 v[116:119], v210, s[40:43], s78 offen sc1
    buffer_load_dwordx4 v[120:123], v211, s[40:43], s78 offen sc1
    s_waitcnt vmcnt(18)
    ds_read_b64_tr_b16 v[68:69], v216 offset:49152
    ds_read_b64_tr_b16 v[70:71], v216 offset:49664
    ds_read_b64_tr_b16 v[72:73], v217 offset:49152
    ds_read_b64_tr_b16 v[74:75], v217 offset:49664
    s_waitcnt lgkmcnt(4)
    v_mfma_f32_32x32x16_bf16 v[4:19], v[76:79], v[124:127], v[4:19]
    v_mfma_f32_32x32x16_bf16 v[20:35], v[76:79], v[128:131], v[20:35]
    s_add_u32 m0, s59, 32768
    s_add_u32 s58, s58, 57344
    buffer_load_dwordx4 v204, s[16:19], s58 offen offset:0 lds
    buffer_load_dwordx4 v205, s[16:19], s58 offen offset:1024 lds
    v_mfma_f32_32x32x16_bf16 v[36:51], v[80:83], v[124:127], v[36:51]
    v_mfma_f32_32x32x16_bf16 v[52:67], v[80:83], v[128:131], v[52:67]
    s_add_u32 s78, s78, 14336
    buffer_load_dwordx4 v[124:127], v210, s[40:43], s78 offen sc1
    buffer_load_dwordx4 v[128:131], v211, s[40:43], s78 offen sc1
    s_waitcnt vmcnt(18)
    ds_read_b64_tr_b16 v[76:77], v216 offset:57344
    ds_read_b64_tr_b16 v[78:79], v216 offset:57856
    ds_read_b64_tr_b16 v[80:81], v217 offset:57344
    ds_read_b64_tr_b16 v[82:83], v217 offset:57856
    s_waitcnt lgkmcnt(4)
    v_mfma_f32_32x32x16_bf16 v[4:19], v[68:71], v[84:87], v[4:19]
    v_mfma_f32_32x32x16_bf16 v[20:35], v[68:71], v[88:91], v[20:35]
    s_add_u32 m0, s59, 40960
    s_add_u32 s58, s58, 57344
    buffer_load_dwordx4 v204, s[16:19], s58 offen offset:0 lds
    buffer_load_dwordx4 v205, s[16:19], s58 offen offset:1024 lds
    v_mfma_f32_32x32x16_bf16 v[36:51], v[72:75], v[84:87], v[36:51]
    v_mfma_f32_32x32x16_bf16 v[52:67], v[72:75], v[88:91], v[52:67]
    s_add_u32 s78, s78, 14336
    buffer_load_dwordx4 v[84:87], v210, s[40:43], s78 offen sc1
    buffer_load_dwordx4 v[88:91], v211, s[40:43], s78 offen sc1
    s_waitcnt vmcnt(18)
    ds_read_b64_tr_b16 v[68:69], v218 offset:0
    ds_read_b64_tr_b16 v[70:71], v218 offset:512
    ds_read_b64_tr_b16 v[72:73], v219 offset:0
    ds_read_b64_tr_b16 v[74:75], v219 offset:512
    s_waitcnt lgkmcnt(4)
    v_mfma_f32_32x32x16_bf16 v[4:19], v[76:79], v[92:95], v[4:19]
    v_mfma_f32_32x32x16_bf16 v[20:35], v[76:79], v[96:99], v[20:35]
    v_mfma_f32_32x32x16_bf16 v[36:51], v[80:83], v[92:95], v[36:51]
    v_mfma_f32_32x32x16_bf16 v[52:67], v[80:83], v[96:99], v[52:67]
    s_add_u32 s78, s78, 14336
    buffer_load_dwordx4 v[92:95], v210, s[40:43], s78 offen sc1
    buffer_load_dwordx4 v[96:99], v211, s[40:43], s78 offen sc1
    s_waitcnt vmcnt(16)
    ds_read_b64_tr_b16 v[76:77], v218 offset:8192
    ds_read_b64_tr_b16 v[78:79], v218 offset:8704
    ds_read_b64_tr_b16 v[80:81], v219 offset:8192
    ds_read_b64_tr_b16 v[82:83], v219 offset:8704
    s_waitcnt lgkmcnt(4)
    v_mfma_f32_32x32x16_bf16 v[4:19], v[68:71], v[100:103], v[4:19]
    v_mfma_f32_32x32x16_bf16 v[20:35], v[68:71], v[104:107], v[20:35]
    s_add_u32 m0, s59, 49152
    s_add_u32 s58, s58, 57344
    buffer_load_dwordx4 v204, s[16:19], s58 offen offset:0 lds
    buffer_load_dwordx4 v205, s[16:19], s58 offen offset:1024 lds
    v_mfma_f32_32x32x16_bf16 v[36:51], v[72:75], v[100:103], v[36:51]
    v_mfma_f32_32x32x16_bf16 v[52:67], v[72:75], v[104:107], v[52:67]
    s_add_u32 s78, s78, 14336
    buffer_load_dwordx4 v[100:103], v210, s[40:43], s78 offen sc1
    buffer_load_dwordx4 v[104:107], v211, s[40:43], s78 offen sc1
    s_waitcnt vmcnt(16)
    ds_read_b64_tr_b16 v[68:69], v218 offset:16384
    ds_read_b64_tr_b16 v[70:71], v218 offset:16896
    ds_read_b64_tr_b16 v[72:73], v219 offset:16384
    ds_read_b64_tr_b16 v[74:75], v219 offset:16896
    s_waitcnt lgkmcnt(4)
    v_mfma_f32_32x32x16_bf16 v[4:19], v[76:79], v[108:111], v[4:19]
    v_mfma_f32_32x32x16_bf16 v[20:35], v[76:79], v[112:115], v[20:35]
    s_add_u32 m0, s59, 57344
    s_add_u32 s58, s58, 57344
    buffer_load_dwordx4 v204, s[16:19], s58 offen offset:0 lds
    buffer_load_dwordx4 v205, s[16:19], s58 offen offset:1024 lds
    v_mfma_f32_32x32x16_bf16 v[36:51], v[80:83], v[108:111], v[36:51]
    v_mfma_f32_32x32x16_bf16 v[52:67], v[80:83], v[112:115], v[52:67]
    s_add_u32 s78, s78, 14336
    buffer_load_dwordx4 v[108:111], v210, s[40:43], s78 offen sc1
    buffer_load_dwordx4 v[112:115], v211, s[40:43], s78 offen sc1
    s_waitcnt vmcnt(18)
    ds_read_b64_tr_b16 v[76:77], v218 offset:24576
    ds_read_b64_tr_b16 v[78:79], v218 offset:25088
    ds_read_b64_tr_b16 v[80:81], v219 offset:24576
    ds_read_b64_tr_b16 v[82:83], v219 offset:25088
    s_waitcnt lgkmcnt(4)
    v_mfma_f32_32x32x16_bf16 v[4:19], v[68:71], v[116:119], v[4:19]
    v_mfma_f32_32x32x16_bf16 v[20:35], v[68:71], v[120:123], v[20:35]
    s_add_u32 m0, s59, 65536
    s_add_u32 s58, s58, 57344
    buffer_load_dwordx4 v204, s[16:19], s58 offen offset:0 lds
    buffer_load_dwordx4 v205, s[16:19], s58 offen offset:1024 lds
    v_mfma_f32_32x32x16_bf16 v[36:51], v[72:75], v[116:119], v[36:51]
    v_mfma_f32_32x32x16_bf16 v[52:67], v[72:75], v[120:123], v[52:67]
    s_add_u32 s78, s78, 14336
    buffer_load_dwordx4 v[116:119], v210, s[40:43], s78 offen sc1
    buffer_load_dwordx4 v[120:123], v211, s[40:43], s78 offen sc1
    s_waitcnt vmcnt(18)
    ds_read_b64_tr_b16 v[68:69], v216 offset:0
    ds_read_b64_tr_b16 v[70:71], v216 offset:512
    ds_read_b64_tr_b16 v[72:73], v217 offset:0
    ds_read_b64_tr_b16 v[74:75], v217 offset:512
    s_waitcnt lgkmcnt(4)
    v_mfma_f32_32x32x16_bf16 v[4:19], v[76:79], v[124:127], v[4:19]
    v_mfma_f32_32x32x16_bf16 v[20:35], v[76:79], v[128:131], v[20:35]
    v_mfma_f32_32x32x16_bf16 v[36:51], v[80:83], v[124:127], v[36:51]
    v_mfma_f32_32x32x16_bf16 v[52:67], v[80:83], v[128:131], v[52:67]
    s_add_u32 s78, s78, 14336
    buffer_load_dwordx4 v[124:127], v210, s[40:43], s78 offen sc1
    buffer_load_dwordx4 v[128:131], v211, s[40:43], s78 offen sc1
    s_waitcnt vmcnt(16)
    ds_read_b64_tr_b16 v[76:77], v216 offset:8192
    ds_read_b64_tr_b16 v[78:79], v216 offset:8704
    ds_read_b64_tr_b16 v[80:81], v217 offset:8192
    ds_read_b64_tr_b16 v[82:83], v217 offset:8704
    s_waitcnt lgkmcnt(4)
    v_mfma_f32_32x32x16_bf16 v[4:19], v[68:71], v[84:87], v[4:19]
    v_mfma_f32_32x32x16_bf16 v[20:35], v[68:71], v[88:91], v[20:35]
    s_add_u32 m0, s59, 73728
    s_add_u32 s58, s58, 57344
    buffer_load_dwordx4 v204, s[16:19], s58 offen offset:0 lds
    buffer_load_dwordx4 v205, s[16:19], s58 offen offset:1024 lds
    v_mfma_f32_32x32x16_bf16 v[36:51], v[72:75], v[84:87], v[36:51]
    v_mfma_f32_32x32x16_bf16 v[52:67], v[72:75], v[88:91], v[52:67]
    s_add_u32 s78, s78, 14336
    buffer_load_dwordx4 v[84:87], v210, s[40:43], s78 offen sc1
    buffer_load_dwordx4 v[88:91], v211, s[40:43], s78 offen sc1
    s_waitcnt vmcnt(18)
    ds_read_b64_tr_b16 v[68:69], v216 offset:16384
    ds_read_b64_tr_b16 v[70:71], v216 offset:16896
    ds_read_b64_tr_b16 v[72:73], v217 offset:16384
    ds_read_b64_tr_b16 v[74:75], v217 offset:16896
    s_waitcnt lgkmcnt(4)
    v_mfma_f32_32x32x16_bf16 v[4:19], v[76:79], v[92:95], v[4:19]
    v_mfma_f32_32x32x16_bf16 v[20:35], v[76:79], v[96:99], v[20:35]
    s_add_u32 m0, s59, 81920
    s_add_u32 s58, s58, 57344
    buffer_load_dwordx4 v204, s[16:19], s58 offen offset:0 lds
    buffer_load_dwordx4 v205, s[16:19], s58 offen offset:1024 lds
    v_mfma_f32_32x32x16_bf16 v[36:51], v[80:83], v[92:95], v[36:51]
    v_mfma_f32_32x32x16_bf16 v[52:67], v[80:83], v[96:99], v[52:67]
    s_add_u32 s78, s78, 14336
    buffer_load_dwordx4 v[92:95], v210, s[40:43], s78 offen sc1
    buffer_load_dwordx4 v[96:99], v211, s[40:43], s78 offen sc1
    v_mov_b32 v232, 163616
    v_mov_b32 v233, 1
    s_mov_b64 exec, 1
    ds_add_u32 v232, v233
    s_mov_b64 exec, -1
    s_waitcnt vmcnt(18)
    ds_read_b64_tr_b16 v[76:77], v216 offset:24576
    ds_read_b64_tr_b16 v[78:79], v216 offset:25088
    ds_read_b64_tr_b16 v[80:81], v217 offset:24576
    ds_read_b64_tr_b16 v[82:83], v217 offset:25088
    s_waitcnt lgkmcnt(5)
    v_mfma_f32_32x32x16_bf16 v[4:19], v[68:71], v[100:103], v[4:19]
    v_mfma_f32_32x32x16_bf16 v[20:35], v[68:71], v[104:107], v[20:35]
    v_mfma_f32_32x32x16_bf16 v[36:51], v[72:75], v[100:103], v[36:51]
    v_mfma_f32_32x32x16_bf16 v[52:67], v[72:75], v[104:107], v[52:67]
    s_waitcnt vmcnt(6)
    s_add_u32 s78, s78, 14336
    buffer_load_dwordx4 v[100:103], v210, s[40:43], s78 offen sc1
    buffer_load_dwordx4 v[104:107], v211, s[40:43], s78 offen sc1
    ds_read_b64_tr_b16 v[68:69], v216 offset:32768
    ds_read_b64_tr_b16 v[70:71], v216 offset:33280
    ds_read_b64_tr_b16 v[72:73], v217 offset:32768
    ds_read_b64_tr_b16 v[74:75], v217 offset:33280
    s_waitcnt lgkmcnt(4)
    v_mfma_f32_32x32x16_bf16 v[4:19], v[76:79], v[108:111], v[4:19]
    v_mfma_f32_32x32x16_bf16 v[20:35], v[76:79], v[112:115], v[20:35]
    s_waitcnt vmcnt(6)
    s_add_u32 m0, s59, 90112
    s_add_u32 s58, s58, 57344
    buffer_load_dwordx4 v204, s[16:19], s58 offen offset:0 lds
    buffer_load_dwordx4 v205, s[16:19], s58 offen offset:1024 lds
    v_mfma_f32_32x32x16_bf16 v[36:51], v[80:83], v[108:111], v[36:51]
    v_mfma_f32_32x32x16_bf16 v[52:67], v[80:83], v[112:115], v[52:67]
    s_waitcnt vmcnt(6)
    s_add_u32 s78, s78, 14336
    buffer_load_dwordx4 v[108:111], v210, s[40:43], s78 offen sc1
    buffer_load_dwordx4 v[112:115], v211, s[40:43], s78 offen sc1
    ds_read_b64_tr_b16 v[76:77], v216 offset:40960
    ds_read_b64_tr_b16 v[78:79], v216 offset:41472
    ds_read_b64_tr_b16 v[80:81], v217 offset:40960
    ds_read_b64_tr_b16 v[82:83], v217 offset:41472
    s_waitcnt lgkmcnt(4)
    v_mfma_f32_32x32x16_bf16 v[4:19], v[68:71], v[116:119], v[4:19]
    v_mfma_f32_32x32x16_bf16 v[20:35], v[68:71], v[120:123], v[20:35]
    s_waitcnt vmcnt(6)
    s_add_u32 m0, s59, 0
    s_add_u32 s58, s58, 57344
    buffer_load_dwordx4 v204, s[16:19], s58 offen offset:0 lds
    buffer_load_dwordx4 v205, s[16:19], s58 offen offset:1024 lds
    v_mfma_f32_32x32x16_bf16 v[36:51], v[72:75], v[116:119], v[36:51]
    v_mfma_f32_32x32x16_bf16 v[52:67], v[72:75], v[120:123], v[52:67]
    s_waitcnt vmcnt(6)
    s_add_u32 s78, s78, 14336
    buffer_load_dwordx4 v[116:119], v210, s[40:43], s78 offen sc1
    buffer_load_dwordx4 v[120:123], v211, s[40:43], s78 offen sc1
    ds_read_b64_tr_b16 v[68:69], v216 offset:49152
    ds_read_b64_tr_b16 v[70:71], v216 offset:49664
    ds_read_b64_tr_b16 v[72:73], v217 offset:49152
    ds_read_b64_tr_b16 v[74:75], v217 offset:49664
    s_waitcnt lgkmcnt(4)
    v_mfma_f32_32x32x16_bf16 v[4:19], v[76:79], v[124:127], v[4:19]
    v_mfma_f32_32x32x16_bf16 v[20:35], v[76:79], v[128:131], v[20:35]
    v_mfma_f32_32x32x16_bf16 v[36:51], v[80:83], v[124:127], v[36:51]
    v_mfma_f32_32x32x16_bf16 v[52:67], v[80:83], v[128:131], v[52:67]
    s_waitcnt vmcnt(6)
    s_add_u32 s78, s78, 14336
    buffer_load_dwordx4 v[124:127], v210, s[40:43], s78 offen sc1
    buffer_load_dwordx4 v[128:131], v211, s[40:43], s78 offen sc1
    ds_read_b64_tr_b16 v[76:77], v216 offset:57344
    ds_read_b64_tr_b16 v[78:79], v216 offset:57856
    ds_read_b64_tr_b16 v[80:81], v217 offset:57344
    ds_read_b64_tr_b16 v[82:83], v217 offset:57856
    s_waitcnt lgkmcnt(4)
    v_mfma_f32_32x32x16_bf16 v[4:19], v[68:71], v[84:87], v[4:19]
    v_mfma_f32_32x32x16_bf16 v[20:35], v[68:71], v[88:91], v[20:35]
    s_waitcnt vmcnt(6)
    s_add_u32 m0, s59, 8192
    s_add_u32 s58, s58, 57344
    buffer_load_dwordx4 v204, s[16:19], s58 offen offset:0 lds
    buffer_load_dwordx4 v205, s[16:19], s58 offen offset:1024 lds
    v_mfma_f32_32x32x16_bf16 v[36:51], v[72:75], v[84:87], v[36:51]
    v_mfma_f32_32x32x16_bf16 v[52:67], v[72:75], v[88:91], v[52:67]
    s_waitcnt vmcnt(6)
    s_add_u32 s78, s78, 14336
    buffer_load_dwordx4 v[84:87], v210, s[40:43], s78 offen sc1
    buffer_load_dwordx4 v[88:91], v211, s[40:43], s78 offen sc1
    ds_read_b64_tr_b16 v[68:69], v218 offset:0
    ds_read_b64_tr_b16 v[70:71], v218 offset:512
    ds_read_b64_tr_b16 v[72:73], v219 offset:0
    ds_read_b64_tr_b16 v[74:75], v219 offset:512
    s_waitcnt lgkmcnt(4)
    v_mfma_f32_32x32x16_bf16 v[4:19], v[76:79], v[92:95], v[4:19]
    v_mfma_f32_32x32x16_bf16 v[20:35], v[76:79], v[96:99], v[20:35]
    s_waitcnt vmcnt(6)
    s_add_u32 m0, s59, 16384
    s_add_u32 s58, s58, 57344
    buffer_load_dwordx4 v204, s[16:19], s58 offen offset:0 lds
    buffer_load_dwordx4 v205, s[16:19], s58 offen offset:1024 lds
    v_mfma_f32_32x32x16_bf16 v[36:51], v[80:83], v[92:95], v[36:51]
    v_mfma_f32_32x32x16_bf16 v[52:67], v[80:83], v[96:99], v[52:67]
    s_waitcnt vmcnt(6)
    s_add_u32 s78, s78, 14336
    buffer_load_dwordx4 v[92:95], v210, s[40:43], s78 offen sc1
    buffer_load_dwordx4 v[96:99], v211, s[40:43], s78 offen sc1
    ds_read_b64_tr_b16 v[76:77], v218 offset:8192
    ds_read_b64_tr_b16 v[78:79], v218 offset:8704
    ds_read_b64_tr_b16 v[80:81], v219 offset:8192
    ds_read_b64_tr_b16 v[82:83], v219 offset:8704
    s_waitcnt lgkmcnt(4)
    v_mfma_f32_32x32x16_bf16 v[4:19], v[68:71], v[100:103], v[4:19]
    v_mfma_f32_32x32x16_bf16 v[20:35], v[68:71], v[104:107], v[20:35]
    s_waitcnt vmcnt(6)
    s_add_u32 m0, s59, 24576
    s_add_u32 s58, s58, 57344
    buffer_load_dwordx4 v204, s[16:19], s58 offen offset:0 lds
    buffer_load_dwordx4 v205, s[16:19], s58 offen offset:1024 lds
    v_mfma_f32_32x32x16_bf16 v[36:51], v[72:75], v[100:103], v[36:51]
    v_mfma_f32_32x32x16_bf16 v[52:67], v[72:75], v[104:107], v[52:67]
    s_waitcnt vmcnt(6)
    s_add_u32 s78, s78, 14336
    buffer_load_dwordx4 v[100:103], v210, s[40:43], s78 offen sc1
    buffer_load_dwordx4 v[104:107], v211, s[40:43], s78 offen sc1
    ds_read_b64_tr_b16 v[68:69], v218 offset:16384
    ds_read_b64_tr_b16 v[70:71], v218 offset:16896
    ds_read_b64_tr_b16 v[72:73], v219 offset:16384
    ds_read_b64_tr_b16 v[74:75], v219 offset:16896
    s_waitcnt lgkmcnt(4)
    v_mfma_f32_32x32x16_bf16 v[4:19], v[76:79], v[108:111], v[4:19]
    v_mfma_f32_32x32x16_bf16 v[20:35], v[76:79], v[112:115], v[20:35]
    v_mfma_f32_32x32x16_bf16 v[36:51], v[80:83], v[108:111], v[36:51]
    v_mfma_f32_32x32x16_bf16 v[52:67], v[80:83], v[112:115], v[52:67]
    s_waitcnt vmcnt(6)
    s_add_u32 s78, s78, 14336
    buffer_load_dwordx4 v[108:111], v210, s[40:43], s78 offen sc1
    buffer_load_dwordx4 v[112:115], v211, s[40:43], s78 offen sc1
    ds_read_b64_tr_b16 v[76:77], v218 offset:24576
    ds_read_b64_tr_b16 v[78:79], v218 offset:25088
    ds_read_b64_tr_b16 v[80:81], v219 offset:24576
    ds_read_b64_tr_b16 v[82:83], v219 offset:25088
    s_waitcnt lgkmcnt(4)
    v_mfma_f32_32x32x16_bf16 v[4:19], v[68:71], v[116:119], v[4:19]
    v_mfma_f32_32x32x16_bf16 v[20:35], v[68:71], v[120:123], v[20:35]
    s_waitcnt vmcnt(6)
    s_add_u32 m0, s59, 32768
    s_add_u32 s58, s58, 57344
    buffer_load_dwordx4 v204, s[16:19], s58 offen offset:0 lds
    buffer_load_dwordx4 v205, s[16:19], s58 offen offset:1024 lds
    v_mfma_f32_32x32x16_bf16 v[36:51], v[72:75], v[116:119], v[36:51]
    v_mfma_f32_32x32x16_bf16 v[52:67], v[72:75], v[120:123], v[52:67]
    s_waitcnt vmcnt(6)
    s_add_u32 s78, s78, 14336
    buffer_load_dwordx4 v[116:119], v210, s[40:43], s78 offen sc1
    buffer_load_dwordx4 v[120:123], v211, s[40:43], s78 offen sc1
    ds_read_b64_tr_b16 v[68:69], v216 offset:0
    ds_read_b64_tr_b16 v[70:71], v216 offset:512
    ds_read_b64_tr_b16 v[72:73], v217 offset:0
    ds_read_b64_tr_b16 v[74:75], v217 offset:512
    s_waitcnt lgkmcnt(4)
    v_mfma_f32_32x32x16_bf16 v[4:19], v[76:79], v[124:127], v[4:19]
    v_mfma_f32_32x32x16_bf16 v[20:35], v[76:79], v[128:131], v[20:35]
    s_waitcnt vmcnt(6)
    s_add_u32 m0, s59, 40960
    s_add_u32 s58, s58, 57344
    buffer_load_dwordx4 v204, s[16:19], s58 offen offset:0 lds
    buffer_load_dwordx4 v205, s[16:19], s58 offen offset:1024 lds
    v_mfma_f32_32x32x16_bf16 v[36:51], v[80:83], v[124:127], v[36:51]
    v_mfma_f32_32x32x16_bf16 v[52:67], v[80:83], v[128:131], v[52:67]
    s_waitcnt vmcnt(6)
    s_add_u32 s78, s78, 14336
    buffer_load_dwordx4 v[124:127], v210, s[40:43], s78 offen sc1
    buffer_load_dwordx4 v[128:131], v211, s[40:43], s78 offen sc1
    ds_read_b64_tr_b16 v[76:77], v216 offset:8192
    ds_read_b64_tr_b16 v[78:79], v216 offset:8704
    ds_read_b64_tr_b16 v[80:81], v217 offset:8192
    ds_read_b64_tr_b16 v[82:83], v217 offset:8704
    s_waitcnt lgkmcnt(4)
    v_mfma_f32_32x32x16_bf16 v[4:19], v[68:71], v[84:87], v[4:19]
    v_mfma_f32_32x32x16_bf16 v[20:35], v[68:71], v[88:91], v[20:35]
    v_mfma_f32_32x32x16_bf16 v[36:51], v[72:75], v[84:87], v[36:51]
    v_mfma_f32_32x32x16_bf16 v[52:67], v[72:75], v[88:91], v[52:67]
    ds_read_b64_tr_b16 v[68:69], v216 offset:16384
    ds_read_b64_tr_b16 v[70:71], v216 offset:16896
    ds_read_b64_tr_b16 v[72:73], v217 offset:16384
    ds_read_b64_tr_b16 v[74:75], v217 offset:16896
    s_waitcnt lgkmcnt(4)
    v_mfma_f32_32x32x16_bf16 v[4:19], v[76:79], v[92:95], v[4:19]
    v_mfma_f32_32x32x16_bf16 v[20:35], v[76:79], v[96:99], v[20:35]
    s_waitcnt vmcnt(6)
    s_add_u32 m0, s59, 49152
    s_add_u32 s58, s58, 57344
    buffer_load_dwordx4 v204, s[16:19], s58 offen offset:0 lds
    buffer_load_dwordx4 v205, s[16:19], s58 offen offset:1024 lds
    v_mfma_f32_32x32x16_bf16 v[36:51], v[80:83], v[92:95], v[36:51]
    v_mfma_f32_32x32x16_bf16 v[52:67], v[80:83], v[96:99], v[52:67]
    s_waitcnt vmcnt(6)
    s_add_u32 s78, s78, 14336
    buffer_load_dwordx4 v[84:87], v210, s[40:43], s78 offen sc1
    buffer_load_dwordx4 v[88:91], v211, s[40:43], s78 offen sc1
    ds_read_b64_tr_b16 v[76:77], v216 offset:24576
    ds_read_b64_tr_b16 v[78:79], v216 offset:25088
    ds_read_b64_tr_b16 v[80:81], v217 offset:24576
    ds_read_b64_tr_b16 v[82:83], v217 offset:25088
    s_waitcnt lgkmcnt(4)
    v_mfma_f32_32x32x16_bf16 v[4:19], v[68:71], v[100:103], v[4:19]
    v_mfma_f32_32x32x16_bf16 v[20:35], v[68:71], v[104:107], v[20:35]
    s_waitcnt vmcnt(6)
    s_add_u32 m0, s59, 57344
    s_add_u32 s58, s58, 57344
    buffer_load_dwordx4 v204, s[16:19], s58 offen offset:0 lds
    buffer_load_dwordx4 v205, s[16:19], s58 offen offset:1024 lds
    v_mfma_f32_32x32x16_bf16 v[36:51], v[72:75], v[100:103], v[36:51]
    v_mfma_f32_32x32x16_bf16 v[52:67], v[72:75], v[104:107], v[52:67]
    s_waitcnt vmcnt(6)
    s_add_u32 s78, s78, 14336
    buffer_load_dwordx4 v[92:95], v210, s[40:43], s78 offen sc1
    buffer_load_dwordx4 v[96:99], v211, s[40:43], s78 offen sc1
    ds_read_b64_tr_b16 v[68:69], v216 offset:32768
    ds_read_b64_tr_b16 v[70:71], v216 offset:33280
    ds_read_b64_tr_b16 v[72:73], v217 offset:32768
    ds_read_b64_tr_b16 v[74:75], v217 offset:33280
    s_waitcnt lgkmcnt(4)
    v_mfma_f32_32x32x16_bf16 v[4:19], v[76:79], v[108:111], v[4:19]
    v_mfma_f32_32x32x16_bf16 v[20:35], v[76:79], v[112:115], v[20:35]
    v_mfma_f32_32x32x16_bf16 v[36:51], v[80:83], v[108:111], v[36:51]
    v_mfma_f32_32x32x16_bf16 v[52:67], v[80:83], v[112:115], v[52:67]
    ds_read_b64_tr_b16 v[76:77], v216 offset:40960
    ds_read_b64_tr_b16 v[78:79], v216 offset:41472
    ds_read_b64_tr_b16 v[80:81], v217 offset:40960
    ds_read_b64_tr_b16 v[82:83], v217 offset:41472
    s_waitcnt lgkmcnt(4)
    v_mfma_f32_32x32x16_bf16 v[4:19], v[68:71], v[116:119], v[4:19]
    v_mfma_f32_32x32x16_bf16 v[20:35], v[68:71], v[120:123], v[20:35]
    v_mfma_f32_32x32x16_bf16 v[36:51], v[72:75], v[116:119], v[36:51]
    v_mfma_f32_32x32x16_bf16 v[52:67], v[72:75], v[120:123], v[52:67]
    s_waitcnt vmcnt(6)
    ds_read_b64_tr_b16 v[68:69], v216 offset:49152
    ds_read_b64_tr_b16 v[70:71], v216 offset:49664
    ds_read_b64_tr_b16 v[72:73], v217 offset:49152
    ds_read_b64_tr_b16 v[74:75], v217 offset:49664
    s_waitcnt lgkmcnt(4)
    v_mfma_f32_32x32x16_bf16 v[4:19], v[76:79], v[124:127], v[4:19]
    v_mfma_f32_32x32x16_bf16 v[20:35], v[76:79], v[128:131], v[20:35]
    v_mfma_f32_32x32x16_bf16 v[36:51], v[80:83], v[124:127], v[36:51]
    v_mfma_f32_32x32x16_bf16 v[52:67], v[80:83], v[128:131], v[52:67]
    s_waitcnt vmcnt(2)
    ds_read_b64_tr_b16 v[76:77], v216 offset:57344
    ds_read_b64_tr_b16 v[78:79], v216 offset:57856
    ds_read_b64_tr_b16 v[80:81], v217 offset:57344
    ds_read_b64_tr_b16 v[82:83], v217 offset:57856
    s_waitcnt lgkmcnt(4)
    v_mfma_f32_32x32x16_bf16 v[4:19], v[68:71], v[84:87], v[4:19]
    v_mfma_f32_32x32x16_bf16 v[20:35], v[68:71], v[88:91], v[20:35]
    v_mfma_f32_32x32x16_bf16 v[36:51], v[72:75], v[84:87], v[36:51]
    v_mfma_f32_32x32x16_bf16 v[52:67], v[72:75], v[88:91], v[52:67]
    s_waitcnt vmcnt(0)
    s_waitcnt lgkmcnt(0)
    v_mfma_f32_32x32x16_bf16 v[4:19], v[76:79], v[92:95], v[4:19]
    v_mfma_f32_32x32x16_bf16 v[20:35], v[76:79], v[96:99], v[20:35]
    v_mfma_f32_32x32x16_bf16 v[36:51], v[80:83], v[92:95], v[36:51]
    v_mfma_f32_32x32x16_bf16 v[52:67], v[80:83], v[96:99], v[52:67]
    s_setprio 2
    v_mov_b32 v236, 163584
    s_mov_b32 s80, 0
L_ev_50:
    ds_read_b32 v237, v236
    s_add_u32 s80, s80, 1
    s_waitcnt lgkmcnt(0)
    v_readfirstlane_b32 s48, v237
    s_cmp_ge_u32 s80, 0x400000
    s_cbranch_scc1 L_eve_51
    s_cmp_lt_u32 s48, 4
    s_cbranch_scc1 L_ev_50
L_eve_51:
    s_xor_b32 s48, s76, 1
    s_mul_i32 s48, s48, 12288
    s_add_u32 s48, s48, 98304
    v_add_u32 v233, s48, v214
    s_xor_b32 s48, s76, 2
    s_mul_i32 s48, s48, 12288
    s_add_u32 s48, s48, 102400
    v_add_u32 v234, s48, v214
    s_xor_b32 s48, s76, 3
    s_mul_i32 s48, s48, 12288
    s_add_u32 s48, s48, 106496
    v_add_u32 v235, s48, v214
    ds_write_b128 v233, v[20:23] offset:0
    ds_write_b128 v233, v[24:27] offset:1024
    ds_write_b128 v233, v[28:31] offset:2048
    ds_write_b128 v233, v[32:35] offset:3072
    ds_write_b128 v234, v[36:39] offset:0
    ds_write_b128 v234, v[40:43] offset:1024
    ds_write_b128 v234, v[44:47] offset:2048
    ds_write_b128 v234, v[48:51] offset:3072
    ds_write_b128 v235, v[52:55] offset:0
    ds_write_b128 v235, v[56:59] offset:1024
    ds_write_b128 v235, v[60:63] offset:2048
    ds_write_b128 v235, v[64:67] offset:3072
    v_mov_b32 v236, 163588
    v_mov_b32 v237, 1
    s_mov_b64 exec, 1
    ds_add_u32 v236, v237
    s_mov_b64 exec, -1
    s_mul_i32 s49, s76, 12288
    s_add_u32 s49, s49, 98304
    v_add_u32 v233, s49, v214
    v_lshlrev_b32 v234, 16, v224
    v_and_b32 v235, 0xffff0000, v224
    v_add_f32 v4, v4, v234
    v_add_f32 v5, v5, v235
    v_lshlrev_b32 v234, 16, v225
    v_and_b32 v235, 0xffff0000, v225
    v_add_f32 v6, v6, v234
    v_add_f32 v7, v7, v235
    v_lshlrev_b32 v234, 16, v226
    v_and_b32 v235, 0xffff0000, v226
    v_add_f32 v8, v8, v234
    v_add_f32 v9, v9, v235
    v_lshlrev_b32 v234, 16, v227
    v_and_b32 v235, 0xffff0000, v227
    v_add_f32 v10, v10, v234
    v_add_f32 v11, v11, v235
    v_lshlrev_b32 v234, 16, v228
    v_and_b32 v235, 0xffff0000, v228
    v_add_f32 v12, v12, v234
    v_add_f32 v13, v13, v235
    v_lshlrev_b32 v234, 16, v229
    v_and_b32 v235, 0xffff0000, v229
    v_add_f32 v14, v14, v234
    v_add_f32 v15, v15, v235
    v_lshlrev_b32 v234, 16, v230
    v_and_b32 v235, 0xffff0000, v230
    v_add_f32 v16, v16, v234
    v_add_f32 v17, v17, v235
    v_lshlrev_b32 v234, 16, v231
    v_and_b32 v235, 0xffff0000, v231
    v_add_f32 v18, v18, v234
    v_add_f32 v19, v19, v235
    v_mov_b32 v236, 163588
    s_mov_b32 s80, 0
L_ev_52:
    ds_read_b32 v237, v236
    s_add_u32 s80, s80, 1
    s_waitcnt lgkmcnt(0)
    v_readfirstlane_b32 s48, v237
    s_cmp_ge_u32 s80, 0x400000
    s_cbranch_scc1 L_eve_53
    s_cmp_lt_u32 s48, 4
    s_cbranch_scc1 L_ev_52
L_eve_53:
    ds_read_b128 v[20:23], v233 offset:0
    ds_read_b128 v[24:27], v233 offset:1024
    ds_read_b128 v[28:31], v233 offset:2048
    ds_read_b128 v[32:35], v233 offset:3072
    ds_read_b128 v[36:39], v233 offset:4096
    ds_read_b128 v[40:43], v233 offset:5120
    ds_read_b128 v[44:47], v233 offset:6144
    ds_read_b128 v[48:51], v233 offset:7168
    ds_read_b128 v[52:55], v233 offset:8192
    ds_read_b128 v[56:59], v233 offset:9216
    ds_read_b128 v[60:63], v233 offset:10240
    ds_read_b128 v[64:67], v233 offset:11264
    s_waitcnt lgkmcnt(11)
    v_add_f32 v4, v4, v20
    v_add_f32 v5, v5, v21
    v_add_f32 v6, v6, v22
    v_add_f32 v7, v7, v23
    s_waitcnt lgkmcnt(10)
    v_add_f32 v8, v8, v24
    v_add_f32 v9, v9, v25
    v_add_f32 v10, v10, v26
    v_add_f32 v11, v11, v27
    s_waitcnt lgkmcnt(9)
    v_add_f32 v12, v12, v28
    v_add_f32 v13, v13, v29
    v_add_f32 v14, v14, v30
    v_add_f32 v15, v15, v31
    s_waitcnt lgkmcnt(8)
    v_add_f32 v16, v16, v32
    v_add_f32 v17, v17, v33
    v_add_f32 v18, v18, v34
    v_add_f32 v19, v19, v35
    s_waitcnt lgkmcnt(7)
    v_add_f32 v4, v4, v36
    v_add_f32 v5, v5, v37
    v_add_f32 v6, v6, v38
    v_add_f32 v7, v7, v39
    s_waitcnt lgkmcnt(6)
    v_add_f32 v8, v8, v40
    v_add_f32 v9, v9, v41
    v_add_f32 v10, v10, v42
    v_add_f32 v11, v11, v43
    s_waitcnt lgkmcnt(5)
    v_add_f32 v12, v12, v44
    v_add_f32 v13, v13, v45
    v_add_f32 v14, v14, v46
    v_add_f32 v15, v15, v47
    s_waitcnt lgkmcnt(4)
    v_add_f32 v16, v16, v48
    v_add_f32 v17, v17, v49
    v_add_f32 v18, v18, v50
    v_add_f32 v19, v19, v51
    s_waitcnt lgkmcnt(3)
    v_add_f32 v4, v4, v52
    v_add_f32 v5, v5, v53
    v_add_f32 v6, v6, v54
    v_add_f32 v7, v7, v55
    s_waitcnt lgkmcnt(2)
    v_add_f32 v8, v8, v56
    v_add_f32 v9, v9, v57
    v_add_f32 v10, v10, v58
    v_add_f32 v11, v11, v59
    s_waitcnt lgkmcnt(1)
    v_add_f32 v12, v12, v60
    v_add_f32 v13, v13, v61
    v_add_f32 v14, v14, v62
    v_add_f32 v15, v15, v63
    s_waitcnt lgkmcnt(0)
    v_add_f32 v16, v16, v64
    v_add_f32 v17, v17, v65
    v_add_f32 v18, v18, v66
    v_add_f32 v19, v19, v67
    v_mov_b32 v236, 163592
    v_mov_b32 v237, 1
    s_mov_b64 exec, 1
    ds_add_u32 v236, v237
    s_mov_b64 exec, -1
    v_mov_b32 v232, 0xc0135761
    v_mov_b32 v233, 0xc0135761
    v_mov_b32 v234, 0xbdd2d3e8
    v_mov_b32 v235, 0xbdd2d3e8
    v_mov_b32 v236, 0x3f800000
    v_mov_b32 v237, 0x3f800000
    v_mul_f32 v20, v4, v4
    v_mul_f32 v21, v5, v5
    v_mul_f32 v22, v6, v6
    v_mul_f32 v23, v7, v7
    v_mul_f32 v24, v8, v8
    v_mul_f32 v25, v9, v9
    v_mul_f32 v26, v10, v10
    v_mul_f32 v27, v11, v11
    v_mul_f32 v28, v12, v12
    v_mul_f32 v29, v13, v13
    v_mul_f32 v30, v14, v14
    v_mul_f32 v31, v15, v15
    v_mul_f32 v32, v16, v16
    v_mul_f32 v33, v17, v17
    v_mul_f32 v34, v18, v18
    v_mul_f32 v35, v19, v19
    v_fma_f32 v20, v20, v234, v232
    v_fma_f32 v21, v21, v235, v233
    v_fma_f32 v22, v22, v234, v232
    v_fma_f32 v23, v23, v235, v233
    v_fma_f32 v24, v24, v234, v232
    v_fma_f32 v25, v25, v235, v233
    v_fma_f32 v26, v26, v234, v232
    v_fma_f32 v27, v27, v235, v233
    v_fma_f32 v28, v28, v234, v232
    v_fma_f32 v29, v29, v235, v233
    v_fma_f32 v30, v30, v234, v232
    v_fma_f32 v31, v31, v235, v233
    v_fma_f32 v32, v32, v234, v232
    v_fma_f32 v33, v33, v235, v233
    v_fma_f32 v34, v34, v234, v232
    v_fma_f32 v35, v35, v235, v233
    v_mul_f32 v20, v20, v4
    v_mul_f32 v21, v21, v5
    v_mul_f32 v22, v22, v6
    v_mul_f32 v23, v23, v7
    v_mul_f32 v24, v24, v8
    v_mul_f32 v25, v25, v9
    v_mul_f32 v26, v26, v10
    v_mul_f32 v27, v27, v11
    v_mul_f32 v28, v28, v12
    v_mul_f32 v29, v29, v13
    v_mul_f32 v30, v30, v14
    v_mul_f32 v31, v31, v15
    v_mul_f32 v32, v32, v16
    v_mul_f32 v33, v33, v17
    v_mul_f32 v34, v34, v18
    v_mul_f32 v35, v35, v19
    v_exp_f32 v20, v20
    v_exp_f32 v21, v21
    v_exp_f32 v22, v22
    v_exp_f32 v23, v23
    v_exp_f32 v24, v24
    v_exp_f32 v25, v25
    v_exp_f32 v26, v26
    v_exp_f32 v27, v27
    v_exp_f32 v28, v28
    v_exp_f32 v29, v29
    v_exp_f32 v30, v30
    v_exp_f32 v31, v31
    v_exp_f32 v32, v32
    v_exp_f32 v33, v33
    v_exp_f32 v34, v34
    v_exp_f32 v35, v35
    v_add_f32 v20, v20, v236
    v_add_f32 v21, v21, v237
    v_add_f32 v22, v22, v236
    v_add_f32 v23, v23, v237
    v_add_f32 v24, v24, v236
    v_add_f32 v25, v25, v237
    v_add_f32 v26, v26, v236
    v_add_f32 v27, v27, v237
    v_add_f32 v28, v28, v236
    v_add_f32 v29, v29, v237
    v_add_f32 v30, v30, v236
    v_add_f32 v31, v31, v237
    v_add_f32 v32, v32, v236
    v_add_f32 v33, v33, v237
    v_add_f32 v34, v34, v236
    v_add_f32 v35, v35, v237
    v_rcp_f32 v20, v20
    v_rcp_f32 v21, v21
    v_rcp_f32 v22, v22
    v_rcp_f32 v23, v23
    v_rcp_f32 v24, v24
    v_rcp_f32 v25, v25
    v_rcp_f32 v26, v26
    v_rcp_f32 v27, v27
    v_rcp_f32 v28, v28
    v_rcp_f32 v29, v29
    v_rcp_f32 v30, v30
    v_rcp_f32 v31, v31
    v_rcp_f32 v32, v32
    v_rcp_f32 v33, v33
    v_rcp_f32 v34, v34
    v_rcp_f32 v35, v35
    v_mul_f32 v20, v20, v4
    v_mul_f32 v21, v21, v5
    v_mul_f32 v22, v22, v6
    v_mul_f32 v23, v23, v7
    v_mul_f32 v24, v24, v8
    v_mul_f32 v25, v25, v9
    v_mul_f32 v26, v26, v10
    v_mul_f32 v27, v27, v11
    v_mul_f32 v28, v28, v12
    v_mul_f32 v29, v29, v13
    v_mul_f32 v30, v30, v14
    v_mul_f32 v31, v31, v15
    v_mul_f32 v32, v32, v16
    v_mul_f32 v33, v33, v17
    v_mul_f32 v34, v34, v18
    v_mul_f32 v35, v35, v19
    v_cvt_pk_bf16_f32 v36, v20, v21
    v_cvt_pk_bf16_f32 v37, v22, v23
    v_cvt_pk_bf16_f32 v38, v24, v25
    v_cvt_pk_bf16_f32 v39, v26, v27
    v_cvt_pk_bf16_f32 v40, v28, v29
    v_cvt_pk_bf16_f32 v41, v30, v31
    v_cvt_pk_bf16_f32 v42, v32, v33
    v_cvt_pk_bf16_f32 v43, v34, v35
    s_lshl_b32 s48, s73, 2
    s_and_b32 s49, s76, 2
    s_add_u32 s48, s48, s49
    s_mul_i32 s48, s48, 14336
    s_add_u32 s48, s48, 0x800000
    s_add_u32 s49, s48, 14336
    buffer_store_dwordx4 v[36:39], v210, s[40:43], s48 offen sc1
    buffer_store_dwordx4 v[40:43], v210, s[40:43], s49 offen sc1
    s_mul_i32 s50, s72, 28
    s_add_u32 s50, s50, s73
    s_add_u32 s50, s50, 256
    v_mov_b32 v236, 163612
    v_mov_b32 v237, 1
    s_waitcnt vmcnt(0)
    s_mov_b64 exec, 1
    ds_add_rtn_u32 v237, v236, v237
    s_mov_b64 exec, -1
    s_waitcnt lgkmcnt(0)
    v_readfirstlane_b32 s48, v237
    s_cmp_lg_u32 s48, 3
    s_cbranch_scc1 L_nsig_54
    s_lshl_b32 s50, s50, 7
    v_lshl_add_u32 v240, v1, 4, s50
    v_mov_b32 v236, s64
    v_mov_b32 v237, s65
    v_mov_b32 v238, s64
    v_mov_b32 v239, s65
    s_mov_b64 exec, 0xff
    buffer_store_dwordx4 v[236:239], v240, s[40:43], 0 offen sc1
    s_mov_b64 exec, -1
L_nsig_54:
    s_setprio 0
    s_add_u32 m0, s59, 65536
    s_mov_b32 s58, 0
    buffer_load_dwordx4 v206, s[20:23], s58 offen offset:0 lds
    buffer_load_dwordx4 v207, s[20:23], s58 offen offset:1024 lds
    s_add_u32 m0, s59, 73728
    s_add_u32 s58, s58, 65536
    buffer_load_dwordx4 v206, s[20:23], s58 offen offset:0 lds
    buffer_load_dwordx4 v207, s[20:23], s58 offen offset:1024 lds
    s_add_u32 m0, s59, 81920
    s_add_u32 s58, s58, 65536
    buffer_load_dwordx4 v206, s[20:23], s58 offen offset:0 lds
    buffer_load_dwordx4 v207, s[20:23], s58 offen offset:1024 lds
    s_add_u32 m0, s59, 90112
    s_add_u32 s58, s58, 65536
    buffer_load_dwordx4 v206, s[20:23], s58 offen offset:0 lds
    buffer_load_dwordx4 v207, s[20:23], s58 offen offset:1024 lds
    s_waitcnt vmcnt(6)
    s_add_u32 m0, s59, 0
    s_add_u32 s58, s58, 65536
    buffer_load_dwordx4 v206, s[20:23], s58 offen offset:0 lds
    buffer_load_dwordx4 v207, s[20:23], s58 offen offset:1024 lds
    s_waitcnt vmcnt(6)
    s_add_u32 m0, s59, 8192
    s_add_u32 s58, s58, 65536
    buffer_load_dwordx4 v206, s[20:23], s58 offen offset:0 lds
    buffer_load_dwordx4 v207, s[20:23], s58 offen offset:1024 lds
    s_mul_i32 s49, s75, 28
    s_mul_i32 s50, s76, 7
    s_add_u32 s49, s49, s50
    s_add_u32 s49, s49, 256
    v_cmp_lt_u32 vcc, 6, v1
    v_add_u32 v232, s49, v1
    v_add_u32 v233, 21, v232
    v_cndmask_b32 v232, v232, v233, vcc
    v_lshlrev_b32 v232, 7, v232
    s_mov_b64 exec, 0x3fff
    s_mov_b32 s80, 0
    s_branch L_pollf_57
L_poll_55:
    s_sleep 2
L_pollf_57:
    buffer_load_dwordx2 v[234:235], v232, s[40:43], 0 offen sc1
    s_add_u32 s80, s80, 1
    s_cmp_ge_u32 s80, 0x100000
    s_waitcnt vmcnt(0)
    s_cbranch_scc1 L_polle_56
    v_cmp_ne_u64 vcc, s[64:65], v[234:235]
    s_cbranch_vccnz L_poll_55
L_polle_56:
    s_mov_b64 exec, -1
    s_mul_i32 s81, s76, 401408
    s_add_u32 s81, s81, 0x800000
    s_mov_b32 s78, s81
    buffer_load_dwordx4 v[84:87], v212, s[40:43], s78 offen sc1
    buffer_load_dwordx4 v[88:91], v213, s[40:43], s78 offen sc1
    s_add_u32 s78, s78, 14336
    buffer_load_dwordx4 v[92:95], v212, s[40:43], s78 offen sc1
    buffer_load_dwordx4 v[96:99], v213, s[40:43], s78 offen sc1
    s_add_u32 s78, s78, 14336
    buffer_load_dwordx4 v[100:103], v212, s[40:43], s78 offen sc1
    buffer_load_dwordx4 v[104:107], v213, s[40:43], s78 offen sc1
    s_add_u32 s78, s78, 14336
    buffer_load_dwordx4 v[108:111], v212, s[40:43], s78 offen sc1
    buffer_load_dwordx4 v[112:115], v213, s[40:43], s78 offen sc1
    s_waitcnt vmcnt(6)
    s_add_u32 s78, s78, 14336
    buffer_load_dwordx4 v[116:119], v212, s[40:43], s78 offen sc1
    buffer_load_dwordx4 v[120:123], v213, s[40:43], s78 offen sc1
    s_waitcnt vmcnt(6)
    s_add_u32 s78, s78, 14336
    buffer_load_dwordx4 v[124:127], v212, s[40:43], s78 offen sc1
    buffer_load_dwordx4 v[128:131], v213, s[40:43], s78 offen sc1
    s_waitcnt vmcnt(6)
    s_add_u32 s78, s78, 14336
    buffer_load_dwordx4 v[132:135], v212, s[40:43], s78 offen sc1
    buffer_load_dwordx4 v[136:139], v213, s[40:43], s78 offen sc1
    s_waitcnt vmcnt(6)
    s_add_u32 s78, s78, 14336
    buffer_load_dwordx4 v[140:143], v212, s[40:43], s78 offen sc1
    buffer_load_dwordx4 v[144:147], v213, s[40:43], s78 offen sc1
    s_waitcnt vmcnt(6)
    s_add_u32 s78, s78, 14336
    buffer_load_dwordx4 v[148:151], v212, s[40:43], s78 offen sc1
    buffer_load_dwordx4 v[152:155], v213, s[40:43], s78 offen sc1
    s_waitcnt vmcnt(6)
    s_add_u32 s78, s78, 14336
    buffer_load_dwordx4 v[156:159], v212, s[40:43], s78 offen sc1
    buffer_load_dwordx4 v[160:163], v213, s[40:43], s78 offen sc1
    s_waitcnt vmcnt(6)
    s_add_u32 s78, s78, 14336
    buffer_load_dwordx4 v[164:167], v212, s[40:43], s78 offen sc1
    buffer_load_dwordx4 v[168:171], v213, s[40:43], s78 offen sc1
    s_waitcnt vmcnt(6)
    s_add_u32 s78, s78, 14336
    buffer_load_dwordx4 v[172:175], v212, s[40:43], s78 offen sc1
    buffer_load_dwordx4 v[176:179], v213, s[40:43], s78 offen sc1
    s_waitcnt vmcnt(6)
    s_add_u32 s78, s78, 14336
    buffer_load_dwordx4 v[180:183], v212, s[40:43], s78 offen sc1
    buffer_load_dwordx4 v[184:187], v213, s[40:43], s78 offen sc1
    s_waitcnt vmcnt(6)
    s_add_u32 s78, s78, 14336
    buffer_load_dwordx4 v[188:191], v212, s[40:43], s78 offen sc1
    buffer_load_dwordx4 v[192:195], v213, s[40:43], s78 offen sc1
    s_waitcnt vmcnt(6)
    s_add_u32 s78, s78, 14336
    buffer_load_dwordx4 v[196:199], v212, s[40:43], s78 offen sc1
    buffer_load_dwordx4 v[200:203], v213, s[40:43], s78 offen sc1
    s_waitcnt vmcnt(6)
    s_add_u32 m0, s59, 16384
    s_add_u32 s58, s58, 65536
    buffer_load_dwordx4 v206, s[20:23], s58 offen offset:0 lds
    buffer_load_dwordx4 v207, s[20:23], s58 offen offset:1024 lds
    s_waitcnt vmcnt(6)
    s_add_u32 m0, s59, 24576
    s_add_u32 s58, s58, 65536
    buffer_load_dwordx4 v206, s[20:23], s58 offen offset:0 lds
    buffer_load_dwordx4 v207, s[20:23], s58 offen offset:1024 lds
    s_waitcnt vmcnt(6)
    s_add_u32 m0, s59, 32768
    s_add_u32 s58, s58, 65536
    buffer_load_dwordx4 v206, s[20:23], s58 offen offset:0 lds
    buffer_load_dwordx4 v207, s[20:23], s58 offen offset:1024 lds
    s_waitcnt vmcnt(6)
    s_add_u32 m0, s59, 40960
    s_add_u32 s58, s58, 65536
    buffer_load_dwordx4 v206, s[20:23], s58 offen offset:0 lds
    buffer_load_dwordx4 v207, s[20:23], s58 offen offset:1024 lds
    s_waitcnt vmcnt(6)
    s_add_u32 m0, s59, 49152
    s_add_u32 s58, s58, 65536
    buffer_load_dwordx4 v206, s[20:23], s58 offen offset:0 lds
    buffer_load_dwordx4 v207, s[20:23], s58 offen offset:1024 lds
    s_waitcnt vmcnt(6)
    s_add_u32 m0, s59, 57344
    s_add_u32 s58, s58, 65536
    buffer_load_dwordx4 v206, s[20:23], s58 offen offset:0 lds
    buffer_load_dwordx4 v207, s[20:23], s58 offen offset:1024 lds
    ds_read_b64_tr_b16 v[68:69], v222 offset:0
    ds_read_b64_tr_b16 v[70:71], v222 offset:1024
    ds_read_b64_tr_b16 v[72:73], v223 offset:0
    ds_read_b64_tr_b16 v[74:75], v223 offset:1024
    ds_read_b64_tr_b16 v[76:77], v222 offset:8192
    ds_read_b64_tr_b16 v[78:79], v222 offset:9216
    ds_read_b64_tr_b16 v[80:81], v223 offset:8192
    ds_read_b64_tr_b16 v[82:83], v223 offset:9216
    s_waitcnt lgkmcnt(4)
    v_mfma_f32_32x32x16_bf16 v[4:19], v[84:87], v[68:71], 0
    v_mfma_f32_32x32x16_bf16 v[20:35], v[84:87], v[72:75], 0
    s_waitcnt vmcnt(6)
    s_add_u32 m0, s59, 65536
    s_add_u32 s58, s58, 65536
    buffer_load_dwordx4 v206, s[20:23], s58 offen offset:0 lds
    buffer_load_dwordx4 v207, s[20:23], s58 offen offset:1024 lds
    v_mfma_f32_32x32x16_bf16 v[36:51], v[88:91], v[68:71], 0
    v_mfma_f32_32x32x16_bf16 v[52:67], v[88:91], v[72:75], 0
    s_waitcnt vmcnt(6)
    s_add_u32 s78, s78, 14336
    buffer_load_dwordx4 v[84:87], v212, s[40:43], s78 offen sc1
    buffer_load_dwordx4 v[88:91], v213, s[40:43], s78 offen sc1
    ds_read_b64_tr_b16 v[68:69], v222 offset:16384
    ds_read_b64_tr_b16 v[70:71], v222 offset:17408
    ds_read_b64_tr_b16 v[72:73], v223 offset:16384
    ds_read_b64_tr_b16 v[74:75], v223 offset:17408
    s_waitcnt lgkmcnt(4)
    v_mfma_f32_32x32x16_bf16 v[4:19], v[92:95], v[76:79], v[4:19]
    v_mfma_f32_32x32x16_bf16 v[20:35], v[92:95], v[80:83], v[20:35]
    s_waitcnt vmcnt(6)
    s_add_u32 m0, s59, 73728
    s_add_u32 s58, s58, 65536
    buffer_load_dwordx4 v206, s[20:23], s58 offen offset:0 lds
    buffer_load_dwordx4 v207, s[20:23], s58 offen offset:1024 lds
    v_mfma_f32_32x32x16_bf16 v[36:51], v[96:99], v[76:79], v[36:51]
    v_mfma_f32_32x32x16_bf16 v[52:67], v[96:99], v[80:83], v[52:67]
    s_waitcnt vmcnt(6)
    s_add_u32 s78, s78, 14336
    buffer_load_dwordx4 v[92:95], v212, s[40:43], s78 offen sc1
    buffer_load_dwordx4 v[96:99], v213, s[40:43], s78 offen sc1
    ds_read_b64_tr_b16 v[76:77], v222 offset:24576
    ds_read_b64_tr_b16 v[78:79], v222 offset:25600
    ds_read_b64_tr_b16 v[80:81], v223 offset:24576
    ds_read_b64_tr_b16 v[82:83], v223 offset:25600
    s_waitcnt lgkmcnt(4)
    v_mfma_f32_32x32x16_bf16 v[4:19], v[100:103], v[68:71], v[4:19]
    v_mfma_f32_32x32x16_bf16 v[20:35], v[100:103], v[72:75], v[20:35]
    s_waitcnt vmcnt(6)
    s_add_u32 m0, s59, 81920
    s_add_u32 s58, s58, 65536
    buffer_load_dwordx4 v206, s[20:23], s58 offen offset:0 lds
    buffer_load_dwordx4 v207, s[20:23], s58 offen offset:1024 lds
    v_mfma_f32_32x32x16_bf16 v[36:51], v[104:107], v[68:71], v[36:51]
    v_mfma_f32_32x32x16_bf16 v[52:67], v[104:107], v[72:75], v[52:67]
    s_waitcnt vmcnt(6)
    s_add_u32 s78, s78, 14336
    buffer_load_dwordx4 v[100:103], v212, s[40:43], s78 offen sc1
    buffer_load_dwordx4 v[104:107], v213, s[40:43], s78 offen sc1
    ds_read_b64_tr_b16 v[68:69], v220 offset:0
    ds_read_b64_tr_b16 v[70:71], v220 offset:1024
    ds_read_b64_tr_b16 v[72:73], v221 offset:0
    ds_read_b64_tr_b16 v[74:75], v221 offset:1024
    s_waitcnt lgkmcnt(4)
    v_mfma_f32_32x32x16_bf16 v[4:19], v[108:111], v[76:79], v[4:19]
    v_mfma_f32_32x32x16_bf16 v[20:35], v[108:111], v[80:83], v[20:35]
    s_waitcnt vmcnt(6)
    s_add_u32 m0, s59, 90112
    s_add_u32 s58, s58, 65536
    buffer_load_dwordx4 v206, s[20:23], s58 offen offset:0 lds
    buffer_load_dwordx4 v207, s[20:23], s58 offen offset:1024 lds
    v_mfma_f32_32x32x16_bf16 v[36:51], v[112:115], v[76:79], v[36:51]
    v_mfma_f32_32x32x16_bf16 v[52:67], v[112:115], v[80:83], v[52:67]
    s_waitcnt vmcnt(6)
    s_add_u32 s78, s78, 14336
    buffer_load_dwordx4 v[108:111], v212, s[40:43], s78 offen sc1
    buffer_load_dwordx4 v[112:115], v213, s[40:43], s78 offen sc1
    ds_read_b64_tr_b16 v[76:77], v220 offset:8192
    ds_read_b64_tr_b16 v[78:79], v220 offset:9216
    ds_read_b64_tr_b16 v[80:81], v221 offset:8192
    ds_read_b64_tr_b16 v[82:83], v221 offset:9216
    s_waitcnt lgkmcnt(4)
    v_mfma_f32_32x32x16_bf16 v[4:19], v[116:119], v[68:71], v[4:19]
    v_mfma_f32_32x32x16_bf16 v[20:35], v[116:119], v[72:75], v[20:35]
    s_waitcnt vmcnt(6)
    s_add_u32 m0, s59, 0
    s_add_u32 s58, s58, 65536
    buffer_load_dwordx4 v206, s[20:23], s58 offen offset:0 lds
    buffer_load_dwordx4 v207, s[20:23], s58 offen offset:1024 lds
    v_mfma_f32_32x32x16_bf16 v[36:51], v[120:123], v[68:71], v[36:51]
    v_mfma_f32_32x32x16_bf16 v[52:67], v[120:123], v[72:75], v[52:67]
    s_waitcnt vmcnt(6)
    s_add_u32 s78, s78, 14336
    buffer_load_dwordx4 v[116:119], v212, s[40:43], s78 offen sc1
    buffer_load_dwordx4 v[120:123], v213, s[40:43], s78 offen sc1
    ds_read_b64_tr_b16 v[68:69], v220 offset:16384
    ds_read_b64_tr_b16 v[70:71], v220 offset:17408
    ds_read_b64_tr_b16 v[72:73], v221 offset:16384
    ds_read_b64_tr_b16 v[74:75], v221 offset:17408
    s_waitcnt lgkmcnt(4)
    v_mfma_f32_32x32x16_bf16 v[4:19], v[124:127], v[76:79], v[4:19]
    v_mfma_f32_32x32x16_bf16 v[20:35], v[124:127], v[80:83], v[20:35]
    s_waitcnt vmcnt(6)
    s_add_u32 m0, s59, 8192
    s_add_u32 s58, s58, 65536
    buffer_load_dwordx4 v206, s[20:23], s58 offen offset:0 lds
    buffer_load_dwordx4 v207, s[20:23], s58 offen offset:1024 lds
    v_mfma_f32_32x32x16_bf16 v[36:51], v[128:131], v[76:79], v[36:51]
    v_mfma_f32_32x32x16_bf16 v[52:67], v[128:131], v[80:83], v[52:67]
    s_waitcnt vmcnt(6)
    s_add_u32 s78, s78, 14336
    buffer_load_dwordx4 v[124:127], v212, s[40:43], s78 offen sc1
    buffer_load_dwordx4 v[128:131], v213, s[40:43], s78 offen sc1
    ds_read_b64_tr_b16 v[76:77], v220 offset:24576
    ds_read_b64_tr_b16 v[78:79], v220 offset:25600
    ds_read_b64_tr_b16 v[80:81], v221 offset:24576
    ds_read_b64_tr_b16 v[82:83], v221 offset:25600
    s_waitcnt lgkmcnt(4)
    v_mfma_f32_32x32x16_bf16 v[4:19], v[132:135], v[68:71], v[4:19]
    v_mfma_f32_32x32x16_bf16 v[20:35], v[132:135], v[72:75], v[20:35]
    s_waitcnt vmcnt(6)
    s_add_u32 m0, s59, 16384
    s_add_u32 s58, s58, 65536
    buffer_load_dwordx4 v206, s[20:23], s58 offen offset:0 lds
    buffer_load_dwordx4 v207, s[20:23], s58 offen offset:1024 lds
    v_mfma_f32_32x32x16_bf16 v[36:51], v[136:139], v[68:71], v[36:51]
    v_mfma_f32_32x32x16_bf16 v[52:67], v[136:139], v[72:75], v[52:67]
    s_waitcnt vmcnt(6)
    s_add_u32 s78, s78, 14336
    buffer_load_dwordx4 v[132:135], v212, s[40:43], s78 offen sc1
    buffer_load_dwordx4 v[136:139], v213, s[40:43], s78 offen sc1
    ds_read_b64_tr_b16 v[68:69], v220 offset:32768
    ds_read_b64_tr_b16 v[70:71], v220 offset:33792
    ds_read_b64_tr_b16 v[72:73], v221 offset:32768
    ds_read_b64_tr_b16 v[74:75], v221 offset:33792
    s_waitcnt lgkmcnt(4)
    v_mfma_f32_32x32x16_bf16 v[4:19], v[140:143], v[76:79], v[4:19]
    v_mfma_f32_32x32x16_bf16 v[20:35], v[140:143], v[80:83], v[20:35]
    s_waitcnt vmcnt(6)
    s_add_u32 m0, s59, 24576
    s_add_u32 s58, s58, 65536
    buffer_load_dwordx4 v206, s[20:23], s58 offen offset:0 lds
    buffer_load_dwordx4 v207, s[20:23], s58 offen offset:1024 lds
    v_mfma_f32_32x32x16_bf16 v[36:51], v[144:147], v[76:79], v[36:51]
    v_mfma_f32_32x32x16_bf16 v[52:67], v[144:147], v[80:83], v[52:67]
    s_waitcnt vmcnt(6)
    s_add_u32 s78, s78, 14336
    buffer_load_dwordx4 v[140:143], v212, s[40:43], s78 offen sc1
    buffer_load_dwordx4 v[144:147], v213, s[40:43], s78 offen sc1
    ds_read_b64_tr_b16 v[76:77], v220 offset:40960
    ds_read_b64_tr_b16 v[78:79], v220 offset:41984
    ds_read_b64_tr_b16 v[80:81], v221 offset:40960
    ds_read_b64_tr_b16 v[82:83], v221 offset:41984
    s_waitcnt lgkmcnt(4)
    v_mfma_f32_32x32x16_bf16 v[4:19], v[148:151], v[68:71], v[4:19]
    v_mfma_f32_32x32x16_bf16 v[20:35], v[148:151], v[72:75], v[20:35]
    s_waitcnt vmcnt(6)
    s_add_u32 m0, s59, 32768
    s_add_u32 s58, s58, 65536
    buffer_load_dwordx4 v206, s[20:23], s58 offen offset:0 lds
    buffer_load_dwordx4 v207, s[20:23], s58 offen offset:1024 lds
    v_mfma_f32_32x32x16_bf16 v[36:51], v[152:155], v[68:71], v[36:51]
    v_mfma_f32_32x32x16_bf16 v[52:67], v[152:155], v[72:75], v[52:67]
    s_waitcnt vmcnt(6)
    s_add_u32 s78, s78, 14336
    buffer_load_dwordx4 v[148:151], v212, s[40:43], s78 offen sc1
    buffer_load_dwordx4 v[152:155], v213, s[40:43], s78 offen sc1
    ds_read_b64_tr_b16 v[68:69], v220 offset:49152
    ds_read_b64_tr_b16 v[70:71], v220 offset:50176
    ds_read_b64_tr_b16 v[72:73], v221 offset:49152
    ds_read_b64_tr_b16 v[74:75], v221 offset:50176
    s_waitcnt lgkmcnt(4)
    v_mfma_f32_32x32x16_bf16 v[4:19], v[156:159], v[76:79], v[4:19]
    v_mfma_f32_32x32x16_bf16 v[20:35], v[156:159], v[80:83], v[20:35]
    s_waitcnt vmcnt(6)
    s_add_u32 m0, s59, 40960
    s_add_u32 s58, s58, 65536
    buffer_load_dwordx4 v206, s[20:23], s58 offen offset:0 lds
    buffer_load_dwordx4 v207, s[20:23], s58 offen offset:1024 lds
    v_mfma_f32_32x32x16_bf16 v[36:51], v[160:163], v[76:79], v[36:51]
    v_mfma_f32_32x32x16_bf16 v[52:67], v[160:163], v[80:83], v[52:67]
    s_waitcnt vmcnt(6)
    s_add_u32 s78, s78, 14336
    buffer_load_dwordx4 v[156:159], v212, s[40:43], s78 offen sc1
    buffer_load_dwordx4 v[160:163], v213, s[40:43], s78 offen sc1
    v_mov_b32 v232, 163600
    s_mov_b32 s80, 0
L_ev_58:
    s_sleep 2
    ds_read_b32 v233, v232
    s_add_u32 s80, s80, 1
    s_waitcnt lgkmcnt(0)
    v_readfirstlane_b32 s48, v233
    s_cmp_ge_u32 s80, 0x400000
    s_cbranch_scc1 L_eve_59
    s_cmp_lt_u32 s48, 4
    s_cbranch_scc1 L_ev_58
L_eve_59:
    ds_read_b64_tr_b16 v[76:77], v220 offset:57344
    ds_read_b64_tr_b16 v[78:79], v220 offset:58368
    ds_read_b64_tr_b16 v[80:81], v221 offset:57344
    ds_read_b64_tr_b16 v[82:83], v221 offset:58368
    v_mfma_f32_32x32x16_bf16 v[4:19], v[164:167], v[68:71], v[4:19]
    v_mfma_f32_32x32x16_bf16 v[20:35], v[164:167], v[72:75], v[20:35]
    s_add_u32 m0, s59, 49152
    s_add_u32 s58, s58, 65536
    buffer_load_dwordx4 v206, s[20:23], s58 offen offset:0 lds
    buffer_load_dwordx4 v207, s[20:23], s58 offen offset:1024 lds
    v_mfma_f32_32x32x16_bf16 v[36:51], v[168:171], v[68:71], v[36:51]
    v_mfma_f32_32x32x16_bf16 v[52:67], v[168:171], v[72:75], v[52:67]
    s_add_u32 s78, s78, 14336
    buffer_load_dwordx4 v[164:167], v212, s[40:43], s78 offen sc1
    buffer_load_dwordx4 v[168:171], v213, s[40:43], s78 offen sc1
    ds_read_b64_tr_b16 v[68:69], v222 offset:0
    ds_read_b64_tr_b16 v[70:71], v222 offset:1024
    ds_read_b64_tr_b16 v[72:73], v223 offset:0
    ds_read_b64_tr_b16 v[74:75], v223 offset:1024
    s_waitcnt lgkmcnt(4)
    v_mfma_f32_32x32x16_bf16 v[4:19], v[172:175], v[76:79], v[4:19]
    v_mfma_f32_32x32x16_bf16 v[20:35], v[172:175], v[80:83], v[20:35]
    s_add_u32 m0, s59, 57344
    s_add_u32 s58, s58, 65536
    buffer_load_dwordx4 v206, s[20:23], s58 offen offset:0 lds
    buffer_load_dwordx4 v207, s[20:23], s58 offen offset:1024 lds
    v_mfma_f32_32x32x16_bf16 v[36:51], v[176:179], v[76:79], v[36:51]
    v_mfma_f32_32x32x16_bf16 v[52:67], v[176:179], v[80:83], v[52:67]
    s_add_u32 s78, s78, 14336
    buffer_load_dwordx4 v[172:175], v212, s[40:43], s78 offen sc1
    buffer_load_dwordx4 v[176:179], v213, s[40:43], s78 offen sc1
    ds_read_b64_tr_b16 v[76:77], v222 offset:8192
    ds_read_b64_tr_b16 v[78:79], v222 offset:9216
    ds_read_b64_tr_b16 v[80:81], v223 offset:8192
    ds_read_b64_tr_b16 v[82:83], v223 offset:9216
    s_waitcnt lgkmcnt(4)
    v_mfma_f32_32x32x16_bf16 v[4:19], v[180:183], v[68:71], v[4:19]
    v_mfma_f32_32x32x16_bf16 v[20:35], v[180:183], v[72:75], v[20:35]
    s_add_u32 m0, s59, 65536
    s_add_u32 s58, s58, 65536
    buffer_load_dwordx4 v206, s[20:23], s58 offen offset:0 lds
    buffer_load_dwordx4 v207, s[20:23], s58 offen offset:1024 lds
    v_mfma_f32_32x32x16_bf16 v[36:51], v[184:187], v[68:71], v[36:51]
    v_mfma_f32_32x32x16_bf16 v[52:67], v[184:187], v[72:75], v[52:67]
    s_add_u32 s78, s78, 14336
    buffer_load_dwordx4 v[180:183], v212, s[40:43], s78 offen sc1
    buffer_load_dwordx4 v[184:187], v213, s[40:43], s78 offen sc1
    ds_read_b64_tr_b16 v[68:69], v222 offset:16384
    ds_read_b64_tr_b16 v[70:71], v222 offset:17408
    ds_read_b64_tr_b16 v[72:73], v223 offset:16384
    ds_read_b64_tr_b16 v[74:75], v223 offset:17408
    s_waitcnt lgkmcnt(4)
    v_mfma_f32_32x32x16_bf16 v[4:19], v[188:191], v[76:79], v[4:19]
    v_mfma_f32_32x32x16_bf16 v[20:35], v[188:191], v[80:83], v[20:35]
    s_add_u32 m0, s59, 73728
    s_add_u32 s58, s58, 65536
    buffer_load_dwordx4 v206, s[20:23], s58 offen offset:0 lds
    buffer_load_dwordx4 v207, s[20:23], s58 offen offset:1024 lds
    v_mfma_f32_32x32x16_bf16 v[36:51], v[192:195], v[76:79], v[36:51]
    v_mfma_f32_32x32x16_bf16 v[52:67], v[192:195], v[80:83], v[52:67]
    ds_read_b64_tr_b16 v[76:77], v222 offset:24576
    ds_read_b64_tr_b16 v[78:79], v222 offset:25600
    ds_read_b64_tr_b16 v[80:81], v223 offset:24576
    ds_read_b64_tr_b16 v[82:83], v223 offset:25600
    s_waitcnt lgkmcnt(4)
    v_mfma_f32_32x32x16_bf16 v[4:19], v[196:199], v[68:71], v[4:19]
    v_mfma_f32_32x32x16_bf16 v[20:35], v[196:199], v[72:75], v[20:35]
    s_add_u32 m0, s59, 81920
    s_add_u32 s58, s58, 65536
    buffer_load_dwordx4 v206, s[20:23], s58 offen offset:0 lds
    buffer_load_dwordx4 v207, s[20:23], s58 offen offset:1024 lds
    v_mfma_f32_32x32x16_bf16 v[36:51], v[200:203], v[68:71], v[36:51]
    v_mfma_f32_32x32x16_bf16 v[52:67], v[200:203], v[72:75], v[52:67]
    ds_read_b64_tr_b16 v[68:69], v220 offset:0
    ds_read_b64_tr_b16 v[70:71], v220 offset:1024
    ds_read_b64_tr_b16 v[72:73], v221 offset:0
    ds_read_b64_tr_b16 v[74:75], v221 offset:1024
    s_waitcnt lgkmcnt(4)
    v_mfma_f32_32x32x16_bf16 v[4:19], v[84:87], v[76:79], v[4:19]
    v_mfma_f32_32x32x16_bf16 v[20:35], v[84:87], v[80:83], v[20:35]
    s_add_u32 m0, s59, 90112
    s_add_u32 s58, s58, 65536
    buffer_load_dwordx4 v206, s[20:23], s58 offen offset:0 lds
    buffer_load_dwordx4 v207, s[20:23], s58 offen offset:1024 lds
    v_mfma_f32_32x32x16_bf16 v[36:51], v[88:91], v[76:79], v[36:51]
    v_mfma_f32_32x32x16_bf16 v[52:67], v[88:91], v[80:83], v[52:67]
    ds_read_b64_tr_b16 v[76:77], v220 offset:8192
    ds_read_b64_tr_b16 v[78:79], v220 offset:9216
    ds_read_b64_tr_b16 v[80:81], v221 offset:8192
    ds_read_b64_tr_b16 v[82:83], v221 offset:9216
    s_waitcnt lgkmcnt(4)
    v_mfma_f32_32x32x16_bf16 v[4:19], v[92:95], v[68:71], v[4:19]
    v_mfma_f32_32x32x16_bf16 v[20:35], v[92:95], v[72:75], v[20:35]
    s_add_u32 m0, s59, 0
    s_xor_b32 s58, s60, 0
    s_mul_i32 s58, s58, 12544
    buffer_load_dwordx4 v208, s[12:15], s58 offen offset:0 lds
    buffer_load_dwordx4 v209, s[12:15], s58 offen offset:1024 lds
    v_mfma_f32_32x32x16_bf16 v[36:51], v[96:99], v[68:71], v[36:51]
    v_mfma_f32_32x32x16_bf16 v[52:67], v[96:99], v[72:75], v[52:67]
    ds_read_b64_tr_b16 v[68:69], v220 offset:16384
    ds_read_b64_tr_b16 v[70:71], v220 offset:17408
    ds_read_b64_tr_b16 v[72:73], v221 offset:16384
    ds_read_b64_tr_b16 v[74:75], v221 offset:17408
    s_waitcnt lgkmcnt(4)
    v_mfma_f32_32x32x16_bf16 v[4:19], v[100:103], v[76:79], v[4:19]
    v_mfma_f32_32x32x16_bf16 v[20:35], v[100:103], v[80:83], v[20:35]
    s_add_u32 m0, s59, 8192
    s_add_u32 s58, s58, 14336
    buffer_load_dwordx4 v208, s[12:15], s58 offen offset:0 lds
    buffer_load_dwordx4 v209, s[12:15], s58 offen offset:1024 lds
    v_mfma_f32_32x32x16_bf16 v[36:51], v[104:107], v[76:79], v[36:51]
    v_mfma_f32_32x32x16_bf16 v[52:67], v[104:107], v[80:83], v[52:67]
    ds_read_b64_tr_b16 v[76:77], v220 offset:24576
    ds_read_b64_tr_b16 v[78:79], v220 offset:25600
    ds_read_b64_tr_b16 v[80:81], v221 offset:24576
    ds_read_b64_tr_b16 v[82:83], v221 offset:25600
    s_waitcnt lgkmcnt(4)
    v_mfma_f32_32x32x16_bf16 v[4:19], v[108:111], v[68:71], v[4:19]
    v_mfma_f32_32x32x16_bf16 v[20:35], v[108:111], v[72:75], v[20:35]
    s_add_u32 m0, s59, 16384
    s_xor_b32 s58, s60, 2
    s_mul_i32 s58, s58, 12544
    buffer_load_dwordx4 v208, s[12:15], s58 offen offset:0 lds
    buffer_load_dwordx4 v209, s[12:15], s58 offen offset:1024 lds
    v_mfma_f32_32x32x16_bf16 v[36:51], v[112:115], v[68:71], v[36:51]
    v_mfma_f32_32x32x16_bf16 v[52:67], v[112:115], v[72:75], v[52:67]
    s_waitcnt vmcnt(30)
    ds_read_b64_tr_b16 v[68:69], v220 offset:32768
    ds_read_b64_tr_b16 v[70:71], v220 offset:33792
    ds_read_b64_tr_b16 v[72:73], v221 offset:32768
    ds_read_b64_tr_b16 v[74:75], v221 offset:33792
    s_waitcnt lgkmcnt(4)
    v_mfma_f32_32x32x16_bf16 v[4:19], v[116:119], v[76:79], v[4:19]
    v_mfma_f32_32x32x16_bf16 v[20:35], v[116:119], v[80:83], v[20:35]
    s_add_u32 m0, s59, 24576
    s_add_u32 s58, s58, 14336
    buffer_load_dwordx4 v208, s[12:15], s58 offen offset:0 lds
    buffer_load_dwordx4 v209, s[12:15], s58 offen offset:1024 lds
    v_mfma_f32_32x32x16_bf16 v[36:51], v[120:123], v[76:79], v[36:51]
    v_mfma_f32_32x32x16_bf16 v[52:67], v[120:123], v[80:83], v[52:67]
    s_waitcnt vmcnt(28)
    ds_read_b64_tr_b16 v[76:77], v220 offset:40960
    ds_read_b64_tr_b16 v[78:79], v220 offset:41984
    ds_read_b64_tr_b16 v[80:81], v221 offset:40960
    ds_read_b64_tr_b16 v[82:83], v221 offset:41984
    s_waitcnt lgkmcnt(4)
    v_mfma_f32_32x32x16_bf16 v[4:19], v[124:127], v[68:71], v[4:19]
    v_mfma_f32_32x32x16_bf16 v[20:35], v[124:127], v[72:75], v[20:35]
    s_add_u32 m0, s59, 32768
    s_xor_b32 s58, s60, 4
    s_mul_i32 s58, s58, 12544
    buffer_load_dwordx4 v208, s[12:15], s58 offen offset:0 lds
    buffer_load_dwordx4 v209, s[12:15], s58 offen offset:1024 lds
    v_mfma_f32_32x32x16_bf16 v[36:51], v[128:131], v[68:71], v[36:51]
    v_mfma_f32_32x32x16_bf16 v[52:67], v[128:131], v[72:75], v[52:67]
    s_waitcnt vmcnt(26)
    ds_read_b64_tr_b16 v[68:69], v220 offset:49152
    ds_read_b64_tr_b16 v[70:71], v220 offset:50176
    ds_read_b64_tr_b16 v[72:73], v221 offset:49152
    ds_read_b64_tr_b16 v[74:75], v221 offset:50176
    s_waitcnt lgkmcnt(4)
    v_mfma_f32_32x32x16_bf16 v[4:19], v[132:135], v[76:79], v[4:19]
    v_mfma_f32_32x32x16_bf16 v[20:35], v[132:135], v[80:83], v[20:35]
    s_add_u32 m0, s59, 40960
    s_add_u32 s58, s58, 14336
    buffer_load_dwordx4 v208, s[12:15], s58 offen offset:0 lds
    buffer_load_dwordx4 v209, s[12:15], s58 offen offset:1024 lds
    v_mfma_f32_32x32x16_bf16 v[36:51], v[136:139], v[76:79], v[36:51]
    v_mfma_f32_32x32x16_bf16 v[52:67], v[136:139], v[80:83], v[52:67]
    s_waitcnt vmcnt(24)
    ds_read_b64_tr_b16 v[76:77], v220 offset:57344
    ds_read_b64_tr_b16 v[78:79], v220 offset:58368
    ds_read_b64_tr_b16 v[80:81], v221 offset:57344
    ds_read_b64_tr_b16 v[82:83], v221 offset:58368
    s_waitcnt lgkmcnt(4)
    v_mfma_f32_32x32x16_bf16 v[4:19], v[140:143], v[68:71], v[4:19]
    v_mfma_f32_32x32x16_bf16 v[20:35], v[140:143], v[72:75], v[20:35]
    s_add_u32 m0, s59, 49152
    s_xor_b32 s58, s60, 6
    s_mul_i32 s58, s58, 12544
    buffer_load_dwordx4 v208, s[12:15], s58 offen offset:0 lds
    buffer_load_dwordx4 v209, s[12:15], s58 offen offset:1024 lds
    v_mfma_f32_32x32x16_bf16 v[36:51], v[144:147], v[68:71], v[36:51]
    v_mfma_f32_32x32x16_bf16 v[52:67], v[144:147], v[72:75], v[52:67]
    s_waitcnt vmcnt(22)
    ds_read_b64_tr_b16 v[68:69], v222 offset:0
    ds_read_b64_tr_b16 v[70:71], v222 offset:1024
    ds_read_b64_tr_b16 v[72:73], v223 offset:0
    ds_read_b64_tr_b16 v[74:75], v223 offset:1024
    s_waitcnt lgkmcnt(4)
    v_mfma_f32_32x32x16_bf16 v[4:19], v[148:151], v[76:79], v[4:19]
    v_mfma_f32_32x32x16_bf16 v[20:35], v[148:151], v[80:83], v[20:35]
    s_add_u32 m0, s59, 57344
    s_add_u32 s58, s58, 14336
    buffer_load_dwordx4 v208, s[12:15], s58 offen offset:0 lds
    buffer_load_dwordx4 v209, s[12:15], s58 offen offset:1024 lds
    v_mfma_f32_32x32x16_bf16 v[36:51], v[152:155], v[76:79], v[36:51]
    v_mfma_f32_32x32x16_bf16 v[52:67], v[152:155], v[80:83], v[52:67]
    s_waitcnt vmcnt(20)
    ds_read_b64_tr_b16 v[76:77], v222 offset:8192
    ds_read_b64_tr_b16 v[78:79], v222 offset:9216
    ds_read_b64_tr_b16 v[80:81], v223 offset:8192
    ds_read_b64_tr_b16 v[82:83], v223 offset:9216
    s_waitcnt lgkmcnt(4)
    v_mfma_f32_32x32x16_bf16 v[4:19], v[156:159], v[68:71], v[4:19]
    v_mfma_f32_32x32x16_bf16 v[20:35], v[156:159], v[72:75], v[20:35]
    v_mfma_f32_32x32x16_bf16 v[36:51], v[160:163], v[68:71], v[36:51]
    v_mfma_f32_32x32x16_bf16 v[52:67], v[160:163], v[72:75], v[52:67]
    s_waitcnt vmcnt(18)
    ds_read_b64_tr_b16 v[68:69], v222 offset:16384
    ds_read_b64_tr_b16 v[70:71], v222 offset:17408
    ds_read_b64_tr_b16 v[72:73], v223 offset:16384
    ds_read_b64_tr_b16 v[74:75], v223 offset:17408
    s_waitcnt lgkmcnt(4)
    v_mfma_f32_32x32x16_bf16 v[4:19], v[164:167], v[76:79], v[4:19]
    v_mfma_f32_32x32x16_bf16 v[20:35], v[164:167], v[80:83], v[20:35]
    v_mfma_f32_32x32x16_bf16 v[36:51], v[168:171], v[76:79], v[36:51]
    v_mfma_f32_32x32x16_bf16 v[52:67], v[168:171], v[80:83], v[52:67]
    s_waitcnt vmcnt(16)
    ds_read_b64_tr_b16 v[76:77], v222 offset:24576
    ds_read_b64_tr_b16 v[78:79], v222 offset:25600
    ds_read_b64_tr_b16 v[80:81], v223 offset:24576
    ds_read_b64_tr_b16 v[82:83], v223 offset:25600
    s_waitcnt lgkmcnt(4)
    v_mfma_f32_32x32x16_bf16 v[4:19], v[172:175], v[68:71], v[4:19]
    v_mfma_f32_32x32x16_bf16 v[20:35], v[172:175], v[72:75], v[20:35]
    v_mfma_f32_32x32x16_bf16 v[36:51], v[176:179], v[68:71], v[36:51]
    v_mfma_f32_32x32x16_bf16 v[52:67], v[176:179], v[72:75], v[52:67]
    s_waitcnt lgkmcnt(0)
    v_mfma_f32_32x32x16_bf16 v[4:19], v[180:183], v[76:79], v[4:19]
    v_mfma_f32_32x32x16_bf16 v[20:35], v[180:183], v[80:83], v[20:35]
    v_mfma_f32_32x32x16_bf16 v[36:51], v[184:187], v[76:79], v[36:51]
    v_mfma_f32_32x32x16_bf16 v[52:67], v[184:187], v[80:83], v[52:67]
    v_mov_b32 v232, 163632
    v_mov_b32 v233, 1
    s_mov_b64 exec, 1
    ds_add_u32 v232, v233
    s_mov_b64 exec, -1
    s_mul_i32 s49, s76, 17408
    s_add_u32 s49, s49, 90112
    v_and_b32 v240, 31, v1
    v_mul_u32_u24 v240, 272, v240
    v_lshrrev_b32 v233, 5, v1
    v_lshl_add_u32 v240, v233, 4, v240
    v_add_u32 v240, s49, v240
    v_mov_b32 v232, 163600
    s_mov_b32 s80, 0
L_ev_60:
    s_sleep 1
    ds_read_b32 v233, v232
    s_add_u32 s80, s80, 1
    s_waitcnt lgkmcnt(0)
    v_readfirstlane_b32 s48, v233
    s_cmp_ge_u32 s80, 0x400000
    s_cbranch_scc1 L_eve_61
    s_cmp_lt_u32 s48, 4
    s_cbranch_scc1 L_ev_60
L_eve_61:
    v_mov_b32 v232, 163632
    s_mov_b32 s80, 0
L_ev_62:
    ds_read_b32 v233, v232
    s_add_u32 s80, s80, 1
    s_waitcnt lgkmcnt(0)
    v_readfirstlane_b32 s48, v233
    s_cmp_ge_u32 s80, 0x400000
    s_cbranch_scc1 L_eve_63
    s_cmp_lt_u32 s48, 4
    s_cbranch_scc1 L_ev_62
L_eve_63:
    s_lshl_b32 s49, s74, 5
    s_lshl_b32 s50, s76, 2
    s_add_u32 s49, s49, s50
    s_add_u32 s49, s49, 512
    v_lshrrev_b32 v232, 2, v1
    v_lshlrev_b32 v232, 4, v232
    v_and_b32 v233, 3, v1
    v_add3_u32 v232, v232, v233, s49
    v_lshlrev_b32 v232, 7, v232
    s_mov_b64 exec, 0xff
    s_mov_b32 s80, 0
    s_branch L_pollf_66
L_poll_64:
    s_sleep 2
L_pollf_66:
    buffer_load_dwordx2 v[234:235], v232, s[40:43], 0 offen sc1
    s_add_u32 s80, s80, 1
    s_cmp_ge_u32 s80, 0x100000
    s_waitcnt vmcnt(0)
    s_cbranch_scc1 L_polle_65
    v_cmp_ne_u64 vcc, s[64:65], v[234:235]
    s_cbranch_vccnz L_poll_64
L_polle_65:
    s_mov_b64 exec, -1
    s_lshl_b32 s81, s74, 16
    s_lshl_b32 s48, s76, 13
    s_add_u32 s81, s81, s48
    s_add_u32 s81, s81, 0x990000
    s_xor_b32 s78, s60, 0
    s_mul_i32 s78, s78, 1024
    s_add_u32 s78, s78, s81
    buffer_load_dwordx4 v[84:87], v214, s[40:43], s78 offen sc1
    buffer_load_dwordx4 v[88:91], v215, s[40:43], s78 offen sc1
    s_add_u32 s78, s78, 1024
    buffer_load_dwordx4 v[92:95], v214, s[40:43], s78 offen sc1
    buffer_load_dwordx4 v[96:99], v215, s[40:43], s78 offen sc1
    s_xor_b32 s78, s60, 2
    s_mul_i32 s78, s78, 1024
    s_add_u32 s78, s78, s81
    buffer_load_dwordx4 v[100:103], v214, s[40:43], s78 offen sc1
    buffer_load_dwordx4 v[104:107], v215, s[40:43], s78 offen sc1
    s_add_u32 s78, s78, 1024
    buffer_load_dwordx4 v[108:111], v214, s[40:43], s78 offen sc1
    buffer_load_dwordx4 v[112:115], v215, s[40:43], s78 offen sc1
    s_xor_b32 s78, s60, 4
    s_mul_i32 s78, s78, 1024
    s_add_u32 s78, s78, s81
    buffer_load_dwordx4 v[116:119], v214, s[40:43], s78 offen sc1
    buffer_load_dwordx4 v[120:123], v215, s[40:43], s78 offen sc1
    s_add_u32 s78, s78, 1024
    buffer_load_dwordx4 v[124:127], v214, s[40:43], s78 offen sc1
    buffer_load_dwordx4 v[128:131], v215, s[40:43], s78 offen sc1
    s_xor_b32 s78, s60, 6
    s_mul_i32 s78, s78, 1024
    s_add_u32 s78, s78, s81
    buffer_load_dwordx4 v[132:135], v214, s[40:43], s78 offen sc1
    buffer_load_dwordx4 v[136:139], v215, s[40:43], s78 offen sc1
    s_add_u32 s78, s78, 1024
    buffer_load_dwordx4 v[140:143], v214, s[40:43], s78 offen sc1
    buffer_load_dwordx4 v[144:147], v215, s[40:43], s78 offen sc1
    s_waitcnt vmcnt(14)
    ds_read_b64_tr_b16 v[68:69], v220 offset:0
    ds_read_b64_tr_b16 v[70:71], v220 offset:1024
    ds_read_b64_tr_b16 v[72:73], v221 offset:0
    ds_read_b64_tr_b16 v[74:75], v221 offset:1024
    ds_read_b64_tr_b16 v[76:77], v220 offset:8192
    ds_read_b64_tr_b16 v[78:79], v220 offset:9216
    ds_read_b64_tr_b16 v[80:81], v221 offset:8192
    ds_read_b64_tr_b16 v[82:83], v221 offset:9216
    s_waitcnt lgkmcnt(4)
    v_mfma_f32_32x32x16_bf16 v[4:19], v[68:71], v[84:87], v[4:19]
    v_mfma_f32_32x32x16_bf16 v[20:35], v[68:71], v[88:91], v[20:35]
    v_mfma_f32_32x32x16_bf16 v[36:51], v[72:75], v[84:87], v[36:51]
    v_mfma_f32_32x32x16_bf16 v[52:67], v[72:75], v[88:91], v[52:67]
    s_waitcnt vmcnt(12)
    ds_read_b64_tr_b16 v[68:69], v220 offset:16384
    ds_read_b64_tr_b16 v[70:71], v220 offset:17408
    ds_read_b64_tr_b16 v[72:73], v221 offset:16384
    ds_read_b64_tr_b16 v[74:75], v221 offset:17408
    s_waitcnt lgkmcnt(4)
    v_mfma_f32_32x32x16_bf16 v[4:19], v[76:79], v[92:95], v[4:19]
    v_mfma_f32_32x32x16_bf16 v[20:35], v[76:79], v[96:99], v[20:35]
    v_mfma_f32_32x32x16_bf16 v[36:51], v[80:83], v[92:95], v[36:51]
    v_mfma_f32_32x32x16_bf16 v[52:67], v[80:83], v[96:99], v[52:67]
    s_waitcnt vmcnt(10)
    ds_read_b64_tr_b16 v[76:77], v220 offset:24576
    ds_read_b64_tr_b16 v[78:79], v220 offset:25600
    ds_read_b64_tr_b16 v[80:81], v221 offset:24576
    ds_read_b64_tr_b16 v[82:83], v221 offset:25600
    s_waitcnt lgkmcnt(4)
    v_mfma_f32_32x32x16_bf16 v[4:19], v[68:71], v[100:103], v[4:19]
    v_mfma_f32_32x32x16_bf16 v[20:35], v[68:71], v[104:107], v[20:35]
    v_mfma_f32_32x32x16_bf16 v[36:51], v[72:75], v[100:103], v[36:51]
    v_mfma_f32_32x32x16_bf16 v[52:67], v[72:75], v[104:107], v[52:67]
    s_waitcnt vmcnt(8)
    ds_read_b64_tr_b16 v[68:69], v220 offset:32768
    ds_read_b64_tr_b16 v[70:71], v220 offset:33792
    ds_read_b64_tr_b16 v[72:73], v221 offset:32768
    ds_read_b64_tr_b16 v[74:75], v221 offset:33792
    s_waitcnt lgkmcnt(4)
    v_mfma_f32_32x32x16_bf16 v[4:19], v[76:79], v[108:111], v[4:19]
    v_mfma_f32_32x32x16_bf16 v[20:35], v[76:79], v[112:115], v[20:35]
    v_mfma_f32_32x32x16_bf16 v[36:51], v[80:83], v[108:111], v[36:51]
    v_mfma_f32_32x32x16_bf16 v[52:67], v[80:83], v[112:115], v[52:67]
    s_waitcnt vmcnt(6)
    ds_read_b64_tr_b16 v[76:77], v220 offset:40960
    ds_read_b64_tr_b16 v[78:79], v220 offset:41984
    ds_read_b64_tr_b16 v[80:81], v221 offset:40960
    ds_read_b64_tr_b16 v[82:83], v221 offset:41984
    s_waitcnt lgkmcnt(4)
    v_mfma_f32_32x32x16_bf16 v[4:19], v[68:71], v[116:119], v[4:19]
    v_mfma_f32_32x32x16_bf16 v[20:35], v[68:71], v[120:123], v[20:35]
    v_mfma_f32_32x32x16_bf16 v[36:51], v[72:75], v[116:119], v[36:51]
    v_mfma_f32_32x32x16_bf16 v[52:67], v[72:75], v[120:123], v[52:67]
    s_waitcnt vmcnt(4)
    ds_read_b64_tr_b16 v[68:69], v220 offset:49152
    ds_read_b64_tr_b16 v[70:71], v220 offset:50176
    ds_read_b64_tr_b16 v[72:73], v221 offset:49152
    ds_read_b64_tr_b16 v[74:75], v221 offset:50176
    s_waitcnt lgkmcnt(4)
    v_mfma_f32_32x32x16_bf16 v[4:19], v[76:79], v[124:127], v[4:19]
    v_mfma_f32_32x32x16_bf16 v[20:35], v[76:79], v[128:131], v[20:35]
    v_mfma_f32_32x32x16_bf16 v[36:51], v[80:83], v[124:127], v[36:51]
    v_mfma_f32_32x32x16_bf16 v[52:67], v[80:83], v[128:131], v[52:67]
    s_waitcnt vmcnt(2)
    ds_read_b64_tr_b16 v[76:77], v220 offset:57344
    ds_read_b64_tr_b16 v[78:79], v220 offset:58368
    ds_read_b64_tr_b16 v[80:81], v221 offset:57344
    ds_read_b64_tr_b16 v[82:83], v221 offset:58368
    s_waitcnt lgkmcnt(4)
    v_mfma_f32_32x32x16_bf16 v[4:19], v[68:71], v[132:135], v[4:19]
    v_mfma_f32_32x32x16_bf16 v[20:35], v[68:71], v[136:139], v[20:35]
    v_mfma_f32_32x32x16_bf16 v[36:51], v[72:75], v[132:135], v[36:51]
    v_mfma_f32_32x32x16_bf16 v[52:67], v[72:75], v[136:139], v[52:67]
    s_waitcnt vmcnt(0)
    s_waitcnt lgkmcnt(0)
    v_mfma_f32_32x32x16_bf16 v[4:19], v[76:79], v[140:143], v[4:19]
    v_mfma_f32_32x32x16_bf16 v[20:35], v[76:79], v[144:147], v[20:35]
    v_mfma_f32_32x32x16_bf16 v[36:51], v[80:83], v[140:143], v[36:51]
    v_mfma_f32_32x32x16_bf16 v[52:67], v[80:83], v[144:147], v[52:67]
    s_nop 8
    ds_write_b128 v240, v[4:7] offset:0
    ds_write_b128 v240, v[8:11] offset:32
    ds_write_b128 v240, v[12:15] offset:64
    ds_write_b128 v240, v[16:19] offset:96
    ds_write_b128 v240, v[20:23] offset:8704
    ds_write_b128 v240, v[24:27] offset:8736
    ds_write_b128 v240, v[28:31] offset:8768
    ds_write_b128 v240, v[32:35] offset:8800
    ds_write_b128 v240, v[36:39] offset:128
    ds_write_b128 v240, v[40:43] offset:160
    ds_write_b128 v240, v[44:47] offset:192
    ds_write_b128 v240, v[48:51] offset:224
    ds_write_b128 v240, v[52:55] offset:8832
    ds_write_b128 v240, v[56:59] offset:8864
    ds_write_b128 v240, v[60:63] offset:8896
    ds_write_b128 v240, v[64:67] offset:8928
L_fin:
    s_waitcnt vmcnt(0) lgkmcnt(0)
    s_barrier
    ds_read_b128 v[4:7], v246 offset:0
    ds_read_b128 v[8:11], v246 offset:16
    ds_read_b128 v[12:15], v246 offset:17408
    ds_read_b128 v[16:19], v246 offset:17424
    ds_read_b128 v[20:23], v246 offset:34816
    ds_read_b128 v[24:27], v246 offset:34832
    ds_read_b128 v[28:31], v246 offset:52224
    ds_read_b128 v[32:35], v246 offset:52240
    v_lshlrev_b32 v252, 16, v252
    v_lshlrev_b32 v40, 16, v248
    v_and_b32 v41, 0xffff0000, v248
    v_lshlrev_b32 v42, 16, v249
    v_and_b32 v43, 0xffff0000, v249
    v_lshlrev_b32 v44, 16, v250
    v_and_b32 v45, 0xffff0000, v250
    v_lshlrev_b32 v46, 16, v251
    v_and_b32 v47, 0xffff0000, v251
    v_add_f32 v40, v40, v252
    v_add_f32 v41, v41, v252
    v_add_f32 v42, v42, v252
    v_add_f32 v43, v43, v252
    v_add_f32 v44, v44, v252
    v_add_f32 v45, v45, v252
    v_add_f32 v46, v46, v252
    v_add_f32 v47, v47, v252
    s_waitcnt lgkmcnt(6)
    v_add_f32 v40, v40, v4
    v_add_f32 v41, v41, v5
    v_add_f32 v42, v42, v6
    v_add_f32 v43, v43, v7
    v_add_f32 v44, v44, v8
    v_add_f32 v45, v45, v9
    v_add_f32 v46, v46, v10
    v_add_f32 v47, v47, v11
    s_waitcnt lgkmcnt(4)
    v_add_f32 v40, v40, v12
    v_add_f32 v41, v41, v13
    v_add_f32 v42, v42, v14
    v_add_f32 v43, v43, v15
    v_add_f32 v44, v44, v16
    v_add_f32 v45, v45, v17
    v_add_f32 v46, v46, v18
    v_add_f32 v47, v47, v19
    s_waitcnt lgkmcnt(2)
    v_add_f32 v40, v40, v20
    v_add_f32 v41, v41, v21
    v_add_f32 v42, v42, v22
    v_add_f32 v43, v43, v23
    v_add_f32 v44, v44, v24
    v_add_f32 v45, v45, v25
    v_add_f32 v46, v46, v26
    v_add_f32 v47, v47, v27
    s_waitcnt lgkmcnt(0)
    v_add_f32 v40, v40, v28
    v_add_f32 v41, v41, v29
    v_add_f32 v42, v42, v30
    v_add_f32 v43, v43, v31
    v_add_f32 v44, v44, v32
    v_add_f32 v45, v45, v33
    v_add_f32 v46, v46, v34
    v_add_f32 v47, v47, v35
    v_cvt_pk_bf16_f32 v48, v40, v41
    v_cvt_pk_bf16_f32 v49, v42, v43
    v_cvt_pk_bf16_f32 v50, v44, v45
    v_cvt_pk_bf16_f32 v51, v46, v47
    buffer_store_dwordx4 v[48:51], v247, s[32:35], 0 offen nt
L_end:
    s_endpgm
L_spare:
    v_mov_b32 v4, 163592
    v_mov_b32 v5, 1
    s_mov_b64 exec, 1
    ds_add_u32 v4, v5
    s_mov_b64 exec, -1
    v_mov_b32 v4, 163616
    v_mov_b32 v5, 1
    s_mov_b64 exec, 1
    ds_add_u32 v4, v5
    s_mov_b64 exec, -1
    v_mov_b32 v4, 163604
    s_mov_b32 s80, 0
L_ev_67:
    s_sleep 4
    ds_read_b32 v5, v4
    s_add_u32 s80, s80, 1
    s_waitcnt lgkmcnt(0)
    v_readfirstlane_b32 s48, v5
    s_cmp_ge_u32 s80, 0x400000
    s_cbranch_scc1 L_eve_68
    s_cmp_lt_u32 s48, 4
    s_cbranch_scc1 L_ev_67
L_eve_68:
    s_and_b32 s48, s46, 3
    s_lshl_b32 s48, s48, 4
    s_mul_i32 s49, s76, 448
    s_add_u32 s48, s48, s49
    s_lshl_b32 s48, s48, 12
    s_lshl_b32 s49, s45, 9
    s_add_u32 s48, s48, s49
    v_lshrrev_b32 v6, 2, v1
    v_mul_u32_u24 v6, 4096, v6
    v_and_b32 v7, 3, v1
    v_lshl_add_u32 v6, v7, 7, v6
    buffer_load_dword v7, v6, s[20:23], s48 offen
    s_add_u32 s48, s48, 262144
    s_waitcnt vmcnt(0)
    buffer_load_dword v7, v6, s[20:23], s48 offen
    s_add_u32 s48, s48, 262144
    s_waitcnt vmcnt(0)
    buffer_load_dword v7, v6, s[20:23], s48 offen
    s_add_u32 s48, s48, 262144
    s_waitcnt vmcnt(0)
    buffer_load_dword v7, v6, s[20:23], s48 offen
    s_add_u32 s48, s48, 262144
    s_waitcnt vmcnt(0)
    buffer_load_dword v7, v6, s[20:23], s48 offen
    s_add_u32 s48, s48, 262144
    s_waitcnt vmcnt(0)
    buffer_load_dword v7, v6, s[20:23], s48 offen
    s_add_u32 s48, s48, 262144
    s_waitcnt vmcnt(0)
    buffer_load_dword v7, v6, s[20:23], s48 offen
    s_add_u32 s48, s48, 262144
    s_waitcnt vmcnt(0)
L_last:
    s_endpgm
.section .rodata,"a"
.p2align 6
.amdhsa_kernel parallel_sum__softmax_full_mha__mixer_token_mlp__prompt_kernel
  .amdhsa_next_free_vgpr 256
  .amdhsa_next_free_sgpr 102
  .amdhsa_accum_offset 256
  .amdhsa_group_segment_fixed_size 0
  .amdhsa_kernarg_size 88
  .amdhsa_user_sgpr_count 2
  .amdhsa_user_sgpr_kernarg_segment_ptr 1
  .amdhsa_system_sgpr_workgroup_id_x 1
.end_amdhsa_kernel
```
